```python
import torch

def _softmax(x, axis=-1):
    return torch.softmax(x, dim=axis)
def _gelu(x):
    return torch.nn.functional.gelu(x, approximate="tanh")
def _silu(x):
    return torch.nn.functional.silu(x)
def _sigmoid(x):
    return torch.sigmoid(x)
def _layernorm(x, axis=-1, eps=1e-5):
    m = x.mean(dim=axis, keepdim=True)
    v = x.var(dim=axis, keepdim=True, unbiased=False)
    return (x - m) / torch.sqrt(v + eps)
def _scatter_add(tgt, idx, src, axis=0):
    return tgt.clone().index_add_(axis, idx, src)
def _segment_sum(src, seg, n):
    out = torch.zeros((n,) + src.shape[1:], dtype=src.dtype)
    return out.index_add_(0, seg, src)
def _pad(x, pw):
    flat = tuple(v for pair in reversed(pw) for v in pair)
    return torch.nn.functional.pad(x, flat)

kernel_name = 'interleave_layers__spectral_gfnet__dense_activation_gelu__prompt'

def setup_inputs():

    _w = (lambda a: (lambda t: t.to(torch.bfloat16) if t.is_floating_point() else t)(torch.as_tensor(a)))
    def _A_setup():
        B, S, D = 1, 2048, 640
        Df = D // 2 + 1
        return {
            "x": _w((lambda *s: torch.randn(*s, dtype=torch.bfloat16) * 0.05)(B, S, D)),
            "w_r": _w((lambda *s: torch.randn(*s, dtype=torch.bfloat16) * 0.4)(S, Df) * 0.02),
            "w_i": _w((lambda *s: torch.randn(*s, dtype=torch.bfloat16) * 0.4)(S, Df) * 0.02),
        }
    _A_in = _A_setup()

    def _B_setup():
        B, S, D, F = 1, 2048, 640, 1536
        return {
            "x": _w((lambda *s: torch.randn(*s, dtype=torch.bfloat16) * 0.05)(B, S, D)),
            "w1": _w((lambda *s: torch.randn(*s, dtype=torch.bfloat16) * 0.4)(D, F) * (D ** -0.5)),
            "b1": _w((lambda *s: torch.randn(*s, dtype=torch.bfloat16) * 12.8)(F) * 0.01),
            "w2": _w((lambda *s: torch.randn(*s, dtype=torch.bfloat16) * 0.1)(F, D) * (F ** -0.5)),
            "b2": _w((lambda *s: torch.randn(*s, dtype=torch.bfloat16) * 0.8)(D) * 0.01),
        }
    _B_in = _B_setup()

    return {
        "A_x": _A_in["x"],
        "A_w_r": _A_in["w_r"],
        "A_w_i": _A_in["w_i"],
        "B_x": _B_in["x"],
        "B_w1": _B_in["w1"],
        "B_b1": _B_in["b1"],
        "B_w2": _B_in["w2"],
        "B_b2": _B_in["b2"],
    }

def reference(A_x, A_w_r, A_w_i, B_x, B_w1, B_b1, B_w2, B_b2):
    def _A_ref(x, w_r, w_i):
        B, S, D = x.shape
        X = (lambda x, axes=(-2,-1): torch.fft.rfft2(x.float(), dim=axes))(x, axes=(-2, -1))
        W = w_r + 1j * w_i
        X = X * W
        y = (lambda x, s, axes=(-2,-1): torch.fft.irfft2(x, s=s, dim=axes).to(torch.bfloat16))(X, (S, D), axes=(-2, -1))
        return y

    def _B_ref(x, w1, b1, w2, b2):
        h = torch.einsum("bsd,df->bsf", x, w1) + b1
        h = _gelu(h)
        return torch.einsum("bsf,fd->bsd", h, w2) + b2

    x = A_x
    x = x + _A_ref(_layernorm(x, axis=-1), A_w_r, A_w_i)
    x = x + _B_ref(_layernorm(x, axis=-1), B_w1, B_b1, B_w2, B_b2)
    x = x + _A_ref(_layernorm(x, axis=-1), A_w_r, A_w_i)
    x = x + _B_ref(_layernorm(x, axis=-1), B_w1, B_b1, B_w2, B_b2)
    return x
```

```asm
; @launch grid=(256,1,1) block=(256,1,1) lds=163840
.amdgcn_target "amdgcn-amd-amdhsa--gfx950"
.text
code_start:
.globl interleave_layers__spectral_gfnet__dense_activation_gelu__prompt_kernel
.p2align 8
.type interleave_layers__spectral_gfnet__dense_activation_gelu__prompt_kernel,@function
interleave_layers__spectral_gfnet__dense_activation_gelu__prompt_kernel:
    s_cmp_ge_u32 s2, 256
    s_cbranch_scc1 K2_end
    s_nop 0
    s_load_dwordx2 s[16:17], s[0:1], 0
    s_load_dwordx2 s[32:33], s[0:1], 32
    s_load_dwordx4 s[20:23], s[0:1], 48
    s_load_dwordx2 s[8:9], s[0:1], 80
    s_load_dwordx2 s[24:25], s[0:1], 8
    s_load_dwordx2 s[28:29], s[0:1], 16
    s_load_dwordx2 s[36:37], s[0:1], 72
    s_load_dwordx2 s[96:97], s[0:1], 40
    s_load_dwordx2 s[98:99], s[0:1], 56
    s_load_dwordx2 s[100:101], s[0:1], 64
    s_cmp_ge_u32 s2, 16
    s_cbranch_scc1 K2_nocp
    s_getpc_b64 s[60:61]
K2_pc:
    s_lshr_b32 s62, s2, 3
    s_mul_i32 s62, s62, 32768
    v_lshl_add_u32 v252, v0, 7, s62
    v_min_u32 v252, code_end-code_start-4, v252
    s_sub_u32 s60, s60, K2_pc-code_start
    s_subb_u32 s61, s61, 0
    v_mov_b32 v253, s61
    v_add_co_u32 v252, vcc, s60, v252
    s_nop 1
    v_addc_co_u32 v253, vcc, 0, v253, vcc
    global_load_dword v254, v[252:253], off
K2_nocp:
    v_lshrrev_b32 v1, 6, v0
    v_and_b32 v0, 63, v0
    v_readfirstlane_b32 s3, v1
    v_and_b32 v1, 15, v0
    v_lshrrev_b32 v2, 4, v0
    v_lshlrev_b32_e64 v3, 4, v0
    s_mov_b32 s10, 268435456
    s_mov_b32 s11, 0x00020000
    s_and_b32 s4, s2, 7
    s_lshr_b32 s5, s2, 3
    s_mov_b32 s38, 256
    s_mov_b32 s39, 0x00020000
    s_mul_i32 s14, s3, 40960
    s_mov_b32 m0, s14
    s_cmp_ge_u32 s5, 25
    s_cbranch_scc1 P0_spare
    s_mul_i32 s7, s5, 52
    s_lshr_b32 s7, s7, 8
    s_mul_i32 s6, s7, 5
    s_sub_u32 s6, s5, s6
    s_lshl_b32 s5, s4, 1
    s_add_u32 s5, s5, s7
    s_add_u32 s12, s5, s4
    s_sub_u32 s12, s12, 2
    s_cmp_ge_u32 s7, 2
    s_cselect_b32 s5, s12, s5
    s_cselect_b32 s7, 1, 0
    s_cselect_b32 s12, s12, 0
    s_cmp_ge_u32 s12, 12
    s_cselect_b32 s7, 2, s7
    s_cselect_b32 s12, 12, 0
    s_sub_u32 s5, s5, s12
P0_typed:
    s_lshl_b32 s5, s5, 2
    s_add_u32 s5, s5, s3
    s_cmp_eq_u32 s7, 1
    s_cbranch_scc1 P0_g1
    v_lshrrev_b32 v4, 3, v0
    v_and_b32 v5, 7, v0
    v_xor_b32 v6, v5, v4
    s_cmp_eq_u32 s7, 2
    s_movk_i32 s12, 2560
    s_cselect_b32 s12, 1280, s12
    s_movk_i32 s13, 1280
    s_cselect_b32 s13, 20480, s13
    s_cmp_eq_u32 s7, 3
    s_cselect_b32 s15, 0, s12
    v_mul_u32_u24 v7, s15, v4
    v_lshl_add_u32 v6, v6, 4, v7
    s_lshl_b32 s12, s12, 3
    s_sub_u32 s12, s12, 2048
    s_sub_u32 s13, s13, 1024
    v_add_u32 v7, s13, v6
    v_add_u32 v8, s12, v6
    v_add_u32 v9, s13, v8
    s_mul_i32 s41, s5, 40960
    s_movk_i32 s48, 128
    s_movk_i32 s49, 1280
    s_lshl_b32 s50, s6, 8
    s_add_u32 s50, s50, s41
P0_geo:
    v_lshrrev_b32 v4, 1, v0
    v_mul_u32_u24 v4, s49, v4
    v_and_b32_e64 v5, 1, v0
    v_lshl_add_u32 v4, v5, 7, v4
    s_waitcnt lgkmcnt(0)
    s_mov_b32 s18, 2621440
    s_mov_b32 s19, 0x00020000
    s_cmp_eq_u32 s7, 3
    s_cselect_b32 s16, s22, s16
    s_cselect_b32 s17, s23, s17
    s_cselect_b32 s18, 1280, s18
    s_cmp_eq_u32 s7, 1
    s_cselect_b32 s16, s32, s16
    s_cselect_b32 s17, s33, s17
    s_cselect_b32 s18, 1966080, s18
    s_cmp_eq_u32 s7, 2
    s_cselect_b32 s16, s20, s16
    s_cselect_b32 s17, s21, s17
    s_cselect_b32 s18, 1966080, s18
    buffer_load_dwordx4 v6, s[16:19], s41 offen offset:0 lds
    buffer_load_dwordx4 v7, s[16:19], s41 offen offset:1024 lds
    buffer_load_dwordx4 v8, s[16:19], s41 offen offset:2048 lds
    buffer_load_dwordx4 v9, s[16:19], s41 offen offset:3072 lds
    s_add_u32 s41, s41, s48
    s_nop 0
    s_add_u32 m0, m0, 4096
    buffer_load_dword v250, v4, s[16:19], s50 offen
    buffer_load_dwordx4 v6, s[16:19], s41 offen offset:0 lds
    buffer_load_dwordx4 v7, s[16:19], s41 offen offset:1024 lds
    buffer_load_dwordx4 v8, s[16:19], s41 offen offset:2048 lds
    buffer_load_dwordx4 v9, s[16:19], s41 offen offset:3072 lds
    s_add_u32 s41, s41, s48
    s_add_u32 m0, m0, 4096
    s_lshl_b32 s44, s6, 6
    s_lshl_b32 s45, s3, 4
    s_add_u32 s45, s45, s44
    v_add_u32_e64 v10, s14, v3
    v_add_u32 v10, 30720, v10
    v_add_u32 v147, s45, v1
    v_lshrrev_b32 v148, 1, v147
    v_and_b32 v149, 1, v147
    v_cvt_f32_u32 v149, v149
    v_mul_f32 v149, 0x3e800000, v149
    v_mov_b32 v150, 0x3d64f92e
    v_mov_b32 v145, 0x3d21e89b
    v_cmp_eq_u32 vcc, 0, v147
    s_nop 1
    v_cndmask_b32 v150, v150, v145, vcc
    v_mov_b32 v145, 160
    v_mov_b32 v144, 0x3e000000
    v_cmp_eq_u32 vcc, 1, v147
    s_nop 1
    v_cndmask_b32 v148, v148, v145, vcc
    v_cndmask_b32 v149, v149, v144, vcc
    v_lshlrev_b32 v145, 3, v2
    v_mul_u32_u24 v145, v145, v148
    v_cvt_f32_u32 v145, v145
    v_cvt_f32_u32_e64 v148, v148
    s_mov_b32 s42, 0x3acccccd
    s_mov_b32 s43, 0x42000000
    v_mul_f32 v144, 0x3d4ccccd, v148
    v_cos_f32_e64 v144, v144
    v_fma_f32 v147, v148, s43, v145
    v_add_f32_e64 v144, v144, v144
    v_fma_f32 v128, v145, s42, v149
    v_fma_f32 v136, v147, s42, v149
    v_cos_f32 v128, v128
    v_cos_f32 v136, v136
    v_add_f32 v145, v145, v148
    v_add_f32 v147, v147, v148
    v_fma_f32 v129, v145, s42, v149
    v_fma_f32 v137, v147, s42, v149
    v_cos_f32 v129, v129
    v_cos_f32 v137, v137
    v_add_f32 v145, v145, v148
    v_add_f32 v147, v147, v148
    v_fma_f32 v130, v145, s42, v149
    v_fma_f32 v138, v147, s42, v149
    v_cos_f32 v130, v130
    v_cos_f32 v138, v138
    v_add_f32 v145, v145, v148
    v_add_f32 v147, v147, v148
    v_fma_f32 v131, v145, s42, v149
    v_fma_f32 v139, v147, s42, v149
    v_cos_f32 v131, v131
    v_cos_f32 v139, v139
    v_add_f32 v145, v145, v148
    v_add_f32 v147, v147, v148
    v_fma_f32 v132, v145, s42, v149
    v_fma_f32 v140, v147, s42, v149
    v_cos_f32 v132, v132
    v_cos_f32 v140, v140
    v_add_f32 v145, v145, v148
    v_add_f32 v147, v147, v148
    v_fma_f32 v133, v145, s42, v149
    v_fma_f32 v141, v147, s42, v149
    v_cos_f32 v133, v133
    v_cos_f32 v141, v141
    v_add_f32 v145, v145, v148
    v_add_f32 v147, v147, v148
    v_fma_f32 v134, v145, s42, v149
    v_fma_f32 v142, v147, s42, v149
    v_cos_f32 v134, v134
    v_cos_f32 v142, v142
    v_add_f32 v145, v145, v148
    v_add_f32 v147, v147, v148
    v_fma_f32 v135, v145, s42, v149
    v_fma_f32 v143, v147, s42, v149
    v_cos_f32 v135, v135
    v_cos_f32 v143, v143
    v_pk_mul_f32 v[128:129], v[128:129], v[150:151] op_sel_hi:[1,0]
    v_pk_mul_f32 v[130:131], v[130:131], v[150:151] op_sel_hi:[1,0]
    v_pk_mul_f32 v[132:133], v[132:133], v[150:151] op_sel_hi:[1,0]
    v_pk_mul_f32 v[134:135], v[134:135], v[150:151] op_sel_hi:[1,0]
    v_pk_mul_f32 v[136:137], v[136:137], v[150:151] op_sel_hi:[1,0]
    v_pk_mul_f32 v[138:139], v[138:139], v[150:151] op_sel_hi:[1,0]
    v_pk_mul_f32 v[140:141], v[140:141], v[150:151] op_sel_hi:[1,0]
    v_pk_mul_f32 v[142:143], v[142:143], v[150:151] op_sel_hi:[1,0]
    v_cvt_pk_bf16_f32 v152, v128, v130
    v_cvt_pk_bf16_f32 v153, v132, v134
    v_cvt_pk_bf16_f32 v156, v129, v131
    v_cvt_pk_bf16_f32 v157, v133, v135
    v_cvt_pk_bf16_f32 v154, v136, v138
    v_cvt_pk_bf16_f32 v155, v140, v142
    v_cvt_pk_bf16_f32 v158, v137, v139
    v_cvt_pk_bf16_f32 v159, v141, v143
    ds_write_b128 v10, v[152:155] offset:0
    ds_write_b128 v10, v[156:159] offset:1024
    v_pk_fma_f32 v[128:129], v[136:137], v[144:145], v[128:129] op_sel_hi:[1,0,1] neg_lo:[0,0,1] neg_hi:[0,0,1]
    v_pk_fma_f32 v[130:131], v[138:139], v[144:145], v[130:131] op_sel_hi:[1,0,1] neg_lo:[0,0,1] neg_hi:[0,0,1]
    v_pk_fma_f32 v[132:133], v[140:141], v[144:145], v[132:133] op_sel_hi:[1,0,1] neg_lo:[0,0,1] neg_hi:[0,0,1]
    v_pk_fma_f32 v[134:135], v[142:143], v[144:145], v[134:135] op_sel_hi:[1,0,1] neg_lo:[0,0,1] neg_hi:[0,0,1]
    v_cvt_pk_bf16_f32 v152, v128, v130
    v_cvt_pk_bf16_f32 v153, v132, v134
    v_cvt_pk_bf16_f32 v156, v129, v131
    v_cvt_pk_bf16_f32 v157, v133, v135
    v_pk_fma_f32 v[136:137], v[128:129], v[144:145], v[136:137] op_sel_hi:[1,0,1] neg_lo:[0,0,1] neg_hi:[0,0,1]
    v_pk_fma_f32 v[138:139], v[130:131], v[144:145], v[138:139] op_sel_hi:[1,0,1] neg_lo:[0,0,1] neg_hi:[0,0,1]
    v_pk_fma_f32 v[140:141], v[132:133], v[144:145], v[140:141] op_sel_hi:[1,0,1] neg_lo:[0,0,1] neg_hi:[0,0,1]
    v_pk_fma_f32 v[142:143], v[134:135], v[144:145], v[142:143] op_sel_hi:[1,0,1] neg_lo:[0,0,1] neg_hi:[0,0,1]
    v_cvt_pk_bf16_f32 v154, v136, v138
    v_cvt_pk_bf16_f32 v155, v140, v142
    v_cvt_pk_bf16_f32 v158, v137, v139
    v_cvt_pk_bf16_f32 v159, v141, v143
    ds_write_b128 v10, v[152:155] offset:2048
    ds_write_b128 v10, v[156:159] offset:3072
    buffer_load_dwordx4 v6, s[16:19], s41 offen offset:0 lds
    v_pk_fma_f32 v[128:129], v[136:137], v[144:145], v[128:129] op_sel_hi:[1,0,1] neg_lo:[0,0,1] neg_hi:[0,0,1]
    v_pk_fma_f32 v[130:131], v[138:139], v[144:145], v[130:131] op_sel_hi:[1,0,1] neg_lo:[0,0,1] neg_hi:[0,0,1]
    v_pk_fma_f32 v[132:133], v[140:141], v[144:145], v[132:133] op_sel_hi:[1,0,1] neg_lo:[0,0,1] neg_hi:[0,0,1]
    v_pk_fma_f32 v[134:135], v[142:143], v[144:145], v[134:135] op_sel_hi:[1,0,1] neg_lo:[0,0,1] neg_hi:[0,0,1]
    v_cvt_pk_bf16_f32 v152, v128, v130
    v_cvt_pk_bf16_f32 v153, v132, v134
    v_cvt_pk_bf16_f32 v156, v129, v131
    v_cvt_pk_bf16_f32 v157, v133, v135
    v_pk_fma_f32 v[136:137], v[128:129], v[144:145], v[136:137] op_sel_hi:[1,0,1] neg_lo:[0,0,1] neg_hi:[0,0,1]
    v_pk_fma_f32 v[138:139], v[130:131], v[144:145], v[138:139] op_sel_hi:[1,0,1] neg_lo:[0,0,1] neg_hi:[0,0,1]
    v_pk_fma_f32 v[140:141], v[132:133], v[144:145], v[140:141] op_sel_hi:[1,0,1] neg_lo:[0,0,1] neg_hi:[0,0,1]
    v_pk_fma_f32 v[142:143], v[134:135], v[144:145], v[142:143] op_sel_hi:[1,0,1] neg_lo:[0,0,1] neg_hi:[0,0,1]
    v_cvt_pk_bf16_f32 v154, v136, v138
    v_cvt_pk_bf16_f32 v155, v140, v142
    v_cvt_pk_bf16_f32 v158, v137, v139
    v_cvt_pk_bf16_f32 v159, v141, v143
    ds_write_b128 v10, v[152:155] offset:4096
    ds_write_b128 v10, v[156:159] offset:5120
    buffer_load_dwordx4 v7, s[16:19], s41 offen offset:1024 lds
    v_pk_fma_f32 v[128:129], v[136:137], v[144:145], v[128:129] op_sel_hi:[1,0,1] neg_lo:[0,0,1] neg_hi:[0,0,1]
    v_pk_fma_f32 v[130:131], v[138:139], v[144:145], v[130:131] op_sel_hi:[1,0,1] neg_lo:[0,0,1] neg_hi:[0,0,1]
    v_pk_fma_f32 v[132:133], v[140:141], v[144:145], v[132:133] op_sel_hi:[1,0,1] neg_lo:[0,0,1] neg_hi:[0,0,1]
    v_pk_fma_f32 v[134:135], v[142:143], v[144:145], v[134:135] op_sel_hi:[1,0,1] neg_lo:[0,0,1] neg_hi:[0,0,1]
    v_cvt_pk_bf16_f32 v152, v128, v130
    v_cvt_pk_bf16_f32 v153, v132, v134
    v_cvt_pk_bf16_f32 v156, v129, v131
    v_cvt_pk_bf16_f32 v157, v133, v135
    v_pk_fma_f32 v[136:137], v[128:129], v[144:145], v[136:137] op_sel_hi:[1,0,1] neg_lo:[0,0,1] neg_hi:[0,0,1]
    v_pk_fma_f32 v[138:139], v[130:131], v[144:145], v[138:139] op_sel_hi:[1,0,1] neg_lo:[0,0,1] neg_hi:[0,0,1]
    v_pk_fma_f32 v[140:141], v[132:133], v[144:145], v[140:141] op_sel_hi:[1,0,1] neg_lo:[0,0,1] neg_hi:[0,0,1]
    v_pk_fma_f32 v[142:143], v[134:135], v[144:145], v[142:143] op_sel_hi:[1,0,1] neg_lo:[0,0,1] neg_hi:[0,0,1]
    v_cvt_pk_bf16_f32 v154, v136, v138
    v_cvt_pk_bf16_f32 v155, v140, v142
    v_cvt_pk_bf16_f32 v158, v137, v139
    v_cvt_pk_bf16_f32 v159, v141, v143
    ds_write_b128 v10, v[152:155] offset:6144
    ds_write_b128 v10, v[156:159] offset:7168
    buffer_load_dwordx4 v8, s[16:19], s41 offen offset:2048 lds
    v_pk_fma_f32 v[128:129], v[136:137], v[144:145], v[128:129] op_sel_hi:[1,0,1] neg_lo:[0,0,1] neg_hi:[0,0,1]
    v_pk_fma_f32 v[130:131], v[138:139], v[144:145], v[130:131] op_sel_hi:[1,0,1] neg_lo:[0,0,1] neg_hi:[0,0,1]
    v_pk_fma_f32 v[132:133], v[140:141], v[144:145], v[132:133] op_sel_hi:[1,0,1] neg_lo:[0,0,1] neg_hi:[0,0,1]
    v_pk_fma_f32 v[134:135], v[142:143], v[144:145], v[134:135] op_sel_hi:[1,0,1] neg_lo:[0,0,1] neg_hi:[0,0,1]
    v_cvt_pk_bf16_f32 v152, v128, v130
    v_cvt_pk_bf16_f32 v153, v132, v134
    v_cvt_pk_bf16_f32 v156, v129, v131
    v_cvt_pk_bf16_f32 v157, v133, v135
    v_pk_fma_f32 v[136:137], v[128:129], v[144:145], v[136:137] op_sel_hi:[1,0,1] neg_lo:[0,0,1] neg_hi:[0,0,1]
    v_pk_fma_f32 v[138:139], v[130:131], v[144:145], v[138:139] op_sel_hi:[1,0,1] neg_lo:[0,0,1] neg_hi:[0,0,1]
    v_pk_fma_f32 v[140:141], v[132:133], v[144:145], v[140:141] op_sel_hi:[1,0,1] neg_lo:[0,0,1] neg_hi:[0,0,1]
    v_pk_fma_f32 v[142:143], v[134:135], v[144:145], v[142:143] op_sel_hi:[1,0,1] neg_lo:[0,0,1] neg_hi:[0,0,1]
    v_cvt_pk_bf16_f32 v154, v136, v138
    v_cvt_pk_bf16_f32 v155, v140, v142
    v_cvt_pk_bf16_f32 v158, v137, v139
    v_cvt_pk_bf16_f32 v159, v141, v143
    ds_write_b128 v10, v[152:155] offset:8192
    ds_write_b128 v10, v[156:159] offset:9216
    buffer_load_dwordx4 v9, s[16:19], s41 offen offset:3072 lds
    s_add_u32 s41, s41, s48
    s_add_u32 m0, m0, 4096
    v_add_u32 v4, 30720, v3
    v_add_u32 v5, 112640, v3
    s_mov_b32 s54, 0x05040100
    s_mov_b32 s55, 0x07060302
    v_mov_b32 v15, 0
    s_waitcnt lgkmcnt(0)
    s_barrier
    ds_read_b128 a[0:3], v4 offset:0
    ds_read_b128 a[4:7], v4 offset:40960
    ds_read_b128 a[8:11], v5 offset:0
    ds_read_b128 a[12:15], v5 offset:40960
    ds_read_b128 a[16:19], v4 offset:1024
    ds_read_b128 a[20:23], v4 offset:41984
    ds_read_b128 a[24:27], v5 offset:1024
    ds_read_b128 a[28:31], v5 offset:41984
    buffer_load_dwordx4 v6, s[16:19], s41 offen offset:0 lds
    buffer_load_dwordx4 v7, s[16:19], s41 offen offset:1024 lds
    s_cmp_eq_u32 s7, 1
    s_cbranch_scc1 P0_w1
    v_and_b32 v11, 7, v1
    v_xor_b32 v10, v11, v2
    v_lshlrev_b32_e64 v10, 4, v10
    v_lshl_add_u32 v10, v11, 7, v10
    v_lshrrev_b32_e64 v11, 3, v1
    v_lshl_add_u32 v10, v11, 11, v10
    v_add_u32 v10, s14, v10
    v_xor_b32 v11, 64, v10
    s_cmp_eq_u32 s7, 2
    s_cbranch_scc1 P0_w2
    s_waitcnt lgkmcnt(7)
    s_waitcnt vmcnt(11)
    ds_read_b128 v[80:83], v10 offset:0
    ds_read_b128 v[84:87], v11 offset:0
    ds_read_b128 v[88:91], v10 offset:1024
    ds_read_b128 v[92:95], v11 offset:1024
    s_waitcnt lgkmcnt(2)
    s_nop 0
    v_perm_b32 v112, v81, v80, s54
    v_perm_b32 v113, v83, v82, s54
    v_perm_b32 v114, v85, v84, s54
    v_perm_b32 v115, v87, v86, s54
    v_perm_b32 v116, v81, v80, s55
    v_perm_b32 v117, v83, v82, s55
    v_perm_b32 v118, v85, v84, s55
    v_perm_b32 v119, v87, v86, s55
    v_mfma_f32_16x16x32_bf16 v[16:19], a[0:3], v[112:115], 0
    s_waitcnt vmcnt(6)
    ds_read_b128 v[96:99], v10 offset:4096
    ds_read_b128 v[100:103], v11 offset:4096
    v_mfma_f32_16x16x32_bf16 v[24:27], a[4:7], v[112:115], 0
    buffer_load_dwordx4 v8, s[16:19], s41 offen offset:2048 lds
    v_mfma_f32_16x16x32_bf16 v[32:35], a[8:11], v[112:115], 0
    s_waitcnt lgkmcnt(2)
    v_mfma_f32_16x16x32_bf16 v[40:43], a[12:15], v[112:115], 0
    v_perm_b32 v120, v89, v88, s54
    v_perm_b32 v121, v91, v90, s54
    ds_read_b128 a[32:35], v4 offset:2048
    ds_read_b128 a[36:39], v4 offset:43008
    v_mfma_f32_16x16x32_bf16 v[20:23], a[16:19], v[116:119], 0
    buffer_load_dwordx4 v9, s[16:19], s41 offen offset:3072 lds
    s_add_u32 s41, s41, s48
    s_add_u32 m0, m0, 4096
    v_perm_b32 v122, v93, v92, s54
    v_perm_b32 v123, v95, v94, s54
    ds_read_b128 a[40:43], v5 offset:2048
    ds_read_b128 a[44:47], v5 offset:43008
    v_mfma_f32_16x16x32_bf16 v[28:31], a[20:23], v[116:119], 0
    v_perm_b32 v124, v89, v88, s55
    v_perm_b32 v125, v91, v90, s55
    ds_read_b128 a[48:51], v4 offset:3072
    ds_read_b128 a[52:55], v4 offset:44032
    v_mfma_f32_16x16x32_bf16 v[36:39], a[24:27], v[116:119], 0
    v_perm_b32 v126, v93, v92, s55
    v_perm_b32 v127, v95, v94, s55
    ds_read_b128 a[56:59], v5 offset:3072
    ds_read_b128 a[60:63], v5 offset:44032
    v_mfma_f32_16x16x32_bf16 v[44:47], a[28:31], v[116:119], 0
    buffer_load_dwordx4 v6, s[16:19], s41 offen offset:0 lds
    v_mfma_f32_16x16x32_bf16 v[48:51], a[0:3], v[120:123], 0
    ds_read_b128 v[104:107], v10 offset:5120
    ds_read_b128 v[108:111], v11 offset:5120
    v_mfma_f32_16x16x32_bf16 v[56:59], a[4:7], v[120:123], 0
    buffer_load_dwordx4 v7, s[16:19], s41 offen offset:1024 lds
    v_mfma_f32_16x16x32_bf16 v[64:67], a[8:11], v[120:123], 0
    s_waitcnt lgkmcnt(2)
    v_mfma_f32_16x16x32_bf16 v[72:75], a[12:15], v[120:123], 0
    v_perm_b32 v112, v97, v96, s54
    v_perm_b32 v113, v99, v98, s54
    ds_read_b128 a[64:67], v4 offset:4096
    ds_read_b128 a[68:71], v4 offset:45056
    v_mfma_f32_16x16x32_bf16 v[52:55], a[16:19], v[124:127], 0
    buffer_load_dwordx4 v8, s[16:19], s41 offen offset:2048 lds
    v_perm_b32 v114, v101, v100, s54
    v_perm_b32 v115, v103, v102, s54
    ds_read_b128 a[72:75], v5 offset:4096
    ds_read_b128 a[76:79], v5 offset:45056
    v_mfma_f32_16x16x32_bf16 v[60:63], a[20:23], v[124:127], 0
    v_perm_b32 v116, v97, v96, s55
    v_perm_b32 v117, v99, v98, s55
    ds_read_b128 a[80:83], v4 offset:5120
    ds_read_b128 a[84:87], v4 offset:46080
    v_mfma_f32_16x16x32_bf16 v[68:71], a[24:27], v[124:127], 0
    v_perm_b32 v118, v101, v100, s55
    v_perm_b32 v119, v103, v102, s55
    ds_read_b128 a[88:91], v5 offset:5120
    ds_read_b128 a[92:95], v5 offset:46080
    v_mfma_f32_16x16x32_bf16 v[76:79], a[28:31], v[124:127], 0
    buffer_load_dwordx4 v9, s[16:19], s41 offen offset:3072 lds
    s_add_u32 s41, s41, s48
    s_add_u32 m0, m0, 4096
    v_mfma_f32_16x16x32_bf16 v[16:19], a[32:35], v[112:115], v[16:19]
    s_waitcnt vmcnt(8)
    ds_read_b128 v[80:83], v10 offset:8192
    ds_read_b128 v[84:87], v11 offset:8192
    v_mfma_f32_16x16x32_bf16 v[24:27], a[36:39], v[112:115], v[24:27]
    buffer_load_dwordx4 v6, s[16:19], s41 offen offset:0 lds
    v_mfma_f32_16x16x32_bf16 v[32:35], a[40:43], v[112:115], v[32:35]
    s_waitcnt lgkmcnt(2)
    s_nop 0
    v_mfma_f32_16x16x32_bf16 v[40:43], a[44:47], v[112:115], v[40:43]
    v_perm_b32 v120, v105, v104, s54
    v_perm_b32 v121, v107, v106, s54
    ds_read_b128 a[96:99], v4 offset:6144
    ds_read_b128 a[100:103], v4 offset:47104
    v_mfma_f32_16x16x32_bf16 v[20:23], a[48:51], v[116:119], v[20:23]
    buffer_load_dwordx4 v7, s[16:19], s41 offen offset:1024 lds
    v_perm_b32 v122, v109, v108, s54
    v_perm_b32 v123, v111, v110, s54
    ds_read_b128 a[104:107], v5 offset:6144
    ds_read_b128 a[108:111], v5 offset:47104
    v_mfma_f32_16x16x32_bf16 v[28:31], a[52:55], v[116:119], v[28:31]
    v_perm_b32 v124, v105, v104, s55
    v_perm_b32 v125, v107, v106, s55
    ds_read_b128 a[112:115], v4 offset:7168
    ds_read_b128 a[116:119], v4 offset:48128
    v_mfma_f32_16x16x32_bf16 v[36:39], a[56:59], v[116:119], v[36:39]
    v_perm_b32 v126, v109, v108, s55
    v_perm_b32 v127, v111, v110, s55
    ds_read_b128 a[120:123], v5 offset:7168
    ds_read_b128 a[124:127], v5 offset:48128
    v_mfma_f32_16x16x32_bf16 v[44:47], a[60:63], v[116:119], v[44:47]
    buffer_load_dwordx4 v8, s[16:19], s41 offen offset:2048 lds
    v_mfma_f32_16x16x32_bf16 v[48:51], a[32:35], v[120:123], v[48:51]
    ds_read_b128 v[88:91], v10 offset:9216
    ds_read_b128 v[92:95], v11 offset:9216
    v_mfma_f32_16x16x32_bf16 v[56:59], a[36:39], v[120:123], v[56:59]
    buffer_load_dwordx4 v9, s[16:19], s41 offen offset:3072 lds
    s_add_u32 s41, s41, s48
    s_add_u32 m0, m0, 4096
    v_mfma_f32_16x16x32_bf16 v[64:67], a[40:43], v[120:123], v[64:67]
    s_waitcnt lgkmcnt(2)
    v_mfma_f32_16x16x32_bf16 v[72:75], a[44:47], v[120:123], v[72:75]
    v_perm_b32 v112, v81, v80, s54
    v_perm_b32 v113, v83, v82, s54
    ds_read_b128 a[128:131], v4 offset:8192
    ds_read_b128 a[132:135], v4 offset:49152
    v_mfma_f32_16x16x32_bf16 v[52:55], a[48:51], v[124:127], v[52:55]
    buffer_load_dwordx4 v6, s[16:19], s41 offen offset:0 lds
    v_perm_b32 v114, v85, v84, s54
    v_perm_b32 v115, v87, v86, s54
    ds_read_b128 a[136:139], v5 offset:8192
    ds_read_b128 a[140:143], v5 offset:49152
    v_mfma_f32_16x16x32_bf16 v[60:63], a[52:55], v[124:127], v[60:63]
    v_perm_b32 v116, v81, v80, s55
    v_perm_b32 v117, v83, v82, s55
    ds_read_b128 a[144:147], v4 offset:9216
    ds_read_b128 a[148:151], v4 offset:50176
    v_mfma_f32_16x16x32_bf16 v[68:71], a[56:59], v[124:127], v[68:71]
    v_perm_b32 v118, v85, v84, s55
    v_perm_b32 v119, v87, v86, s55
    ds_read_b128 a[152:155], v5 offset:9216
    ds_read_b128 a[156:159], v5 offset:50176
    v_mfma_f32_16x16x32_bf16 v[76:79], a[60:63], v[124:127], v[76:79]
    buffer_load_dwordx4 v7, s[16:19], s41 offen offset:1024 lds
    v_mfma_f32_16x16x32_bf16 v[16:19], a[64:67], v[112:115], v[16:19]
    s_waitcnt vmcnt(10)
    ds_read_b128 v[96:99], v10 offset:12288
    ds_read_b128 v[100:103], v11 offset:12288
    v_mfma_f32_16x16x32_bf16 v[24:27], a[68:71], v[112:115], v[24:27]
    buffer_load_dwordx4 v8, s[16:19], s41 offen offset:2048 lds
    v_mfma_f32_16x16x32_bf16 v[32:35], a[72:75], v[112:115], v[32:35]
    s_waitcnt lgkmcnt(2)
    s_barrier
    v_mfma_f32_16x16x32_bf16 v[40:43], a[76:79], v[112:115], v[40:43]
    v_perm_b32 v120, v89, v88, s54
    v_perm_b32 v121, v91, v90, s54
    v_mfma_f32_16x16x32_bf16 v[20:23], a[80:83], v[116:119], v[20:23]
    buffer_load_dwordx4 v9, s[16:19], s41 offen offset:3072 lds
    s_add_u32 s41, s41, s48
    s_add_u32 m0, m0, 4096
    v_perm_b32 v122, v93, v92, s54
    v_perm_b32 v123, v95, v94, s54
    v_mfma_f32_16x16x32_bf16 v[28:31], a[84:87], v[116:119], v[28:31]
    v_perm_b32 v124, v89, v88, s55
    v_perm_b32 v125, v91, v90, s55
    v_mfma_f32_16x16x32_bf16 v[36:39], a[88:91], v[116:119], v[36:39]
    v_perm_b32 v126, v93, v92, s55
    v_perm_b32 v127, v95, v94, s55
    v_mfma_f32_16x16x32_bf16 v[44:47], a[92:95], v[116:119], v[44:47]
    buffer_load_dwordx4 v6, s[16:19], s41 offen offset:0 lds
    v_mfma_f32_16x16x32_bf16 v[48:51], a[64:67], v[120:123], v[48:51]
    ds_read_b128 v[104:107], v10 offset:13312
    ds_read_b128 v[108:111], v11 offset:13312
    v_mfma_f32_16x16x32_bf16 v[56:59], a[68:71], v[120:123], v[56:59]
    buffer_load_dwordx4 v7, s[16:19], s41 offen offset:1024 lds
    v_mfma_f32_16x16x32_bf16 v[64:67], a[72:75], v[120:123], v[64:67]
    s_waitcnt lgkmcnt(2)
    v_mfma_f32_16x16x32_bf16 v[72:75], a[76:79], v[120:123], v[72:75]
    v_perm_b32 v112, v97, v96, s54
    v_perm_b32 v113, v99, v98, s54
    v_mfma_f32_16x16x32_bf16 v[52:55], a[80:83], v[124:127], v[52:55]
    buffer_load_dwordx4 v8, s[16:19], s41 offen offset:2048 lds
    v_perm_b32 v114, v101, v100, s54
    v_perm_b32 v115, v103, v102, s54
    v_mfma_f32_16x16x32_bf16 v[60:63], a[84:87], v[124:127], v[60:63]
    v_perm_b32 v116, v97, v96, s55
    v_perm_b32 v117, v99, v98, s55
    v_mfma_f32_16x16x32_bf16 v[68:71], a[88:91], v[124:127], v[68:71]
    v_perm_b32 v118, v101, v100, s55
    v_perm_b32 v119, v103, v102, s55
    v_mfma_f32_16x16x32_bf16 v[76:79], a[92:95], v[124:127], v[76:79]
    buffer_load_dwordx4 v9, s[16:19], s41 offen offset:3072 lds
    s_add_u32 s41, s41, s48
    s_add_u32 m0, m0, 4096
    v_mfma_f32_16x16x32_bf16 v[16:19], a[96:99], v[112:115], v[16:19]
    s_waitcnt vmcnt(12)
    ds_read_b128 v[80:83], v10 offset:16384
    ds_read_b128 v[84:87], v11 offset:16384
    v_mfma_f32_16x16x32_bf16 v[24:27], a[100:103], v[112:115], v[24:27]
    buffer_load_dwordx4 v6, s[16:19], s41 offen offset:0 lds
    v_mfma_f32_16x16x32_bf16 v[32:35], a[104:107], v[112:115], v[32:35]
    s_waitcnt lgkmcnt(2)
    v_mfma_f32_16x16x32_bf16 v[40:43], a[108:111], v[112:115], v[40:43]
    v_perm_b32 v120, v105, v104, s54
    v_perm_b32 v121, v107, v106, s54
    v_mfma_f32_16x16x32_bf16 v[20:23], a[112:115], v[116:119], v[20:23]
    buffer_load_dwordx4 v7, s[16:19], s41 offen offset:1024 lds
    v_perm_b32 v122, v109, v108, s54
    v_perm_b32 v123, v111, v110, s54
    v_mfma_f32_16x16x32_bf16 v[28:31], a[116:119], v[116:119], v[28:31]
    v_perm_b32 v124, v105, v104, s55
    v_perm_b32 v125, v107, v106, s55
    v_mfma_f32_16x16x32_bf16 v[36:39], a[120:123], v[116:119], v[36:39]
    v_perm_b32 v126, v109, v108, s55
    v_perm_b32 v127, v111, v110, s55
    v_mfma_f32_16x16x32_bf16 v[44:47], a[124:127], v[116:119], v[44:47]
    buffer_load_dwordx4 v8, s[16:19], s41 offen offset:2048 lds
    v_mfma_f32_16x16x32_bf16 v[48:51], a[96:99], v[120:123], v[48:51]
    ds_read_b128 v[88:91], v10 offset:17408
    ds_read_b128 v[92:95], v11 offset:17408
    v_mfma_f32_16x16x32_bf16 v[56:59], a[100:103], v[120:123], v[56:59]
    buffer_load_dwordx4 v9, s[16:19], s41 offen offset:3072 lds
    s_add_u32 s41, s41, s48
    s_add_u32 m0, m0, 4096
    v_mfma_f32_16x16x32_bf16 v[64:67], a[104:107], v[120:123], v[64:67]
    s_waitcnt lgkmcnt(2)
    v_mfma_f32_16x16x32_bf16 v[72:75], a[108:111], v[120:123], v[72:75]
    v_perm_b32 v112, v81, v80, s54
    v_perm_b32 v113, v83, v82, s54
    v_mfma_f32_16x16x32_bf16 v[52:55], a[112:115], v[124:127], v[52:55]
    buffer_load_dwordx4 v6, s[16:19], s41 offen offset:0 lds
    v_perm_b32 v114, v85, v84, s54
    v_perm_b32 v115, v87, v86, s54
    v_mfma_f32_16x16x32_bf16 v[60:63], a[116:119], v[124:127], v[60:63]
    v_perm_b32 v116, v81, v80, s55
    v_perm_b32 v117, v83, v82, s55
    v_mfma_f32_16x16x32_bf16 v[68:71], a[120:123], v[124:127], v[68:71]
    v_perm_b32 v118, v85, v84, s55
    v_perm_b32 v119, v87, v86, s55
    v_mfma_f32_16x16x32_bf16 v[76:79], a[124:127], v[124:127], v[76:79]
    buffer_load_dwordx4 v7, s[16:19], s41 offen offset:1024 lds
    v_mfma_f32_16x16x32_bf16 v[16:19], a[128:131], v[112:115], v[16:19]
    s_waitcnt vmcnt(14)
    ds_read_b128 v[96:99], v10 offset:20480
    ds_read_b128 v[100:103], v11 offset:20480
    v_mfma_f32_16x16x32_bf16 v[24:27], a[132:135], v[112:115], v[24:27]
    buffer_load_dwordx4 v8, s[16:19], s41 offen offset:2048 lds
    v_mfma_f32_16x16x32_bf16 v[32:35], a[136:139], v[112:115], v[32:35]
    s_waitcnt lgkmcnt(2)
    v_mfma_f32_16x16x32_bf16 v[40:43], a[140:143], v[112:115], v[40:43]
    v_perm_b32 v120, v89, v88, s54
    v_perm_b32 v121, v91, v90, s54
    v_mfma_f32_16x16x32_bf16 v[20:23], a[144:147], v[116:119], v[20:23]
    buffer_load_dwordx4 v9, s[16:19], s41 offen offset:3072 lds
    s_add_u32 s41, s41, s48
    s_add_u32 m0, m0, 4096
    buffer_load_dword v14, v15, s[36:39], 0 offen sc1
    v_perm_b32 v122, v93, v92, s54
    v_perm_b32 v123, v95, v94, s54
    v_mfma_f32_16x16x32_bf16 v[28:31], a[148:151], v[116:119], v[28:31]
    v_perm_b32 v124, v89, v88, s55
    v_perm_b32 v125, v91, v90, s55
    v_mfma_f32_16x16x32_bf16 v[36:39], a[152:155], v[116:119], v[36:39]
    v_perm_b32 v126, v93, v92, s55
    v_perm_b32 v127, v95, v94, s55
    v_mfma_f32_16x16x32_bf16 v[44:47], a[156:159], v[116:119], v[44:47]
    v_mfma_f32_16x16x32_bf16 v[48:51], a[128:131], v[120:123], v[48:51]
    ds_read_b128 v[104:107], v10 offset:21504
    ds_read_b128 v[108:111], v11 offset:21504
    v_mfma_f32_16x16x32_bf16 v[56:59], a[132:135], v[120:123], v[56:59]
    v_mfma_f32_16x16x32_bf16 v[64:67], a[136:139], v[120:123], v[64:67]
    s_waitcnt lgkmcnt(2)
    v_mfma_f32_16x16x32_bf16 v[72:75], a[140:143], v[120:123], v[72:75]
    v_perm_b32 v112, v97, v96, s54
    v_perm_b32 v113, v99, v98, s54
    v_mfma_f32_16x16x32_bf16 v[52:55], a[144:147], v[124:127], v[52:55]
    v_perm_b32 v114, v101, v100, s54
    v_perm_b32 v115, v103, v102, s54
    v_mfma_f32_16x16x32_bf16 v[60:63], a[148:151], v[124:127], v[60:63]
    v_perm_b32 v116, v97, v96, s55
    v_perm_b32 v117, v99, v98, s55
    v_mfma_f32_16x16x32_bf16 v[68:71], a[152:155], v[124:127], v[68:71]
    v_perm_b32 v118, v101, v100, s55
    v_perm_b32 v119, v103, v102, s55
    v_mfma_f32_16x16x32_bf16 v[76:79], a[156:159], v[124:127], v[76:79]
    v_pk_mul_f32 v[18:19], v[18:19], -1.0 op_sel_hi:[1,0]
    v_pk_mul_f32 v[22:23], v[22:23], -1.0 op_sel_hi:[1,0]
    v_pk_mul_f32 v[26:27], v[26:27], -1.0 op_sel_hi:[1,0]
    v_pk_mul_f32 v[30:31], v[30:31], -1.0 op_sel_hi:[1,0]
    v_pk_mul_f32 v[34:35], v[34:35], -1.0 op_sel_hi:[1,0]
    v_pk_mul_f32 v[38:39], v[38:39], -1.0 op_sel_hi:[1,0]
    v_pk_mul_f32 v[42:43], v[42:43], -1.0 op_sel_hi:[1,0]
    v_pk_mul_f32 v[46:47], v[46:47], -1.0 op_sel_hi:[1,0]
    v_pk_mul_f32 v[50:51], v[50:51], -1.0 op_sel_hi:[1,0]
    v_pk_mul_f32 v[54:55], v[54:55], -1.0 op_sel_hi:[1,0]
    v_pk_mul_f32 v[58:59], v[58:59], -1.0 op_sel_hi:[1,0]
    v_pk_mul_f32 v[62:63], v[62:63], -1.0 op_sel_hi:[1,0]
    v_pk_mul_f32 v[66:67], v[66:67], -1.0 op_sel_hi:[1,0]
    v_pk_mul_f32 v[70:71], v[70:71], -1.0 op_sel_hi:[1,0]
    v_pk_mul_f32 v[74:75], v[74:75], -1.0 op_sel_hi:[1,0]
    v_pk_mul_f32 v[78:79], v[78:79], -1.0 op_sel_hi:[1,0]
    v_mfma_f32_16x16x32_bf16 v[16:19], a[0:3], v[112:115], v[16:19]
    s_waitcnt vmcnt(13)
    ds_read_b128 v[80:83], v10 offset:24576
    ds_read_b128 v[84:87], v11 offset:24576
    v_mfma_f32_16x16x32_bf16 v[24:27], a[4:7], v[112:115], v[24:27]
    v_mfma_f32_16x16x32_bf16 v[32:35], a[8:11], v[112:115], v[32:35]
    s_waitcnt lgkmcnt(2)
    v_mfma_f32_16x16x32_bf16 v[40:43], a[12:15], v[112:115], v[40:43]
    v_perm_b32 v120, v105, v104, s54
    v_perm_b32 v121, v107, v106, s54
    v_mfma_f32_16x16x32_bf16 v[20:23], a[16:19], v[116:119], v[20:23]
    v_perm_b32 v122, v109, v108, s54
    v_perm_b32 v123, v111, v110, s54
    v_mfma_f32_16x16x32_bf16 v[28:31], a[20:23], v[116:119], v[28:31]
    v_perm_b32 v124, v105, v104, s55
    v_perm_b32 v125, v107, v106, s55
    v_mfma_f32_16x16x32_bf16 v[36:39], a[24:27], v[116:119], v[36:39]
    v_perm_b32 v126, v109, v108, s55
    v_perm_b32 v127, v111, v110, s55
    v_mfma_f32_16x16x32_bf16 v[44:47], a[28:31], v[116:119], v[44:47]
    v_mfma_f32_16x16x32_bf16 v[48:51], a[0:3], v[120:123], v[48:51]
    ds_read_b128 v[88:91], v10 offset:25600
    ds_read_b128 v[92:95], v11 offset:25600
    v_mfma_f32_16x16x32_bf16 v[56:59], a[4:7], v[120:123], v[56:59]
    v_mfma_f32_16x16x32_bf16 v[64:67], a[8:11], v[120:123], v[64:67]
    s_waitcnt lgkmcnt(2)
    v_mfma_f32_16x16x32_bf16 v[72:75], a[12:15], v[120:123], v[72:75]
    v_perm_b32 v112, v81, v80, s54
    v_perm_b32 v113, v83, v82, s54
    v_mfma_f32_16x16x32_bf16 v[52:55], a[16:19], v[124:127], v[52:55]
    v_perm_b32 v114, v85, v84, s54
    v_perm_b32 v115, v87, v86, s54
    v_mfma_f32_16x16x32_bf16 v[60:63], a[20:23], v[124:127], v[60:63]
    v_perm_b32 v116, v81, v80, s55
    v_perm_b32 v117, v83, v82, s55
    v_mfma_f32_16x16x32_bf16 v[68:71], a[24:27], v[124:127], v[68:71]
    v_perm_b32 v118, v85, v84, s55
    v_perm_b32 v119, v87, v86, s55
    v_mfma_f32_16x16x32_bf16 v[76:79], a[28:31], v[124:127], v[76:79]
    v_mfma_f32_16x16x32_bf16 v[16:19], a[32:35], v[112:115], v[16:19]
    s_waitcnt vmcnt(9)
    ds_read_b128 v[96:99], v10 offset:28672
    ds_read_b128 v[100:103], v11 offset:28672
    v_mfma_f32_16x16x32_bf16 v[24:27], a[36:39], v[112:115], v[24:27]
    v_mfma_f32_16x16x32_bf16 v[32:35], a[40:43], v[112:115], v[32:35]
    s_waitcnt lgkmcnt(2)
    v_mfma_f32_16x16x32_bf16 v[40:43], a[44:47], v[112:115], v[40:43]
    v_perm_b32 v120, v89, v88, s54
    v_perm_b32 v121, v91, v90, s54
    v_mfma_f32_16x16x32_bf16 v[20:23], a[48:51], v[116:119], v[20:23]
    v_perm_b32 v122, v93, v92, s54
    v_perm_b32 v123, v95, v94, s54
    v_mfma_f32_16x16x32_bf16 v[28:31], a[52:55], v[116:119], v[28:31]
    v_perm_b32 v124, v89, v88, s55
    v_perm_b32 v125, v91, v90, s55
    v_mfma_f32_16x16x32_bf16 v[36:39], a[56:59], v[116:119], v[36:39]
    v_perm_b32 v126, v93, v92, s55
    v_perm_b32 v127, v95, v94, s55
    v_mfma_f32_16x16x32_bf16 v[44:47], a[60:63], v[116:119], v[44:47]
    v_mfma_f32_16x16x32_bf16 v[48:51], a[32:35], v[120:123], v[48:51]
    ds_read_b128 v[104:107], v10 offset:29696
    ds_read_b128 v[108:111], v11 offset:29696
    v_mfma_f32_16x16x32_bf16 v[56:59], a[36:39], v[120:123], v[56:59]
    v_mfma_f32_16x16x32_bf16 v[64:67], a[40:43], v[120:123], v[64:67]
    s_waitcnt lgkmcnt(2)
    v_mfma_f32_16x16x32_bf16 v[72:75], a[44:47], v[120:123], v[72:75]
    v_perm_b32 v112, v97, v96, s54
    v_perm_b32 v113, v99, v98, s54
    v_mfma_f32_16x16x32_bf16 v[52:55], a[48:51], v[124:127], v[52:55]
    v_perm_b32 v114, v101, v100, s54
    v_perm_b32 v115, v103, v102, s54
    v_mfma_f32_16x16x32_bf16 v[60:63], a[52:55], v[124:127], v[60:63]
    v_perm_b32 v116, v97, v96, s55
    v_perm_b32 v117, v99, v98, s55
    v_mfma_f32_16x16x32_bf16 v[68:71], a[56:59], v[124:127], v[68:71]
    v_perm_b32 v118, v101, v100, s55
    v_perm_b32 v119, v103, v102, s55
    v_mfma_f32_16x16x32_bf16 v[76:79], a[60:63], v[124:127], v[76:79]
    v_mfma_f32_16x16x32_bf16 v[16:19], a[64:67], v[112:115], v[16:19]
    s_waitcnt vmcnt(5)
    ds_read_b128 v[80:83], v10 offset:32768
    ds_read_b128 v[84:87], v11 offset:32768
    v_mfma_f32_16x16x32_bf16 v[24:27], a[68:71], v[112:115], v[24:27]
    v_mfma_f32_16x16x32_bf16 v[32:35], a[72:75], v[112:115], v[32:35]
    s_waitcnt lgkmcnt(2)
    v_mfma_f32_16x16x32_bf16 v[40:43], a[76:79], v[112:115], v[40:43]
    v_perm_b32 v120, v105, v104, s54
    v_perm_b32 v121, v107, v106, s54
    v_mfma_f32_16x16x32_bf16 v[20:23], a[80:83], v[116:119], v[20:23]
    v_perm_b32 v122, v109, v108, s54
    v_perm_b32 v123, v111, v110, s54
    v_mfma_f32_16x16x32_bf16 v[28:31], a[84:87], v[116:119], v[28:31]
    v_perm_b32 v124, v105, v104, s55
    v_perm_b32 v125, v107, v106, s55
    v_mfma_f32_16x16x32_bf16 v[36:39], a[88:91], v[116:119], v[36:39]
    v_perm_b32 v126, v109, v108, s55
    v_perm_b32 v127, v111, v110, s55
    v_mfma_f32_16x16x32_bf16 v[44:47], a[92:95], v[116:119], v[44:47]
    v_mfma_f32_16x16x32_bf16 v[48:51], a[64:67], v[120:123], v[48:51]
    ds_read_b128 v[88:91], v10 offset:33792
    ds_read_b128 v[92:95], v11 offset:33792
    v_mfma_f32_16x16x32_bf16 v[56:59], a[68:71], v[120:123], v[56:59]
    v_mfma_f32_16x16x32_bf16 v[64:67], a[72:75], v[120:123], v[64:67]
    s_waitcnt lgkmcnt(2)
    v_mfma_f32_16x16x32_bf16 v[72:75], a[76:79], v[120:123], v[72:75]
    v_perm_b32 v112, v81, v80, s54
    v_perm_b32 v113, v83, v82, s54
    v_mfma_f32_16x16x32_bf16 v[52:55], a[80:83], v[124:127], v[52:55]
    v_perm_b32 v114, v85, v84, s54
    v_perm_b32 v115, v87, v86, s54
    v_mfma_f32_16x16x32_bf16 v[60:63], a[84:87], v[124:127], v[60:63]
    v_perm_b32 v116, v81, v80, s55
    v_perm_b32 v117, v83, v82, s55
    v_mfma_f32_16x16x32_bf16 v[68:71], a[88:91], v[124:127], v[68:71]
    v_perm_b32 v118, v85, v84, s55
    v_perm_b32 v119, v87, v86, s55
    v_mfma_f32_16x16x32_bf16 v[76:79], a[92:95], v[124:127], v[76:79]
    v_mfma_f32_16x16x32_bf16 v[16:19], a[96:99], v[112:115], v[16:19]
    s_waitcnt vmcnt(1)
    ds_read_b128 v[96:99], v10 offset:36864
    ds_read_b128 v[100:103], v11 offset:36864
    v_mfma_f32_16x16x32_bf16 v[24:27], a[100:103], v[112:115], v[24:27]
    v_mfma_f32_16x16x32_bf16 v[32:35], a[104:107], v[112:115], v[32:35]
    s_waitcnt lgkmcnt(2)
    v_mfma_f32_16x16x32_bf16 v[40:43], a[108:111], v[112:115], v[40:43]
    v_perm_b32 v120, v89, v88, s54
    v_perm_b32 v121, v91, v90, s54
    v_mfma_f32_16x16x32_bf16 v[20:23], a[112:115], v[116:119], v[20:23]
    v_perm_b32 v122, v93, v92, s54
    v_perm_b32 v123, v95, v94, s54
    v_mfma_f32_16x16x32_bf16 v[28:31], a[116:119], v[116:119], v[28:31]
    v_perm_b32 v124, v89, v88, s55
    v_perm_b32 v125, v91, v90, s55
    v_mfma_f32_16x16x32_bf16 v[36:39], a[120:123], v[116:119], v[36:39]
    v_perm_b32 v126, v93, v92, s55
    v_perm_b32 v127, v95, v94, s55
    v_mfma_f32_16x16x32_bf16 v[44:47], a[124:127], v[116:119], v[44:47]
    v_mfma_f32_16x16x32_bf16 v[48:51], a[96:99], v[120:123], v[48:51]
    ds_read_b128 v[104:107], v10 offset:37888
    ds_read_b128 v[108:111], v11 offset:37888
    v_mfma_f32_16x16x32_bf16 v[56:59], a[100:103], v[120:123], v[56:59]
    v_mfma_f32_16x16x32_bf16 v[64:67], a[104:107], v[120:123], v[64:67]
    s_waitcnt lgkmcnt(2)
    v_mfma_f32_16x16x32_bf16 v[72:75], a[108:111], v[120:123], v[72:75]
    v_perm_b32 v112, v97, v96, s54
    v_perm_b32 v113, v99, v98, s54
    v_mfma_f32_16x16x32_bf16 v[52:55], a[112:115], v[124:127], v[52:55]
    v_perm_b32 v114, v101, v100, s54
    v_perm_b32 v115, v103, v102, s54
    v_mfma_f32_16x16x32_bf16 v[60:63], a[116:119], v[124:127], v[60:63]
    v_perm_b32 v116, v97, v96, s55
    v_perm_b32 v117, v99, v98, s55
    v_mfma_f32_16x16x32_bf16 v[68:71], a[120:123], v[124:127], v[68:71]
    v_perm_b32 v118, v101, v100, s55
    v_perm_b32 v119, v103, v102, s55
    v_mfma_f32_16x16x32_bf16 v[76:79], a[124:127], v[124:127], v[76:79]
    v_mfma_f32_16x16x32_bf16 v[16:19], a[128:131], v[112:115], v[16:19]
    v_mfma_f32_16x16x32_bf16 v[24:27], a[132:135], v[112:115], v[24:27]
    v_mfma_f32_16x16x32_bf16 v[32:35], a[136:139], v[112:115], v[32:35]
    s_waitcnt lgkmcnt(0)
    v_mfma_f32_16x16x32_bf16 v[40:43], a[140:143], v[112:115], v[40:43]
    v_perm_b32 v120, v105, v104, s54
    v_perm_b32 v121, v107, v106, s54
    v_mfma_f32_16x16x32_bf16 v[20:23], a[144:147], v[116:119], v[20:23]
    v_perm_b32 v122, v109, v108, s54
    v_perm_b32 v123, v111, v110, s54
    v_mfma_f32_16x16x32_bf16 v[28:31], a[148:151], v[116:119], v[28:31]
    v_perm_b32 v124, v105, v104, s55
    v_perm_b32 v125, v107, v106, s55
    v_mfma_f32_16x16x32_bf16 v[36:39], a[152:155], v[116:119], v[36:39]
    v_perm_b32 v126, v109, v108, s55
    v_perm_b32 v127, v111, v110, s55
    v_mfma_f32_16x16x32_bf16 v[44:47], a[156:159], v[116:119], v[44:47]
    v_mfma_f32_16x16x32_bf16 v[48:51], a[128:131], v[120:123], v[48:51]
    v_mfma_f32_16x16x32_bf16 v[56:59], a[132:135], v[120:123], v[56:59]
    v_mfma_f32_16x16x32_bf16 v[64:67], a[136:139], v[120:123], v[64:67]
    v_mfma_f32_16x16x32_bf16 v[72:75], a[140:143], v[120:123], v[72:75]
    v_mfma_f32_16x16x32_bf16 v[52:55], a[144:147], v[124:127], v[52:55]
    v_mfma_f32_16x16x32_bf16 v[60:63], a[148:151], v[124:127], v[60:63]
    v_mfma_f32_16x16x32_bf16 v[68:71], a[152:155], v[124:127], v[68:71]
    v_mfma_f32_16x16x32_bf16 v[76:79], a[156:159], v[124:127], v[76:79]
    s_waitcnt vmcnt(0)
    v_cmp_gt_u32 vcc, 7, v14
    s_nop 1
    s_cbranch_vccnz P0_spin1
P0_rdy1:
    v_or_b32 v12, s44, v2
    v_cmp_eq_u32 vcc, 0, v12
    s_lshl_b32 s12, s44, 12
    s_lshl_b32 s13, s5, 8
    s_add_u32 s12, s12, s13
    s_add_u32 s48, s12, 0
    s_add_u32 s49, s48, 1310720
    s_add_u32 s13, s13, 32440320
    v_lshlrev_b32 v8, 14, v2
    v_lshl_add_u32 v8, v1, 4, v8
    v_lshlrev_b32 v9, 3, v0
    s_mov_b32 s47, 1
    s_cmp_eq_u32 s7, 3
    s_cbranch_scc1 P0_b2
    v_pk_add_f32 v[128:129], v[16:17], v[20:21]
    v_pk_add_f32 v[130:131], v[18:19], v[22:23] neg_lo:[1,1] neg_hi:[1,1]
    v_pk_add_f32 v[132:133], v[16:17], v[20:21] neg_lo:[0,1] neg_hi:[1,0]
    v_pk_add_f32 v[134:135], v[18:19], v[22:23] neg_lo:[1,0] neg_hi:[0,1]
    v_cndmask_b32 v12, v128, v132, vcc
    v_cndmask_b32 v132, v132, v129, vcc
    v_cndmask_b32 v129, v129, v128, vcc
    v_mov_b32 v128, v12
    v_pk_add_f32 v[160:161], v[48:49], v[52:53]
    v_pk_add_f32 v[162:163], v[50:51], v[54:55] neg_lo:[1,1] neg_hi:[1,1]
    v_pk_add_f32 v[164:165], v[48:49], v[52:53] neg_lo:[0,1] neg_hi:[1,0]
    v_pk_add_f32 v[166:167], v[50:51], v[54:55] neg_lo:[1,0] neg_hi:[0,1]
    v_cndmask_b32 v12, v160, v164, vcc
    v_cndmask_b32 v164, v164, v161, vcc
    v_cndmask_b32 v161, v161, v160, vcc
    v_mov_b32 v160, v12
    v_cvt_pk_bf16_f32 v80, v128, v129
    v_cvt_pk_bf16_f32 v81, v130, v131
    v_cvt_pk_bf16_f32 v82, v160, v161
    v_cvt_pk_bf16_f32 v83, v162, v163
    buffer_store_dwordx4 v[80:83], v8, s[8:11], s48 offen sc1
    s_add_u32 s48, s48, 65536
    v_cvt_pk_bf16_f32 v84, v132, v133
    v_cvt_pk_bf16_f32 v85, v134, v135
    v_cvt_pk_bf16_f32 v86, v164, v165
    v_cvt_pk_bf16_f32 v87, v166, v167
    buffer_store_dwordx4 v[84:87], v8, s[8:11], s49 offen sc1
    s_add_u32 s49, s49, 65536
    v_pk_add_f32 v[136:137], v[24:25], v[28:29]
    v_pk_add_f32 v[138:139], v[26:27], v[30:31] neg_lo:[1,1] neg_hi:[1,1]
    v_pk_add_f32 v[140:141], v[24:25], v[28:29] neg_lo:[0,1] neg_hi:[1,0]
    v_pk_add_f32 v[142:143], v[26:27], v[30:31] neg_lo:[1,0] neg_hi:[0,1]
    v_pk_add_f32 v[168:169], v[56:57], v[60:61]
    v_pk_add_f32 v[170:171], v[58:59], v[62:63] neg_lo:[1,1] neg_hi:[1,1]
    v_pk_add_f32 v[172:173], v[56:57], v[60:61] neg_lo:[0,1] neg_hi:[1,0]
    v_pk_add_f32 v[174:175], v[58:59], v[62:63] neg_lo:[1,0] neg_hi:[0,1]
    v_cvt_pk_bf16_f32 v88, v136, v137
    v_cvt_pk_bf16_f32 v89, v138, v139
    v_cvt_pk_bf16_f32 v90, v168, v169
    v_cvt_pk_bf16_f32 v91, v170, v171
    buffer_store_dwordx4 v[88:91], v8, s[8:11], s48 offen sc1
    s_add_u32 s48, s48, 65536
    v_cvt_pk_bf16_f32 v92, v140, v141
    v_cvt_pk_bf16_f32 v93, v142, v143
    v_cvt_pk_bf16_f32 v94, v172, v173
    v_cvt_pk_bf16_f32 v95, v174, v175
    buffer_store_dwordx4 v[92:95], v8, s[8:11], s49 offen sc1
    s_add_u32 s49, s49, 65536
    v_pk_add_f32 v[144:145], v[32:33], v[36:37]
    v_pk_add_f32 v[146:147], v[34:35], v[38:39] neg_lo:[1,1] neg_hi:[1,1]
    v_pk_add_f32 v[148:149], v[32:33], v[36:37] neg_lo:[0,1] neg_hi:[1,0]
    v_pk_add_f32 v[150:151], v[34:35], v[38:39] neg_lo:[1,0] neg_hi:[0,1]
    v_pk_add_f32 v[176:177], v[64:65], v[68:69]
    v_pk_add_f32 v[178:179], v[66:67], v[70:71] neg_lo:[1,1] neg_hi:[1,1]
    v_pk_add_f32 v[180:181], v[64:65], v[68:69] neg_lo:[0,1] neg_hi:[1,0]
    v_pk_add_f32 v[182:183], v[66:67], v[70:71] neg_lo:[1,0] neg_hi:[0,1]
    v_cvt_pk_bf16_f32 v96, v144, v145
    v_cvt_pk_bf16_f32 v97, v146, v147
    v_cvt_pk_bf16_f32 v98, v176, v177
    v_cvt_pk_bf16_f32 v99, v178, v179
    buffer_store_dwordx4 v[96:99], v8, s[8:11], s48 offen sc1
    s_add_u32 s48, s48, 65536
    v_cvt_pk_bf16_f32 v100, v148, v149
    v_cvt_pk_bf16_f32 v101, v150, v151
    v_cvt_pk_bf16_f32 v102, v180, v181
    v_cvt_pk_bf16_f32 v103, v182, v183
    buffer_store_dwordx4 v[100:103], v8, s[8:11], s49 offen sc1
    s_add_u32 s49, s49, 65536
    v_pk_add_f32 v[152:153], v[40:41], v[44:45]
    v_pk_add_f32 v[154:155], v[42:43], v[46:47] neg_lo:[1,1] neg_hi:[1,1]
    v_pk_add_f32 v[156:157], v[40:41], v[44:45] neg_lo:[0,1] neg_hi:[1,0]
    v_pk_add_f32 v[158:159], v[42:43], v[46:47] neg_lo:[1,0] neg_hi:[0,1]
    v_pk_add_f32 v[184:185], v[72:73], v[76:77]
    v_pk_add_f32 v[186:187], v[74:75], v[78:79] neg_lo:[1,1] neg_hi:[1,1]
    v_pk_add_f32 v[188:189], v[72:73], v[76:77] neg_lo:[0,1] neg_hi:[1,0]
    v_pk_add_f32 v[190:191], v[74:75], v[78:79] neg_lo:[1,0] neg_hi:[0,1]
    v_cvt_pk_bf16_f32 v104, v152, v153
    v_cvt_pk_bf16_f32 v105, v154, v155
    v_cvt_pk_bf16_f32 v106, v184, v185
    v_cvt_pk_bf16_f32 v107, v186, v187
    buffer_store_dwordx4 v[104:107], v8, s[8:11], s48 offen sc1
    s_add_u32 s48, s48, 65536
    v_cvt_pk_bf16_f32 v108, v156, v157
    v_cvt_pk_bf16_f32 v109, v158, v159
    v_cvt_pk_bf16_f32 v110, v188, v189
    v_cvt_pk_bf16_f32 v111, v190, v191
    buffer_store_dwordx4 v[108:111], v8, s[8:11], s49 offen sc1
    s_add_u32 s49, s49, 65536
    v_cndmask_b32 v129, v129, 0, vcc
    v_pk_mul_f32 v[16:17], v[128:129], v[128:129]
    v_cndmask_b32 v161, v161, 0, vcc
    v_pk_mul_f32 v[18:19], v[160:161], v[160:161]
    v_pk_fma_f32 v[16:17], v[130:131], v[130:131], v[16:17]
    v_pk_fma_f32 v[18:19], v[162:163], v[162:163], v[18:19]
    v_pk_fma_f32 v[16:17], v[132:133], v[132:133], v[16:17]
    v_pk_fma_f32 v[18:19], v[164:165], v[164:165], v[18:19]
    v_pk_fma_f32 v[16:17], v[134:135], v[134:135], v[16:17]
    v_pk_fma_f32 v[18:19], v[166:167], v[166:167], v[18:19]
    v_pk_fma_f32 v[16:17], v[136:137], v[136:137], v[16:17]
    v_pk_fma_f32 v[18:19], v[168:169], v[168:169], v[18:19]
    v_pk_fma_f32 v[16:17], v[138:139], v[138:139], v[16:17]
    v_pk_fma_f32 v[18:19], v[170:171], v[170:171], v[18:19]
    v_pk_fma_f32 v[16:17], v[140:141], v[140:141], v[16:17]
    v_pk_fma_f32 v[18:19], v[172:173], v[172:173], v[18:19]
    v_pk_fma_f32 v[16:17], v[142:143], v[142:143], v[16:17]
    v_pk_fma_f32 v[18:19], v[174:175], v[174:175], v[18:19]
    v_pk_fma_f32 v[16:17], v[144:145], v[144:145], v[16:17]
    v_pk_fma_f32 v[18:19], v[176:177], v[176:177], v[18:19]
    v_pk_fma_f32 v[16:17], v[146:147], v[146:147], v[16:17]
    v_pk_fma_f32 v[18:19], v[178:179], v[178:179], v[18:19]
    v_pk_fma_f32 v[16:17], v[148:149], v[148:149], v[16:17]
    v_pk_fma_f32 v[18:19], v[180:181], v[180:181], v[18:19]
    v_pk_fma_f32 v[16:17], v[150:151], v[150:151], v[16:17]
    v_pk_fma_f32 v[18:19], v[182:183], v[182:183], v[18:19]
    v_pk_fma_f32 v[16:17], v[152:153], v[152:153], v[16:17]
    v_pk_fma_f32 v[18:19], v[184:185], v[184:185], v[18:19]
    v_pk_fma_f32 v[16:17], v[154:155], v[154:155], v[16:17]
    v_pk_fma_f32 v[18:19], v[186:187], v[186:187], v[18:19]
    v_pk_fma_f32 v[16:17], v[156:157], v[156:157], v[16:17]
    v_pk_fma_f32 v[18:19], v[188:189], v[188:189], v[18:19]
    v_pk_fma_f32 v[16:17], v[158:159], v[158:159], v[16:17]
    v_pk_fma_f32 v[18:19], v[190:191], v[190:191], v[18:19]
    v_add_f32 v16, v16, v17
    v_add_f32 v18, v18, v19
    s_nop 1
    v_permlane16_swap_b32 v16, v18
    v_add_f32 v16, v16, v18
    v_mov_b32 v18, v16
    s_nop 1
    v_permlane32_swap_b32 v16, v18
    v_add_f32 v16, v16, v18
    v_cvt_f64_f32 v[24:25], v16
    s_mov_b32 exec_hi, 0
    buffer_atomic_add_f64 v[24:25], v9, s[8:11], s13 offen
    s_mov_b32 exec_hi, -1
    s_branch P0_done
P0_b2:
    s_mov_b32 s47, 0
    s_cmp_lg_u32 s3, 0
    s_cbranch_scc1 P0_done
    v_pk_add_f32 v[128:129], v[16:17], v[20:21]
    v_pk_add_f32 v[130:131], v[18:19], v[22:23] neg_lo:[1,1] neg_hi:[1,1]
    v_pk_add_f32 v[132:133], v[16:17], v[20:21] neg_lo:[0,1] neg_hi:[1,0]
    v_pk_add_f32 v[134:135], v[18:19], v[22:23] neg_lo:[1,0] neg_hi:[0,1]
    v_cndmask_b32 v12, v128, v132, vcc
    v_cndmask_b32 v132, v132, v129, vcc
    v_cndmask_b32 v129, v129, v128, vcc
    v_mov_b32 v128, v12
    v_pk_add_f32 v[136:137], v[24:25], v[28:29]
    v_pk_add_f32 v[138:139], v[26:27], v[30:31] neg_lo:[1,1] neg_hi:[1,1]
    v_pk_add_f32 v[140:141], v[24:25], v[28:29] neg_lo:[0,1] neg_hi:[1,0]
    v_pk_add_f32 v[142:143], v[26:27], v[30:31] neg_lo:[1,0] neg_hi:[0,1]
    v_pk_add_f32 v[144:145], v[32:33], v[36:37]
    v_pk_add_f32 v[146:147], v[34:35], v[38:39] neg_lo:[1,1] neg_hi:[1,1]
    v_pk_add_f32 v[148:149], v[32:33], v[36:37] neg_lo:[0,1] neg_hi:[1,0]
    v_pk_add_f32 v[150:151], v[34:35], v[38:39] neg_lo:[1,0] neg_hi:[0,1]
    v_pk_add_f32 v[152:153], v[40:41], v[44:45]
    v_pk_add_f32 v[154:155], v[42:43], v[46:47] neg_lo:[1,1] neg_hi:[1,1]
    v_pk_add_f32 v[156:157], v[40:41], v[44:45] neg_lo:[0,1] neg_hi:[1,0]
    v_pk_add_f32 v[158:159], v[42:43], v[46:47] neg_lo:[1,0] neg_hi:[0,1]
    v_mov_b32_dpp v128, v128 row_shr:8 row_mask:0xf bank_mask:0xc
    v_mov_b32_dpp v129, v129 row_shr:8 row_mask:0xf bank_mask:0xc
    v_mov_b32_dpp v130, v130 row_shr:8 row_mask:0xf bank_mask:0xc
    v_mov_b32_dpp v131, v131 row_shr:8 row_mask:0xf bank_mask:0xc
    v_mov_b32_dpp v132, v132 row_shr:8 row_mask:0xf bank_mask:0xc
    v_mov_b32_dpp v133, v133 row_shr:8 row_mask:0xf bank_mask:0xc
    v_mov_b32_dpp v134, v134 row_shr:8 row_mask:0xf bank_mask:0xc
    v_mov_b32_dpp v135, v135 row_shr:8 row_mask:0xf bank_mask:0xc
    v_mov_b32_dpp v136, v136 row_shr:8 row_mask:0xf bank_mask:0xc
    v_mov_b32_dpp v137, v137 row_shr:8 row_mask:0xf bank_mask:0xc
    v_mov_b32_dpp v138, v138 row_shr:8 row_mask:0xf bank_mask:0xc
    v_mov_b32_dpp v139, v139 row_shr:8 row_mask:0xf bank_mask:0xc
    v_mov_b32_dpp v140, v140 row_shr:8 row_mask:0xf bank_mask:0xc
    v_mov_b32_dpp v141, v141 row_shr:8 row_mask:0xf bank_mask:0xc
    v_mov_b32_dpp v142, v142 row_shr:8 row_mask:0xf bank_mask:0xc
    v_mov_b32_dpp v143, v143 row_shr:8 row_mask:0xf bank_mask:0xc
    v_mov_b32_dpp v144, v144 row_shr:8 row_mask:0xf bank_mask:0xc
    v_mov_b32_dpp v145, v145 row_shr:8 row_mask:0xf bank_mask:0xc
    v_mov_b32_dpp v146, v146 row_shr:8 row_mask:0xf bank_mask:0xc
    v_mov_b32_dpp v147, v147 row_shr:8 row_mask:0xf bank_mask:0xc
    v_mov_b32_dpp v148, v148 row_shr:8 row_mask:0xf bank_mask:0xc
    v_mov_b32_dpp v149, v149 row_shr:8 row_mask:0xf bank_mask:0xc
    v_mov_b32_dpp v150, v150 row_shr:8 row_mask:0xf bank_mask:0xc
    v_mov_b32_dpp v151, v151 row_shr:8 row_mask:0xf bank_mask:0xc
    v_mov_b32_dpp v152, v152 row_shr:8 row_mask:0xf bank_mask:0xc
    v_mov_b32_dpp v153, v153 row_shr:8 row_mask:0xf bank_mask:0xc
    v_mov_b32_dpp v154, v154 row_shr:8 row_mask:0xf bank_mask:0xc
    v_mov_b32_dpp v155, v155 row_shr:8 row_mask:0xf bank_mask:0xc
    v_mov_b32_dpp v156, v156 row_shr:8 row_mask:0xf bank_mask:0xc
    v_mov_b32_dpp v157, v157 row_shr:8 row_mask:0xf bank_mask:0xc
    v_mov_b32_dpp v158, v158 row_shr:8 row_mask:0xf bank_mask:0xc
    v_mov_b32_dpp v159, v159 row_shr:8 row_mask:0xf bank_mask:0xc
    s_lshl_b32 s12, s44, 6
    s_nop 0
    s_add_u32 s12, s12, 32571392
    s_add_u32 s13, s12, 20480
    buffer_store_dwordx4 v[128:131], v3, s[8:11], s12 offen offset:0 sc1
    buffer_store_dwordx4 v[132:135], v3, s[8:11], s13 offen offset:0 sc1
    buffer_store_dwordx4 v[136:139], v3, s[8:11], s12 offen offset:1024 sc1
    buffer_store_dwordx4 v[140:143], v3, s[8:11], s13 offen offset:1024 sc1
    buffer_store_dwordx4 v[144:147], v3, s[8:11], s12 offen offset:2048 sc1
    buffer_store_dwordx4 v[148:151], v3, s[8:11], s13 offen offset:2048 sc1
    buffer_store_dwordx4 v[152:155], v3, s[8:11], s12 offen offset:3072 sc1
    buffer_store_dwordx4 v[156:159], v3, s[8:11], s13 offen offset:3072 sc1
    s_branch P0_done
P0_w2:
    v_and_b32 v12, 2, v1
    v_lshlrev_b32 v12, 30, v12
    v_xor_b32 v12, 1.0, v12
    s_waitcnt lgkmcnt(7)
    s_waitcnt vmcnt(11)
    ds_read_b128 v[80:83], v10 offset:0
    ds_read_b128 v[84:87], v11 offset:0
    ds_read_b128 v[88:91], v10 offset:1024
    ds_read_b128 v[92:95], v11 offset:1024
    s_waitcnt lgkmcnt(2)
    s_nop 0
    v_perm_b32 v112, v81, v80, s54
    v_perm_b32 v113, v83, v82, s54
    v_perm_b32 v114, v85, v84, s54
    v_perm_b32 v115, v87, v86, s54
    v_perm_b32 v116, v81, v80, s55
    v_perm_b32 v117, v83, v82, s55
    v_perm_b32 v118, v85, v84, s55
    v_perm_b32 v119, v87, v86, s55
    v_mfma_f32_16x16x32_bf16 v[16:19], v[112:115], a[0:3], 0
    s_waitcnt vmcnt(6)
    ds_read_b128 v[96:99], v10 offset:4096
    ds_read_b128 v[100:103], v11 offset:4096
    v_mfma_f32_16x16x32_bf16 v[24:27], v[112:115], a[4:7], 0
    buffer_load_dwordx4 v8, s[16:19], s41 offen offset:2048 lds
    v_mfma_f32_16x16x32_bf16 v[32:35], v[112:115], a[8:11], 0
    s_waitcnt lgkmcnt(2)
    v_mfma_f32_16x16x32_bf16 v[40:43], v[112:115], a[12:15], 0
    v_perm_b32 v120, v89, v88, s54
    v_perm_b32 v121, v91, v90, s54
    ds_read_b128 a[32:35], v4 offset:2048
    ds_read_b128 a[36:39], v4 offset:43008
    v_mfma_f32_16x16x32_bf16 v[20:23], v[116:119], a[16:19], 0
    buffer_load_dwordx4 v9, s[16:19], s41 offen offset:3072 lds
    s_add_u32 s41, s41, s48
    s_add_u32 m0, m0, 4096
    v_perm_b32 v122, v93, v92, s54
    v_perm_b32 v123, v95, v94, s54
    ds_read_b128 a[40:43], v5 offset:2048
    ds_read_b128 a[44:47], v5 offset:43008
    v_mfma_f32_16x16x32_bf16 v[28:31], v[116:119], a[20:23], 0
    v_perm_b32 v124, v89, v88, s55
    v_perm_b32 v125, v91, v90, s55
    ds_read_b128 a[48:51], v4 offset:3072
    ds_read_b128 a[52:55], v4 offset:44032
    v_mfma_f32_16x16x32_bf16 v[36:39], v[116:119], a[24:27], 0
    v_perm_b32 v126, v93, v92, s55
    v_perm_b32 v127, v95, v94, s55
    ds_read_b128 a[56:59], v5 offset:3072
    ds_read_b128 a[60:63], v5 offset:44032
    v_mfma_f32_16x16x32_bf16 v[44:47], v[116:119], a[28:31], 0
    buffer_load_dwordx4 v6, s[16:19], s41 offen offset:0 lds
    v_mfma_f32_16x16x32_bf16 v[48:51], v[120:123], a[0:3], 0
    ds_read_b128 v[104:107], v10 offset:5120
    ds_read_b128 v[108:111], v11 offset:5120
    v_mfma_f32_16x16x32_bf16 v[56:59], v[120:123], a[4:7], 0
    buffer_load_dwordx4 v7, s[16:19], s41 offen offset:1024 lds
    v_mfma_f32_16x16x32_bf16 v[64:67], v[120:123], a[8:11], 0
    s_waitcnt lgkmcnt(2)
    v_mfma_f32_16x16x32_bf16 v[72:75], v[120:123], a[12:15], 0
    v_perm_b32 v112, v97, v96, s54
    v_perm_b32 v113, v99, v98, s54
    ds_read_b128 a[64:67], v4 offset:4096
    ds_read_b128 a[68:71], v4 offset:45056
    v_mfma_f32_16x16x32_bf16 v[52:55], v[124:127], a[16:19], 0
    buffer_load_dwordx4 v8, s[16:19], s41 offen offset:2048 lds
    v_perm_b32 v114, v101, v100, s54
    v_perm_b32 v115, v103, v102, s54
    ds_read_b128 a[72:75], v5 offset:4096
    ds_read_b128 a[76:79], v5 offset:45056
    v_mfma_f32_16x16x32_bf16 v[60:63], v[124:127], a[20:23], 0
    v_perm_b32 v116, v97, v96, s55
    v_perm_b32 v117, v99, v98, s55
    ds_read_b128 a[80:83], v4 offset:5120
    ds_read_b128 a[84:87], v4 offset:46080
    v_mfma_f32_16x16x32_bf16 v[68:71], v[124:127], a[24:27], 0
    v_perm_b32 v118, v101, v100, s55
    v_perm_b32 v119, v103, v102, s55
    ds_read_b128 a[88:91], v5 offset:5120
    ds_read_b128 a[92:95], v5 offset:46080
    v_mfma_f32_16x16x32_bf16 v[76:79], v[124:127], a[28:31], 0
    buffer_load_dwordx4 v9, s[16:19], s41 offen offset:3072 lds
    s_add_u32 s41, s41, s48
    s_add_u32 m0, m0, 4096
    v_mfma_f32_16x16x32_bf16 v[16:19], v[112:115], a[32:35], v[16:19]
    s_waitcnt vmcnt(8)
    ds_read_b128 v[80:83], v10 offset:8192
    ds_read_b128 v[84:87], v11 offset:8192
    v_mfma_f32_16x16x32_bf16 v[24:27], v[112:115], a[36:39], v[24:27]
    buffer_load_dwordx4 v6, s[16:19], s41 offen offset:0 lds
    v_mfma_f32_16x16x32_bf16 v[32:35], v[112:115], a[40:43], v[32:35]
    s_waitcnt lgkmcnt(2)
    s_nop 0
    v_mfma_f32_16x16x32_bf16 v[40:43], v[112:115], a[44:47], v[40:43]
    v_perm_b32 v120, v105, v104, s54
    v_perm_b32 v121, v107, v106, s54
    ds_read_b128 a[96:99], v4 offset:6144
    ds_read_b128 a[100:103], v4 offset:47104
    v_mfma_f32_16x16x32_bf16 v[20:23], v[116:119], a[48:51], v[20:23]
    buffer_load_dwordx4 v7, s[16:19], s41 offen offset:1024 lds
    v_perm_b32 v122, v109, v108, s54
    v_perm_b32 v123, v111, v110, s54
    ds_read_b128 a[104:107], v5 offset:6144
    ds_read_b128 a[108:111], v5 offset:47104
    v_mfma_f32_16x16x32_bf16 v[28:31], v[116:119], a[52:55], v[28:31]
    v_perm_b32 v124, v105, v104, s55
    v_perm_b32 v125, v107, v106, s55
    ds_read_b128 a[112:115], v4 offset:7168
    ds_read_b128 a[116:119], v4 offset:48128
    v_mfma_f32_16x16x32_bf16 v[36:39], v[116:119], a[56:59], v[36:39]
    v_perm_b32 v126, v109, v108, s55
    v_perm_b32 v127, v111, v110, s55
    ds_read_b128 a[120:123], v5 offset:7168
    ds_read_b128 a[124:127], v5 offset:48128
    v_mfma_f32_16x16x32_bf16 v[44:47], v[116:119], a[60:63], v[44:47]
    buffer_load_dwordx4 v8, s[16:19], s41 offen offset:2048 lds
    v_mfma_f32_16x16x32_bf16 v[48:51], v[120:123], a[32:35], v[48:51]
    ds_read_b128 v[88:91], v10 offset:9216
    ds_read_b128 v[92:95], v11 offset:9216
    v_mfma_f32_16x16x32_bf16 v[56:59], v[120:123], a[36:39], v[56:59]
    buffer_load_dwordx4 v9, s[16:19], s41 offen offset:3072 lds
    s_add_u32 s41, s41, s48
    s_add_u32 m0, m0, 4096
    v_mfma_f32_16x16x32_bf16 v[64:67], v[120:123], a[40:43], v[64:67]
    s_waitcnt lgkmcnt(2)
    v_mfma_f32_16x16x32_bf16 v[72:75], v[120:123], a[44:47], v[72:75]
    v_perm_b32 v112, v81, v80, s54
    v_perm_b32 v113, v83, v82, s54
    ds_read_b128 a[128:131], v4 offset:8192
    ds_read_b128 a[132:135], v4 offset:49152
    v_mfma_f32_16x16x32_bf16 v[52:55], v[124:127], a[48:51], v[52:55]
    buffer_load_dwordx4 v6, s[16:19], s41 offen offset:0 lds
    v_perm_b32 v114, v85, v84, s54
    v_perm_b32 v115, v87, v86, s54
    ds_read_b128 a[136:139], v5 offset:8192
    ds_read_b128 a[140:143], v5 offset:49152
    v_mfma_f32_16x16x32_bf16 v[60:63], v[124:127], a[52:55], v[60:63]
    v_perm_b32 v116, v81, v80, s55
    v_perm_b32 v117, v83, v82, s55
    ds_read_b128 a[144:147], v4 offset:9216
    ds_read_b128 a[148:151], v4 offset:50176
    v_mfma_f32_16x16x32_bf16 v[68:71], v[124:127], a[56:59], v[68:71]
    v_perm_b32 v118, v85, v84, s55
    v_perm_b32 v119, v87, v86, s55
    ds_read_b128 a[152:155], v5 offset:9216
    ds_read_b128 a[156:159], v5 offset:50176
    v_mfma_f32_16x16x32_bf16 v[76:79], v[124:127], a[60:63], v[76:79]
    buffer_load_dwordx4 v7, s[16:19], s41 offen offset:1024 lds
    v_mfma_f32_16x16x32_bf16 v[16:19], v[112:115], a[64:67], v[16:19]
    s_waitcnt vmcnt(10)
    ds_read_b128 v[96:99], v10 offset:12288
    ds_read_b128 v[100:103], v11 offset:12288
    v_mfma_f32_16x16x32_bf16 v[24:27], v[112:115], a[68:71], v[24:27]
    buffer_load_dwordx4 v8, s[16:19], s41 offen offset:2048 lds
    v_mfma_f32_16x16x32_bf16 v[32:35], v[112:115], a[72:75], v[32:35]
    s_waitcnt lgkmcnt(2)
    s_barrier
    v_mfma_f32_16x16x32_bf16 v[40:43], v[112:115], a[76:79], v[40:43]
    v_perm_b32 v120, v89, v88, s54
    v_perm_b32 v121, v91, v90, s54
    v_mfma_f32_16x16x32_bf16 v[20:23], v[116:119], a[80:83], v[20:23]
    buffer_load_dwordx4 v9, s[16:19], s41 offen offset:3072 lds
    s_add_u32 s41, s41, s48
    s_add_u32 m0, m0, 4096
    v_perm_b32 v122, v93, v92, s54
    v_perm_b32 v123, v95, v94, s54
    v_mfma_f32_16x16x32_bf16 v[28:31], v[116:119], a[84:87], v[28:31]
    v_perm_b32 v124, v89, v88, s55
    v_perm_b32 v125, v91, v90, s55
    v_mfma_f32_16x16x32_bf16 v[36:39], v[116:119], a[88:91], v[36:39]
    v_perm_b32 v126, v93, v92, s55
    v_perm_b32 v127, v95, v94, s55
    v_mfma_f32_16x16x32_bf16 v[44:47], v[116:119], a[92:95], v[44:47]
    buffer_load_dwordx4 v6, s[16:19], s41 offen offset:0 lds
    v_mfma_f32_16x16x32_bf16 v[48:51], v[120:123], a[64:67], v[48:51]
    ds_read_b128 v[104:107], v10 offset:13312
    ds_read_b128 v[108:111], v11 offset:13312
    v_mfma_f32_16x16x32_bf16 v[56:59], v[120:123], a[68:71], v[56:59]
    buffer_load_dwordx4 v7, s[16:19], s41 offen offset:1024 lds
    v_mfma_f32_16x16x32_bf16 v[64:67], v[120:123], a[72:75], v[64:67]
    s_waitcnt lgkmcnt(2)
    v_mfma_f32_16x16x32_bf16 v[72:75], v[120:123], a[76:79], v[72:75]
    v_perm_b32 v112, v97, v96, s54
    v_perm_b32 v113, v99, v98, s54
    v_mfma_f32_16x16x32_bf16 v[52:55], v[124:127], a[80:83], v[52:55]
    buffer_load_dwordx4 v8, s[16:19], s41 offen offset:2048 lds
    v_perm_b32 v114, v101, v100, s54
    v_perm_b32 v115, v103, v102, s54
    v_mfma_f32_16x16x32_bf16 v[60:63], v[124:127], a[84:87], v[60:63]
    v_perm_b32 v116, v97, v96, s55
    v_perm_b32 v117, v99, v98, s55
    v_mfma_f32_16x16x32_bf16 v[68:71], v[124:127], a[88:91], v[68:71]
    v_perm_b32 v118, v101, v100, s55
    v_perm_b32 v119, v103, v102, s55
    v_mfma_f32_16x16x32_bf16 v[76:79], v[124:127], a[92:95], v[76:79]
    buffer_load_dwordx4 v9, s[16:19], s41 offen offset:3072 lds
    s_add_u32 s41, s41, s48
    s_add_u32 m0, m0, 4096
    v_mfma_f32_16x16x32_bf16 v[16:19], v[112:115], a[96:99], v[16:19]
    s_waitcnt vmcnt(12)
    ds_read_b128 v[80:83], v10 offset:16384
    ds_read_b128 v[84:87], v11 offset:16384
    v_mfma_f32_16x16x32_bf16 v[24:27], v[112:115], a[100:103], v[24:27]
    buffer_load_dwordx4 v6, s[16:19], s41 offen offset:0 lds
    v_mfma_f32_16x16x32_bf16 v[32:35], v[112:115], a[104:107], v[32:35]
    s_waitcnt lgkmcnt(2)
    v_mfma_f32_16x16x32_bf16 v[40:43], v[112:115], a[108:111], v[40:43]
    v_perm_b32 v120, v105, v104, s54
    v_perm_b32 v121, v107, v106, s54
    v_mfma_f32_16x16x32_bf16 v[20:23], v[116:119], a[112:115], v[20:23]
    buffer_load_dwordx4 v7, s[16:19], s41 offen offset:1024 lds
    v_perm_b32 v122, v109, v108, s54
    v_perm_b32 v123, v111, v110, s54
    v_mfma_f32_16x16x32_bf16 v[28:31], v[116:119], a[116:119], v[28:31]
    v_perm_b32 v124, v105, v104, s55
    v_perm_b32 v125, v107, v106, s55
    v_mfma_f32_16x16x32_bf16 v[36:39], v[116:119], a[120:123], v[36:39]
    v_perm_b32 v126, v109, v108, s55
    v_perm_b32 v127, v111, v110, s55
    v_mfma_f32_16x16x32_bf16 v[44:47], v[116:119], a[124:127], v[44:47]
    buffer_load_dwordx4 v8, s[16:19], s41 offen offset:2048 lds
    v_mfma_f32_16x16x32_bf16 v[48:51], v[120:123], a[96:99], v[48:51]
    ds_read_b128 v[88:91], v10 offset:17408
    ds_read_b128 v[92:95], v11 offset:17408
    v_mfma_f32_16x16x32_bf16 v[56:59], v[120:123], a[100:103], v[56:59]
    buffer_load_dwordx4 v9, s[16:19], s41 offen offset:3072 lds
    s_add_u32 s41, s41, s48
    s_add_u32 m0, m0, 4096
    v_mfma_f32_16x16x32_bf16 v[64:67], v[120:123], a[104:107], v[64:67]
    s_waitcnt lgkmcnt(2)
    v_mfma_f32_16x16x32_bf16 v[72:75], v[120:123], a[108:111], v[72:75]
    v_perm_b32 v112, v81, v80, s54
    v_perm_b32 v113, v83, v82, s54
    v_mfma_f32_16x16x32_bf16 v[52:55], v[124:127], a[112:115], v[52:55]
    buffer_load_dwordx4 v6, s[16:19], s41 offen offset:0 lds
    v_perm_b32 v114, v85, v84, s54
    v_perm_b32 v115, v87, v86, s54
    v_mfma_f32_16x16x32_bf16 v[60:63], v[124:127], a[116:119], v[60:63]
    v_perm_b32 v116, v81, v80, s55
    v_perm_b32 v117, v83, v82, s55
    v_mfma_f32_16x16x32_bf16 v[68:71], v[124:127], a[120:123], v[68:71]
    v_perm_b32 v118, v85, v84, s55
    v_perm_b32 v119, v87, v86, s55
    v_mfma_f32_16x16x32_bf16 v[76:79], v[124:127], a[124:127], v[76:79]
    buffer_load_dwordx4 v7, s[16:19], s41 offen offset:1024 lds
    v_mfma_f32_16x16x32_bf16 v[16:19], v[112:115], a[128:131], v[16:19]
    s_waitcnt vmcnt(14)
    ds_read_b128 v[96:99], v10 offset:20480
    ds_read_b128 v[100:103], v11 offset:20480
    v_mfma_f32_16x16x32_bf16 v[24:27], v[112:115], a[132:135], v[24:27]
    buffer_load_dwordx4 v8, s[16:19], s41 offen offset:2048 lds
    v_mfma_f32_16x16x32_bf16 v[32:35], v[112:115], a[136:139], v[32:35]
    s_waitcnt lgkmcnt(2)
    v_mfma_f32_16x16x32_bf16 v[40:43], v[112:115], a[140:143], v[40:43]
    v_perm_b32 v120, v89, v88, s54
    v_perm_b32 v121, v91, v90, s54
    v_mfma_f32_16x16x32_bf16 v[20:23], v[116:119], a[144:147], v[20:23]
    buffer_load_dwordx4 v9, s[16:19], s41 offen offset:3072 lds
    s_add_u32 s41, s41, s48
    s_add_u32 m0, m0, 4096
    buffer_load_dword v14, v15, s[36:39], 0 offen sc1
    v_perm_b32 v122, v93, v92, s54
    v_perm_b32 v123, v95, v94, s54
    v_mfma_f32_16x16x32_bf16 v[28:31], v[116:119], a[148:151], v[28:31]
    v_perm_b32 v124, v89, v88, s55
    v_perm_b32 v125, v91, v90, s55
    v_mfma_f32_16x16x32_bf16 v[36:39], v[116:119], a[152:155], v[36:39]
    v_perm_b32 v126, v93, v92, s55
    v_perm_b32 v127, v95, v94, s55
    v_mfma_f32_16x16x32_bf16 v[44:47], v[116:119], a[156:159], v[44:47]
    v_mfma_f32_16x16x32_bf16 v[48:51], v[120:123], a[128:131], v[48:51]
    ds_read_b128 v[104:107], v10 offset:21504
    ds_read_b128 v[108:111], v11 offset:21504
    v_mfma_f32_16x16x32_bf16 v[56:59], v[120:123], a[132:135], v[56:59]
    v_mfma_f32_16x16x32_bf16 v[64:67], v[120:123], a[136:139], v[64:67]
    s_waitcnt lgkmcnt(2)
    v_mfma_f32_16x16x32_bf16 v[72:75], v[120:123], a[140:143], v[72:75]
    v_perm_b32 v112, v97, v96, s54
    v_perm_b32 v113, v99, v98, s54
    v_mfma_f32_16x16x32_bf16 v[52:55], v[124:127], a[144:147], v[52:55]
    v_perm_b32 v114, v101, v100, s54
    v_perm_b32 v115, v103, v102, s54
    v_mfma_f32_16x16x32_bf16 v[60:63], v[124:127], a[148:151], v[60:63]
    v_perm_b32 v116, v97, v96, s55
    v_perm_b32 v117, v99, v98, s55
    v_mfma_f32_16x16x32_bf16 v[68:71], v[124:127], a[152:155], v[68:71]
    v_perm_b32 v118, v101, v100, s55
    v_perm_b32 v119, v103, v102, s55
    v_mfma_f32_16x16x32_bf16 v[76:79], v[124:127], a[156:159], v[76:79]
    v_pk_mul_f32 v[16:17], v[16:17], v[12:13] op_sel_hi:[1,0]
    v_pk_mul_f32 v[18:19], v[18:19], v[12:13] op_sel_hi:[1,0]
    v_pk_mul_f32 v[20:21], v[20:21], v[12:13] op_sel_hi:[1,0]
    v_pk_mul_f32 v[22:23], v[22:23], v[12:13] op_sel_hi:[1,0]
    v_pk_mul_f32 v[24:25], v[24:25], v[12:13] op_sel_hi:[1,0]
    v_pk_mul_f32 v[26:27], v[26:27], v[12:13] op_sel_hi:[1,0]
    v_pk_mul_f32 v[28:29], v[28:29], v[12:13] op_sel_hi:[1,0]
    v_pk_mul_f32 v[30:31], v[30:31], v[12:13] op_sel_hi:[1,0]
    v_pk_mul_f32 v[32:33], v[32:33], v[12:13] op_sel_hi:[1,0]
    v_pk_mul_f32 v[34:35], v[34:35], v[12:13] op_sel_hi:[1,0]
    v_pk_mul_f32 v[36:37], v[36:37], v[12:13] op_sel_hi:[1,0]
    v_pk_mul_f32 v[38:39], v[38:39], v[12:13] op_sel_hi:[1,0]
    v_pk_mul_f32 v[40:41], v[40:41], v[12:13] op_sel_hi:[1,0]
    v_pk_mul_f32 v[42:43], v[42:43], v[12:13] op_sel_hi:[1,0]
    v_pk_mul_f32 v[44:45], v[44:45], v[12:13] op_sel_hi:[1,0]
    v_pk_mul_f32 v[46:47], v[46:47], v[12:13] op_sel_hi:[1,0]
    v_pk_mul_f32 v[48:49], v[48:49], v[12:13] op_sel_hi:[1,0]
    v_pk_mul_f32 v[50:51], v[50:51], v[12:13] op_sel_hi:[1,0]
    v_pk_mul_f32 v[52:53], v[52:53], v[12:13] op_sel_hi:[1,0]
    v_pk_mul_f32 v[54:55], v[54:55], v[12:13] op_sel_hi:[1,0]
    v_pk_mul_f32 v[56:57], v[56:57], v[12:13] op_sel_hi:[1,0]
    v_pk_mul_f32 v[58:59], v[58:59], v[12:13] op_sel_hi:[1,0]
    v_pk_mul_f32 v[60:61], v[60:61], v[12:13] op_sel_hi:[1,0]
    v_pk_mul_f32 v[62:63], v[62:63], v[12:13] op_sel_hi:[1,0]
    v_pk_mul_f32 v[64:65], v[64:65], v[12:13] op_sel_hi:[1,0]
    v_pk_mul_f32 v[66:67], v[66:67], v[12:13] op_sel_hi:[1,0]
    v_pk_mul_f32 v[68:69], v[68:69], v[12:13] op_sel_hi:[1,0]
    v_pk_mul_f32 v[70:71], v[70:71], v[12:13] op_sel_hi:[1,0]
    v_pk_mul_f32 v[72:73], v[72:73], v[12:13] op_sel_hi:[1,0]
    v_pk_mul_f32 v[74:75], v[74:75], v[12:13] op_sel_hi:[1,0]
    v_pk_mul_f32 v[76:77], v[76:77], v[12:13] op_sel_hi:[1,0]
    v_pk_mul_f32 v[78:79], v[78:79], v[12:13] op_sel_hi:[1,0]
    v_mfma_f32_16x16x32_bf16 v[16:19], v[112:115], a[0:3], v[16:19]
    s_waitcnt vmcnt(13)
    ds_read_b128 v[80:83], v10 offset:24576
    ds_read_b128 v[84:87], v11 offset:24576
    v_mfma_f32_16x16x32_bf16 v[24:27], v[112:115], a[4:7], v[24:27]
    v_mfma_f32_16x16x32_bf16 v[32:35], v[112:115], a[8:11], v[32:35]
    s_waitcnt lgkmcnt(2)
    v_mfma_f32_16x16x32_bf16 v[40:43], v[112:115], a[12:15], v[40:43]
    v_perm_b32 v120, v105, v104, s54
    v_perm_b32 v121, v107, v106, s54
    v_mfma_f32_16x16x32_bf16 v[20:23], v[116:119], a[16:19], v[20:23]
    v_perm_b32 v122, v109, v108, s54
    v_perm_b32 v123, v111, v110, s54
    v_mfma_f32_16x16x32_bf16 v[28:31], v[116:119], a[20:23], v[28:31]
    v_perm_b32 v124, v105, v104, s55
    v_perm_b32 v125, v107, v106, s55
    v_mfma_f32_16x16x32_bf16 v[36:39], v[116:119], a[24:27], v[36:39]
    v_perm_b32 v126, v109, v108, s55
    v_perm_b32 v127, v111, v110, s55
    v_mfma_f32_16x16x32_bf16 v[44:47], v[116:119], a[28:31], v[44:47]
    v_mfma_f32_16x16x32_bf16 v[48:51], v[120:123], a[0:3], v[48:51]
    ds_read_b128 v[88:91], v10 offset:25600
    ds_read_b128 v[92:95], v11 offset:25600
    v_mfma_f32_16x16x32_bf16 v[56:59], v[120:123], a[4:7], v[56:59]
    v_mfma_f32_16x16x32_bf16 v[64:67], v[120:123], a[8:11], v[64:67]
    s_waitcnt lgkmcnt(2)
    v_mfma_f32_16x16x32_bf16 v[72:75], v[120:123], a[12:15], v[72:75]
    v_perm_b32 v112, v81, v80, s54
    v_perm_b32 v113, v83, v82, s54
    v_mfma_f32_16x16x32_bf16 v[52:55], v[124:127], a[16:19], v[52:55]
    v_perm_b32 v114, v85, v84, s54
    v_perm_b32 v115, v87, v86, s54
    v_mfma_f32_16x16x32_bf16 v[60:63], v[124:127], a[20:23], v[60:63]
    v_perm_b32 v116, v81, v80, s55
    v_perm_b32 v117, v83, v82, s55
    v_mfma_f32_16x16x32_bf16 v[68:71], v[124:127], a[24:27], v[68:71]
    v_perm_b32 v118, v85, v84, s55
    v_perm_b32 v119, v87, v86, s55
    v_mfma_f32_16x16x32_bf16 v[76:79], v[124:127], a[28:31], v[76:79]
    v_mfma_f32_16x16x32_bf16 v[16:19], v[112:115], a[32:35], v[16:19]
    s_waitcnt vmcnt(9)
    ds_read_b128 v[96:99], v10 offset:28672
    ds_read_b128 v[100:103], v11 offset:28672
    v_mfma_f32_16x16x32_bf16 v[24:27], v[112:115], a[36:39], v[24:27]
    v_mfma_f32_16x16x32_bf16 v[32:35], v[112:115], a[40:43], v[32:35]
    s_waitcnt lgkmcnt(2)
    v_mfma_f32_16x16x32_bf16 v[40:43], v[112:115], a[44:47], v[40:43]
    v_perm_b32 v120, v89, v88, s54
    v_perm_b32 v121, v91, v90, s54
    v_mfma_f32_16x16x32_bf16 v[20:23], v[116:119], a[48:51], v[20:23]
    v_perm_b32 v122, v93, v92, s54
    v_perm_b32 v123, v95, v94, s54
    v_mfma_f32_16x16x32_bf16 v[28:31], v[116:119], a[52:55], v[28:31]
    v_perm_b32 v124, v89, v88, s55
    v_perm_b32 v125, v91, v90, s55
    v_mfma_f32_16x16x32_bf16 v[36:39], v[116:119], a[56:59], v[36:39]
    v_perm_b32 v126, v93, v92, s55
    v_perm_b32 v127, v95, v94, s55
    v_mfma_f32_16x16x32_bf16 v[44:47], v[116:119], a[60:63], v[44:47]
    v_mfma_f32_16x16x32_bf16 v[48:51], v[120:123], a[32:35], v[48:51]
    ds_read_b128 v[104:107], v10 offset:29696
    ds_read_b128 v[108:111], v11 offset:29696
    v_mfma_f32_16x16x32_bf16 v[56:59], v[120:123], a[36:39], v[56:59]
    v_mfma_f32_16x16x32_bf16 v[64:67], v[120:123], a[40:43], v[64:67]
    s_waitcnt lgkmcnt(2)
    v_mfma_f32_16x16x32_bf16 v[72:75], v[120:123], a[44:47], v[72:75]
    v_perm_b32 v112, v97, v96, s54
    v_perm_b32 v113, v99, v98, s54
    v_mfma_f32_16x16x32_bf16 v[52:55], v[124:127], a[48:51], v[52:55]
    v_perm_b32 v114, v101, v100, s54
    v_perm_b32 v115, v103, v102, s54
    v_mfma_f32_16x16x32_bf16 v[60:63], v[124:127], a[52:55], v[60:63]
    v_perm_b32 v116, v97, v96, s55
    v_perm_b32 v117, v99, v98, s55
    v_mfma_f32_16x16x32_bf16 v[68:71], v[124:127], a[56:59], v[68:71]
    v_perm_b32 v118, v101, v100, s55
    v_perm_b32 v119, v103, v102, s55
    v_mfma_f32_16x16x32_bf16 v[76:79], v[124:127], a[60:63], v[76:79]
    v_mfma_f32_16x16x32_bf16 v[16:19], v[112:115], a[64:67], v[16:19]
    s_waitcnt vmcnt(5)
    ds_read_b128 v[80:83], v10 offset:32768
    ds_read_b128 v[84:87], v11 offset:32768
    v_mfma_f32_16x16x32_bf16 v[24:27], v[112:115], a[68:71], v[24:27]
    v_mfma_f32_16x16x32_bf16 v[32:35], v[112:115], a[72:75], v[32:35]
    s_waitcnt lgkmcnt(2)
    v_mfma_f32_16x16x32_bf16 v[40:43], v[112:115], a[76:79], v[40:43]
    v_perm_b32 v120, v105, v104, s54
    v_perm_b32 v121, v107, v106, s54
    v_mfma_f32_16x16x32_bf16 v[20:23], v[116:119], a[80:83], v[20:23]
    v_perm_b32 v122, v109, v108, s54
    v_perm_b32 v123, v111, v110, s54
    v_mfma_f32_16x16x32_bf16 v[28:31], v[116:119], a[84:87], v[28:31]
    v_perm_b32 v124, v105, v104, s55
    v_perm_b32 v125, v107, v106, s55
    v_mfma_f32_16x16x32_bf16 v[36:39], v[116:119], a[88:91], v[36:39]
    v_perm_b32 v126, v109, v108, s55
    v_perm_b32 v127, v111, v110, s55
    v_mfma_f32_16x16x32_bf16 v[44:47], v[116:119], a[92:95], v[44:47]
    v_mfma_f32_16x16x32_bf16 v[48:51], v[120:123], a[64:67], v[48:51]
    ds_read_b128 v[88:91], v10 offset:33792
    ds_read_b128 v[92:95], v11 offset:33792
    v_mfma_f32_16x16x32_bf16 v[56:59], v[120:123], a[68:71], v[56:59]
    v_mfma_f32_16x16x32_bf16 v[64:67], v[120:123], a[72:75], v[64:67]
    s_waitcnt lgkmcnt(2)
    v_mfma_f32_16x16x32_bf16 v[72:75], v[120:123], a[76:79], v[72:75]
    v_perm_b32 v112, v81, v80, s54
    v_perm_b32 v113, v83, v82, s54
    v_mfma_f32_16x16x32_bf16 v[52:55], v[124:127], a[80:83], v[52:55]
    v_perm_b32 v114, v85, v84, s54
    v_perm_b32 v115, v87, v86, s54
    v_mfma_f32_16x16x32_bf16 v[60:63], v[124:127], a[84:87], v[60:63]
    v_perm_b32 v116, v81, v80, s55
    v_perm_b32 v117, v83, v82, s55
    v_mfma_f32_16x16x32_bf16 v[68:71], v[124:127], a[88:91], v[68:71]
    v_perm_b32 v118, v85, v84, s55
    v_perm_b32 v119, v87, v86, s55
    v_mfma_f32_16x16x32_bf16 v[76:79], v[124:127], a[92:95], v[76:79]
    v_mfma_f32_16x16x32_bf16 v[16:19], v[112:115], a[96:99], v[16:19]
    s_waitcnt vmcnt(1)
    ds_read_b128 v[96:99], v10 offset:36864
    ds_read_b128 v[100:103], v11 offset:36864
    v_mfma_f32_16x16x32_bf16 v[24:27], v[112:115], a[100:103], v[24:27]
    v_mfma_f32_16x16x32_bf16 v[32:35], v[112:115], a[104:107], v[32:35]
    s_waitcnt lgkmcnt(2)
    v_mfma_f32_16x16x32_bf16 v[40:43], v[112:115], a[108:111], v[40:43]
    v_perm_b32 v120, v89, v88, s54
    v_perm_b32 v121, v91, v90, s54
    v_mfma_f32_16x16x32_bf16 v[20:23], v[116:119], a[112:115], v[20:23]
    v_perm_b32 v122, v93, v92, s54
    v_perm_b32 v123, v95, v94, s54
    v_mfma_f32_16x16x32_bf16 v[28:31], v[116:119], a[116:119], v[28:31]
    v_perm_b32 v124, v89, v88, s55
    v_perm_b32 v125, v91, v90, s55
    v_mfma_f32_16x16x32_bf16 v[36:39], v[116:119], a[120:123], v[36:39]
    v_perm_b32 v126, v93, v92, s55
    v_perm_b32 v127, v95, v94, s55
    v_mfma_f32_16x16x32_bf16 v[44:47], v[116:119], a[124:127], v[44:47]
    v_mfma_f32_16x16x32_bf16 v[48:51], v[120:123], a[96:99], v[48:51]
    ds_read_b128 v[104:107], v10 offset:37888
    ds_read_b128 v[108:111], v11 offset:37888
    v_mfma_f32_16x16x32_bf16 v[56:59], v[120:123], a[100:103], v[56:59]
    v_mfma_f32_16x16x32_bf16 v[64:67], v[120:123], a[104:107], v[64:67]
    s_waitcnt lgkmcnt(2)
    v_mfma_f32_16x16x32_bf16 v[72:75], v[120:123], a[108:111], v[72:75]
    v_perm_b32 v112, v97, v96, s54
    v_perm_b32 v113, v99, v98, s54
    v_mfma_f32_16x16x32_bf16 v[52:55], v[124:127], a[112:115], v[52:55]
    v_perm_b32 v114, v101, v100, s54
    v_perm_b32 v115, v103, v102, s54
    v_mfma_f32_16x16x32_bf16 v[60:63], v[124:127], a[116:119], v[60:63]
    v_perm_b32 v116, v97, v96, s55
    v_perm_b32 v117, v99, v98, s55
    v_mfma_f32_16x16x32_bf16 v[68:71], v[124:127], a[120:123], v[68:71]
    v_perm_b32 v118, v101, v100, s55
    v_perm_b32 v119, v103, v102, s55
    v_mfma_f32_16x16x32_bf16 v[76:79], v[124:127], a[124:127], v[76:79]
    v_mfma_f32_16x16x32_bf16 v[16:19], v[112:115], a[128:131], v[16:19]
    v_mfma_f32_16x16x32_bf16 v[24:27], v[112:115], a[132:135], v[24:27]
    v_mfma_f32_16x16x32_bf16 v[32:35], v[112:115], a[136:139], v[32:35]
    s_waitcnt lgkmcnt(0)
    v_mfma_f32_16x16x32_bf16 v[40:43], v[112:115], a[140:143], v[40:43]
    v_perm_b32 v120, v105, v104, s54
    v_perm_b32 v121, v107, v106, s54
    v_mfma_f32_16x16x32_bf16 v[20:23], v[116:119], a[144:147], v[20:23]
    v_perm_b32 v122, v109, v108, s54
    v_perm_b32 v123, v111, v110, s54
    v_mfma_f32_16x16x32_bf16 v[28:31], v[116:119], a[148:151], v[28:31]
    v_perm_b32 v124, v105, v104, s55
    v_perm_b32 v125, v107, v106, s55
    v_mfma_f32_16x16x32_bf16 v[36:39], v[116:119], a[152:155], v[36:39]
    v_perm_b32 v126, v109, v108, s55
    v_perm_b32 v127, v111, v110, s55
    v_mfma_f32_16x16x32_bf16 v[44:47], v[116:119], a[156:159], v[44:47]
    v_mfma_f32_16x16x32_bf16 v[48:51], v[120:123], a[128:131], v[48:51]
    v_mfma_f32_16x16x32_bf16 v[56:59], v[120:123], a[132:135], v[56:59]
    v_mfma_f32_16x16x32_bf16 v[64:67], v[120:123], a[136:139], v[64:67]
    v_mfma_f32_16x16x32_bf16 v[72:75], v[120:123], a[140:143], v[72:75]
    v_mfma_f32_16x16x32_bf16 v[52:55], v[124:127], a[144:147], v[52:55]
    v_mfma_f32_16x16x32_bf16 v[60:63], v[124:127], a[148:151], v[60:63]
    v_mfma_f32_16x16x32_bf16 v[68:71], v[124:127], a[152:155], v[68:71]
    v_mfma_f32_16x16x32_bf16 v[76:79], v[124:127], a[156:159], v[76:79]
    s_waitcnt vmcnt(0)
    v_cmp_gt_u32 vcc, 7, v14
    s_nop 1
    s_cbranch_vccnz P0_spin2
P0_rdy2:
    v_bfe_u32 v8, v1, 1, 1
    v_and_b32 v9, 1, v1
    v_xor_b32_e64 v9, v9, v8
    v_mul_u32_u24 v8, 0x8000, v8
    v_lshl_or_b32 v8, v8, 16, v8
    v_mul_u32_u24 v9, 0x8000, v9
    v_lshl_or_b32 v9, v9, 16, v9
    v_or_b32_e64 v12, s44, v1
    v_add_u32 v11, 983040, v3
    v_cmp_eq_u32 s[50:51], 0, v12
    v_cmp_eq_u32 s[52:53], 1, v12
    s_mul_i32 s13, s5, 5120
    s_add_u32 s13, s13, 25034752
    s_lshr_b32 s14, s44, 4
    s_mov_b32 s47, 0
    s_mul_i32 s48, s14, 13108
    s_lshr_b32 s48, s48, 16
    s_mul_i32 s48, s48, 240640
    s_lshl_b32 s49, s14, 10
    s_add_u32 s48, s48, s49
    s_add_u32 s48, s48, s13
    s_add_u32 s14, s14, 1
    s_nop 0
    v_pk_add_f32 v[136:137], v[16:17], v[20:21]
    v_pk_add_f32 v[138:139], v[18:19], v[22:23]
    v_pk_add_f32 v[140:141], v[48:49], v[52:53]
    v_pk_add_f32 v[142:143], v[50:51], v[54:55]
    v_cvt_pk_bf16_f32 v80, v136, v137
    v_cvt_pk_bf16_f32 v81, v138, v139
    v_cvt_pk_bf16_f32 v82, v140, v141
    v_cvt_pk_bf16_f32 v83, v142, v143
    v_xor_b32 v80, v8, v80
    v_xor_b32 v81, v8, v81
    v_xor_b32 v82, v8, v82
    v_xor_b32 v83, v8, v83
    v_pk_add_f32 v[128:129], v[16:17], v[20:21] neg_lo:[0,1] neg_hi:[0,1]
    v_pk_add_f32 v[130:131], v[18:19], v[22:23] neg_lo:[0,1] neg_hi:[0,1]
    v_pk_add_f32 v[132:133], v[48:49], v[52:53] neg_lo:[0,1] neg_hi:[0,1]
    v_pk_add_f32 v[134:135], v[50:51], v[54:55] neg_lo:[0,1] neg_hi:[0,1]
    v_cvt_pk_bf16_f32 v84, v128, v129
    v_cvt_pk_bf16_f32 v85, v130, v131
    v_cvt_pk_bf16_f32 v86, v132, v133
    v_cvt_pk_bf16_f32 v87, v134, v135
    v_xor_b32 v84, v9, v84
    v_xor_b32 v85, v9, v85
    v_xor_b32 v86, v9, v86
    v_xor_b32 v87, v9, v87
    v_mov_b32_dpp v144, v80 quad_perm:[1,0,2,3] row_mask:0xf bank_mask:0xf
    v_mov_b32_dpp v145, v81 quad_perm:[1,0,2,3] row_mask:0xf bank_mask:0xf
    v_mov_b32_dpp v146, v82 quad_perm:[1,0,2,3] row_mask:0xf bank_mask:0xf
    v_mov_b32_dpp v147, v83 quad_perm:[1,0,2,3] row_mask:0xf bank_mask:0xf
    v_cndmask_b32 v80, v80, v84, s[50:51]
    v_cndmask_b32 v80, v80, v144, s[52:53]
    v_cndmask_b32 v84, v84, v144, s[50:51]
    v_cndmask_b32 v81, v81, v85, s[50:51]
    v_cndmask_b32 v81, v81, v145, s[52:53]
    v_cndmask_b32 v85, v85, v145, s[50:51]
    v_cndmask_b32 v82, v82, v86, s[50:51]
    v_cndmask_b32 v82, v82, v146, s[52:53]
    v_cndmask_b32 v86, v86, v146, s[50:51]
    v_cndmask_b32 v83, v83, v87, s[50:51]
    v_cndmask_b32 v83, v83, v147, s[52:53]
    v_cndmask_b32 v87, v87, v147, s[50:51]
    buffer_store_dwordx4 v[80:83], v3, s[8:11], s48 offen sc1
    buffer_store_dwordx4 v[84:87], v11, s[8:11], s48 offen sc1
    s_mul_i32 s48, s14, 13108
    s_lshr_b32 s48, s48, 16
    s_mul_i32 s48, s48, 240640
    s_lshl_b32 s49, s14, 10
    s_add_u32 s48, s48, s49
    s_add_u32 s48, s48, s13
    s_add_u32 s14, s14, 1
    s_nop 0
    v_pk_add_f32 v[136:137], v[24:25], v[28:29]
    v_pk_add_f32 v[138:139], v[26:27], v[30:31]
    v_pk_add_f32 v[140:141], v[56:57], v[60:61]
    v_pk_add_f32 v[142:143], v[58:59], v[62:63]
    v_cvt_pk_bf16_f32 v88, v136, v137
    v_cvt_pk_bf16_f32 v89, v138, v139
    v_cvt_pk_bf16_f32 v90, v140, v141
    v_cvt_pk_bf16_f32 v91, v142, v143
    v_xor_b32 v88, v8, v88
    v_xor_b32 v89, v8, v89
    v_xor_b32 v90, v8, v90
    v_xor_b32 v91, v8, v91
    buffer_store_dwordx4 v[88:91], v3, s[8:11], s48 offen sc1
    v_pk_add_f32 v[128:129], v[24:25], v[28:29] neg_lo:[0,1] neg_hi:[0,1]
    v_pk_add_f32 v[130:131], v[26:27], v[30:31] neg_lo:[0,1] neg_hi:[0,1]
    v_pk_add_f32 v[132:133], v[56:57], v[60:61] neg_lo:[0,1] neg_hi:[0,1]
    v_pk_add_f32 v[134:135], v[58:59], v[62:63] neg_lo:[0,1] neg_hi:[0,1]
    v_cvt_pk_bf16_f32 v92, v128, v129
    v_cvt_pk_bf16_f32 v93, v130, v131
    v_cvt_pk_bf16_f32 v94, v132, v133
    v_cvt_pk_bf16_f32 v95, v134, v135
    v_xor_b32 v92, v9, v92
    v_xor_b32 v93, v9, v93
    v_xor_b32 v94, v9, v94
    v_xor_b32 v95, v9, v95
    buffer_store_dwordx4 v[92:95], v11, s[8:11], s48 offen sc1
    s_mul_i32 s48, s14, 13108
    s_lshr_b32 s48, s48, 16
    s_mul_i32 s48, s48, 240640
    s_lshl_b32 s49, s14, 10
    s_add_u32 s48, s48, s49
    s_add_u32 s48, s48, s13
    s_add_u32 s14, s14, 1
    s_nop 0
    v_pk_add_f32 v[136:137], v[32:33], v[36:37]
    v_pk_add_f32 v[138:139], v[34:35], v[38:39]
    v_pk_add_f32 v[140:141], v[64:65], v[68:69]
    v_pk_add_f32 v[142:143], v[66:67], v[70:71]
    v_cvt_pk_bf16_f32 v96, v136, v137
    v_cvt_pk_bf16_f32 v97, v138, v139
    v_cvt_pk_bf16_f32 v98, v140, v141
    v_cvt_pk_bf16_f32 v99, v142, v143
    v_xor_b32 v96, v8, v96
    v_xor_b32 v97, v8, v97
    v_xor_b32 v98, v8, v98
    v_xor_b32 v99, v8, v99
    buffer_store_dwordx4 v[96:99], v3, s[8:11], s48 offen sc1
    v_pk_add_f32 v[128:129], v[32:33], v[36:37] neg_lo:[0,1] neg_hi:[0,1]
    v_pk_add_f32 v[130:131], v[34:35], v[38:39] neg_lo:[0,1] neg_hi:[0,1]
    v_pk_add_f32 v[132:133], v[64:65], v[68:69] neg_lo:[0,1] neg_hi:[0,1]
    v_pk_add_f32 v[134:135], v[66:67], v[70:71] neg_lo:[0,1] neg_hi:[0,1]
    v_cvt_pk_bf16_f32 v100, v128, v129
    v_cvt_pk_bf16_f32 v101, v130, v131
    v_cvt_pk_bf16_f32 v102, v132, v133
    v_cvt_pk_bf16_f32 v103, v134, v135
    v_xor_b32 v100, v9, v100
    v_xor_b32 v101, v9, v101
    v_xor_b32 v102, v9, v102
    v_xor_b32 v103, v9, v103
    buffer_store_dwordx4 v[100:103], v11, s[8:11], s48 offen sc1
    s_mul_i32 s48, s14, 13108
    s_lshr_b32 s48, s48, 16
    s_mul_i32 s48, s48, 240640
    s_lshl_b32 s49, s14, 10
    s_add_u32 s48, s48, s49
    s_add_u32 s48, s48, s13
    s_add_u32 s14, s14, 1
    s_nop 0
    v_pk_add_f32 v[136:137], v[40:41], v[44:45]
    v_pk_add_f32 v[138:139], v[42:43], v[46:47]
    v_pk_add_f32 v[140:141], v[72:73], v[76:77]
    v_pk_add_f32 v[142:143], v[74:75], v[78:79]
    v_cvt_pk_bf16_f32 v104, v136, v137
    v_cvt_pk_bf16_f32 v105, v138, v139
    v_cvt_pk_bf16_f32 v106, v140, v141
    v_cvt_pk_bf16_f32 v107, v142, v143
    v_xor_b32 v104, v8, v104
    v_xor_b32 v105, v8, v105
    v_xor_b32 v106, v8, v106
    v_xor_b32 v107, v8, v107
    buffer_store_dwordx4 v[104:107], v3, s[8:11], s48 offen sc1
    v_pk_add_f32 v[128:129], v[40:41], v[44:45] neg_lo:[0,1] neg_hi:[0,1]
    v_pk_add_f32 v[130:131], v[42:43], v[46:47] neg_lo:[0,1] neg_hi:[0,1]
    v_pk_add_f32 v[132:133], v[72:73], v[76:77] neg_lo:[0,1] neg_hi:[0,1]
    v_pk_add_f32 v[134:135], v[74:75], v[78:79] neg_lo:[0,1] neg_hi:[0,1]
    v_cvt_pk_bf16_f32 v108, v128, v129
    v_cvt_pk_bf16_f32 v109, v130, v131
    v_cvt_pk_bf16_f32 v110, v132, v133
    v_cvt_pk_bf16_f32 v111, v134, v135
    v_xor_b32 v108, v9, v108
    v_xor_b32 v109, v9, v109
    v_xor_b32 v110, v9, v110
    v_xor_b32 v111, v9, v111
    buffer_store_dwordx4 v[108:111], v11, s[8:11], s48 offen sc1
    s_branch P0_done
P0_g1:
    v_bfe_u32 v4, v0, 2, 2
    v_bfe_u32 v5, v0, 4, 1
    v_lshl_add_u32 v4, v4, 1, v5
    v_lshrrev_b32 v5, 5, v0
    v_lshl_add_u32 v4, v5, 3, v4
    v_mul_u32_u24 v4, 3072, v4
    v_and_b32 v6, 3, v0
    v_lshlrev_b32 v5, 1, v5
    v_xor_b32_e64 v6, v6, v5
    v_lshl_add_u32 v6, v6, 4, v4
    v_add_u32 v7, 48128, v6
    v_add_u32 v8, 96256, v6
    v_add_u32 v9, 144384, v6
    s_lshl_b32 s41, s5, 6
    s_mov_b32 s48, 196608
    s_movk_i32 s49, 3072
    s_lshl_b32 s50, s6, 2
    s_add_u32 s50, s50, s3
    s_mul_i32 s50, s50, 98304
    s_lshr_b32 s51, s5, 2
    s_lshl_b32 s51, s51, 8
    s_add_u32 s50, s50, s51
    s_branch P0_geo
P0_w1:
    v_and_b32 v10, 1, v2
    v_lshlrev_b32 v10, 5, v10
    v_and_b32_e64 v11, 3, v0
    v_lshl_add_u32 v10, v11, 3, v10
    v_bfe_u32 v11, v0, 2, 2
    v_lshl_add_u32 v10, v11, 6, v10
    v_lshl_add_u32 v10, v2, 9, v10
    v_add_u32 v10, s14, v10
    v_xor_b32 v11, 32, v10
    s_waitcnt lgkmcnt(7)
    s_waitcnt vmcnt(11)
    ds_read_b64_tr_b16 v[80:81], v10 offset:0
    ds_read_b64_tr_b16 v[82:83], v10 offset:2048
    ds_read_b64_tr_b16 v[84:85], v10 offset:256
    ds_read_b64_tr_b16 v[86:87], v10 offset:2304
    ds_read_b64_tr_b16 v[88:89], v11 offset:0
    ds_read_b64_tr_b16 v[90:91], v11 offset:2048
    ds_read_b64_tr_b16 v[92:93], v11 offset:256
    ds_read_b64_tr_b16 v[94:95], v11 offset:2304
    s_waitcnt lgkmcnt(4)
    v_mfma_f32_16x16x32_bf16 v[16:19], a[0:3], v[80:83], 0
    s_waitcnt vmcnt(6)
    ds_read_b64_tr_b16 v[96:97], v10 offset:4096
    ds_read_b64_tr_b16 v[98:99], v10 offset:6144
    ds_read_b64_tr_b16 v[100:101], v10 offset:4352
    ds_read_b64_tr_b16 v[102:103], v10 offset:6400
    v_mfma_f32_16x16x32_bf16 v[24:27], a[4:7], v[80:83], 0
    buffer_load_dwordx4 v8, s[16:19], s41 offen offset:2048 lds
    v_mfma_f32_16x16x32_bf16 v[32:35], a[8:11], v[80:83], 0
    s_waitcnt lgkmcnt(4)
    v_mfma_f32_16x16x32_bf16 v[40:43], a[12:15], v[80:83], 0
    ds_read_b128 a[32:35], v4 offset:2048
    ds_read_b128 a[36:39], v4 offset:43008
    v_mfma_f32_16x16x32_bf16 v[20:23], a[16:19], v[84:87], 0
    buffer_load_dwordx4 v9, s[16:19], s41 offen offset:3072 lds
    s_add_u32 s41, s41, s48
    s_add_u32 m0, m0, 4096
    ds_read_b128 a[40:43], v5 offset:2048
    ds_read_b128 a[44:47], v5 offset:43008
    v_mfma_f32_16x16x32_bf16 v[28:31], a[20:23], v[84:87], 0
    ds_read_b128 a[48:51], v4 offset:3072
    ds_read_b128 a[52:55], v4 offset:44032
    v_mfma_f32_16x16x32_bf16 v[36:39], a[24:27], v[84:87], 0
    ds_read_b128 a[56:59], v5 offset:3072
    ds_read_b128 a[60:63], v5 offset:44032
    v_mfma_f32_16x16x32_bf16 v[44:47], a[28:31], v[84:87], 0
    buffer_load_dwordx4 v6, s[16:19], s41 offen offset:0 lds
    s_waitcnt lgkmcnt(8)
    v_mfma_f32_16x16x32_bf16 v[48:51], a[0:3], v[88:91], 0
    ds_read_b64_tr_b16 v[104:105], v11 offset:4096
    ds_read_b64_tr_b16 v[106:107], v11 offset:6144
    ds_read_b64_tr_b16 v[108:109], v11 offset:4352
    ds_read_b64_tr_b16 v[110:111], v11 offset:6400
    v_mfma_f32_16x16x32_bf16 v[56:59], a[4:7], v[88:91], 0
    buffer_load_dwordx4 v7, s[16:19], s41 offen offset:1024 lds
    v_mfma_f32_16x16x32_bf16 v[64:67], a[8:11], v[88:91], 0
    s_waitcnt lgkmcnt(4)
    v_mfma_f32_16x16x32_bf16 v[72:75], a[12:15], v[88:91], 0
    ds_read_b128 a[64:67], v4 offset:4096
    ds_read_b128 a[68:71], v4 offset:45056
    v_mfma_f32_16x16x32_bf16 v[52:55], a[16:19], v[92:95], 0
    buffer_load_dwordx4 v8, s[16:19], s41 offen offset:2048 lds
    ds_read_b128 a[72:75], v5 offset:4096
    ds_read_b128 a[76:79], v5 offset:45056
    v_mfma_f32_16x16x32_bf16 v[60:63], a[20:23], v[92:95], 0
    ds_read_b128 a[80:83], v4 offset:5120
    ds_read_b128 a[84:87], v4 offset:46080
    v_mfma_f32_16x16x32_bf16 v[68:71], a[24:27], v[92:95], 0
    ds_read_b128 a[88:91], v5 offset:5120
    ds_read_b128 a[92:95], v5 offset:46080
    v_mfma_f32_16x16x32_bf16 v[76:79], a[28:31], v[92:95], 0
    buffer_load_dwordx4 v9, s[16:19], s41 offen offset:3072 lds
    s_add_u32 s41, s41, s48
    s_add_u32 m0, m0, 4096
    s_waitcnt lgkmcnt(8)
    v_mfma_f32_16x16x32_bf16 v[16:19], a[32:35], v[96:99], v[16:19]
    s_waitcnt vmcnt(8)
    ds_read_b64_tr_b16 v[80:81], v10 offset:8192
    ds_read_b64_tr_b16 v[82:83], v10 offset:10240
    ds_read_b64_tr_b16 v[84:85], v10 offset:8448
    ds_read_b64_tr_b16 v[86:87], v10 offset:10496
    v_mfma_f32_16x16x32_bf16 v[24:27], a[36:39], v[96:99], v[24:27]
    buffer_load_dwordx4 v6, s[16:19], s41 offen offset:0 lds
    v_mfma_f32_16x16x32_bf16 v[32:35], a[40:43], v[96:99], v[32:35]
    s_waitcnt lgkmcnt(4)
    v_mfma_f32_16x16x32_bf16 v[40:43], a[44:47], v[96:99], v[40:43]
    ds_read_b128 a[96:99], v4 offset:6144
    ds_read_b128 a[100:103], v4 offset:47104
    v_mfma_f32_16x16x32_bf16 v[20:23], a[48:51], v[100:103], v[20:23]
    buffer_load_dwordx4 v7, s[16:19], s41 offen offset:1024 lds
    ds_read_b128 a[104:107], v5 offset:6144
    ds_read_b128 a[108:111], v5 offset:47104
    v_mfma_f32_16x16x32_bf16 v[28:31], a[52:55], v[100:103], v[28:31]
    ds_read_b128 a[112:115], v4 offset:7168
    ds_read_b128 a[116:119], v4 offset:48128
    v_mfma_f32_16x16x32_bf16 v[36:39], a[56:59], v[100:103], v[36:39]
    ds_read_b128 a[120:123], v5 offset:7168
    ds_read_b128 a[124:127], v5 offset:48128
    v_mfma_f32_16x16x32_bf16 v[44:47], a[60:63], v[100:103], v[44:47]
    buffer_load_dwordx4 v8, s[16:19], s41 offen offset:2048 lds
    s_waitcnt lgkmcnt(8)
    v_mfma_f32_16x16x32_bf16 v[48:51], a[32:35], v[104:107], v[48:51]
    ds_read_b64_tr_b16 v[88:89], v11 offset:8192
    ds_read_b64_tr_b16 v[90:91], v11 offset:10240
    ds_read_b64_tr_b16 v[92:93], v11 offset:8448
    ds_read_b64_tr_b16 v[94:95], v11 offset:10496
    v_mfma_f32_16x16x32_bf16 v[56:59], a[36:39], v[104:107], v[56:59]
    buffer_load_dwordx4 v9, s[16:19], s41 offen offset:3072 lds
    s_add_u32 s41, s41, s48
    s_add_u32 m0, m0, 4096
    v_mfma_f32_16x16x32_bf16 v[64:67], a[40:43], v[104:107], v[64:67]
    s_waitcnt lgkmcnt(4)
    v_mfma_f32_16x16x32_bf16 v[72:75], a[44:47], v[104:107], v[72:75]
    ds_read_b128 a[128:131], v4 offset:8192
    ds_read_b128 a[132:135], v4 offset:49152
    v_mfma_f32_16x16x32_bf16 v[52:55], a[48:51], v[108:111], v[52:55]
    buffer_load_dwordx4 v6, s[16:19], s41 offen offset:0 lds
    ds_read_b128 a[136:139], v5 offset:8192
    ds_read_b128 a[140:143], v5 offset:49152
    v_mfma_f32_16x16x32_bf16 v[60:63], a[52:55], v[108:111], v[60:63]
    ds_read_b128 a[144:147], v4 offset:9216
    ds_read_b128 a[148:151], v4 offset:50176
    v_mfma_f32_16x16x32_bf16 v[68:71], a[56:59], v[108:111], v[68:71]
    ds_read_b128 a[152:155], v5 offset:9216
    ds_read_b128 a[156:159], v5 offset:50176
    v_mfma_f32_16x16x32_bf16 v[76:79], a[60:63], v[108:111], v[76:79]
    buffer_load_dwordx4 v7, s[16:19], s41 offen offset:1024 lds
    s_waitcnt lgkmcnt(8)
    v_mfma_f32_16x16x32_bf16 v[16:19], a[64:67], v[80:83], v[16:19]
    s_waitcnt vmcnt(10)
    ds_read_b64_tr_b16 v[96:97], v10 offset:12288
    ds_read_b64_tr_b16 v[98:99], v10 offset:14336
    ds_read_b64_tr_b16 v[100:101], v10 offset:12544
    ds_read_b64_tr_b16 v[102:103], v10 offset:14592
    v_mfma_f32_16x16x32_bf16 v[24:27], a[68:71], v[80:83], v[24:27]
    buffer_load_dwordx4 v8, s[16:19], s41 offen offset:2048 lds
    v_mfma_f32_16x16x32_bf16 v[32:35], a[72:75], v[80:83], v[32:35]
    s_waitcnt lgkmcnt(4)
    s_barrier
    v_mfma_f32_16x16x32_bf16 v[40:43], a[76:79], v[80:83], v[40:43]
    v_mfma_f32_16x16x32_bf16 v[20:23], a[80:83], v[84:87], v[20:23]
    buffer_load_dwordx4 v9, s[16:19], s41 offen offset:3072 lds
    s_add_u32 s41, s41, s48
    s_add_u32 m0, m0, 4096
    v_mfma_f32_16x16x32_bf16 v[28:31], a[84:87], v[84:87], v[28:31]
    v_mfma_f32_16x16x32_bf16 v[36:39], a[88:91], v[84:87], v[36:39]
    v_mfma_f32_16x16x32_bf16 v[44:47], a[92:95], v[84:87], v[44:47]
    buffer_load_dwordx4 v6, s[16:19], s41 offen offset:0 lds
    s_waitcnt lgkmcnt(4)
    v_mfma_f32_16x16x32_bf16 v[48:51], a[64:67], v[88:91], v[48:51]
    ds_read_b64_tr_b16 v[104:105], v11 offset:12288
    ds_read_b64_tr_b16 v[106:107], v11 offset:14336
    ds_read_b64_tr_b16 v[108:109], v11 offset:12544
    ds_read_b64_tr_b16 v[110:111], v11 offset:14592
    v_mfma_f32_16x16x32_bf16 v[56:59], a[68:71], v[88:91], v[56:59]
    buffer_load_dwordx4 v7, s[16:19], s41 offen offset:1024 lds
    v_mfma_f32_16x16x32_bf16 v[64:67], a[72:75], v[88:91], v[64:67]
    v_mfma_f32_16x16x32_bf16 v[72:75], a[76:79], v[88:91], v[72:75]
    v_mfma_f32_16x16x32_bf16 v[52:55], a[80:83], v[92:95], v[52:55]
    buffer_load_dwordx4 v8, s[16:19], s41 offen offset:2048 lds
    v_mfma_f32_16x16x32_bf16 v[60:63], a[84:87], v[92:95], v[60:63]
    v_mfma_f32_16x16x32_bf16 v[68:71], a[88:91], v[92:95], v[68:71]
    v_mfma_f32_16x16x32_bf16 v[76:79], a[92:95], v[92:95], v[76:79]
    buffer_load_dwordx4 v9, s[16:19], s41 offen offset:3072 lds
    s_add_u32 s41, s41, s48
    s_add_u32 m0, m0, 4096
    s_waitcnt lgkmcnt(4)
    v_mfma_f32_16x16x32_bf16 v[16:19], a[96:99], v[96:99], v[16:19]
    s_waitcnt vmcnt(12)
    ds_read_b64_tr_b16 v[80:81], v10 offset:16384
    ds_read_b64_tr_b16 v[82:83], v10 offset:18432
    ds_read_b64_tr_b16 v[84:85], v10 offset:16640
    ds_read_b64_tr_b16 v[86:87], v10 offset:18688
    v_mfma_f32_16x16x32_bf16 v[24:27], a[100:103], v[96:99], v[24:27]
    buffer_load_dwordx4 v6, s[16:19], s41 offen offset:0 lds
    v_mfma_f32_16x16x32_bf16 v[32:35], a[104:107], v[96:99], v[32:35]
    v_mfma_f32_16x16x32_bf16 v[40:43], a[108:111], v[96:99], v[40:43]
    v_mfma_f32_16x16x32_bf16 v[20:23], a[112:115], v[100:103], v[20:23]
    buffer_load_dwordx4 v7, s[16:19], s41 offen offset:1024 lds
    v_mfma_f32_16x16x32_bf16 v[28:31], a[116:119], v[100:103], v[28:31]
    v_mfma_f32_16x16x32_bf16 v[36:39], a[120:123], v[100:103], v[36:39]
    v_mfma_f32_16x16x32_bf16 v[44:47], a[124:127], v[100:103], v[44:47]
    buffer_load_dwordx4 v8, s[16:19], s41 offen offset:2048 lds
    s_waitcnt lgkmcnt(4)
    v_mfma_f32_16x16x32_bf16 v[48:51], a[96:99], v[104:107], v[48:51]
    ds_read_b64_tr_b16 v[88:89], v11 offset:16384
    ds_read_b64_tr_b16 v[90:91], v11 offset:18432
    ds_read_b64_tr_b16 v[92:93], v11 offset:16640
    ds_read_b64_tr_b16 v[94:95], v11 offset:18688
    v_mfma_f32_16x16x32_bf16 v[56:59], a[100:103], v[104:107], v[56:59]
    buffer_load_dwordx4 v9, s[16:19], s41 offen offset:3072 lds
    s_add_u32 s41, s41, s48
    s_add_u32 m0, m0, 4096
    v_mfma_f32_16x16x32_bf16 v[64:67], a[104:107], v[104:107], v[64:67]
    v_mfma_f32_16x16x32_bf16 v[72:75], a[108:111], v[104:107], v[72:75]
    v_mfma_f32_16x16x32_bf16 v[52:55], a[112:115], v[108:111], v[52:55]
    buffer_load_dwordx4 v6, s[16:19], s41 offen offset:0 lds
    v_mfma_f32_16x16x32_bf16 v[60:63], a[116:119], v[108:111], v[60:63]
    v_mfma_f32_16x16x32_bf16 v[68:71], a[120:123], v[108:111], v[68:71]
    v_mfma_f32_16x16x32_bf16 v[76:79], a[124:127], v[108:111], v[76:79]
    buffer_load_dwordx4 v7, s[16:19], s41 offen offset:1024 lds
    s_waitcnt lgkmcnt(4)
    v_mfma_f32_16x16x32_bf16 v[16:19], a[128:131], v[80:83], v[16:19]
    s_waitcnt vmcnt(14)
    ds_read_b64_tr_b16 v[96:97], v10 offset:20480
    ds_read_b64_tr_b16 v[98:99], v10 offset:22528
    ds_read_b64_tr_b16 v[100:101], v10 offset:20736
    ds_read_b64_tr_b16 v[102:103], v10 offset:22784
    v_mfma_f32_16x16x32_bf16 v[24:27], a[132:135], v[80:83], v[24:27]
    buffer_load_dwordx4 v8, s[16:19], s41 offen offset:2048 lds
    v_mfma_f32_16x16x32_bf16 v[32:35], a[136:139], v[80:83], v[32:35]
    v_mfma_f32_16x16x32_bf16 v[40:43], a[140:143], v[80:83], v[40:43]
    v_mfma_f32_16x16x32_bf16 v[20:23], a[144:147], v[84:87], v[20:23]
    buffer_load_dwordx4 v9, s[16:19], s41 offen offset:3072 lds
    s_add_u32 s41, s41, s48
    s_add_u32 m0, m0, 4096
    buffer_load_dword v14, v15, s[36:39], 0 offen sc1
    v_mfma_f32_16x16x32_bf16 v[28:31], a[148:151], v[84:87], v[28:31]
    v_mfma_f32_16x16x32_bf16 v[36:39], a[152:155], v[84:87], v[36:39]
    v_mfma_f32_16x16x32_bf16 v[44:47], a[156:159], v[84:87], v[44:47]
    s_waitcnt lgkmcnt(4)
    v_mfma_f32_16x16x32_bf16 v[48:51], a[128:131], v[88:91], v[48:51]
    ds_read_b64_tr_b16 v[104:105], v11 offset:20480
    ds_read_b64_tr_b16 v[106:107], v11 offset:22528
    ds_read_b64_tr_b16 v[108:109], v11 offset:20736
    ds_read_b64_tr_b16 v[110:111], v11 offset:22784
    v_mfma_f32_16x16x32_bf16 v[56:59], a[132:135], v[88:91], v[56:59]
    v_mfma_f32_16x16x32_bf16 v[64:67], a[136:139], v[88:91], v[64:67]
    v_mfma_f32_16x16x32_bf16 v[72:75], a[140:143], v[88:91], v[72:75]
    v_mfma_f32_16x16x32_bf16 v[52:55], a[144:147], v[92:95], v[52:55]
    v_mfma_f32_16x16x32_bf16 v[60:63], a[148:151], v[92:95], v[60:63]
    v_mfma_f32_16x16x32_bf16 v[68:71], a[152:155], v[92:95], v[68:71]
    v_mfma_f32_16x16x32_bf16 v[76:79], a[156:159], v[92:95], v[76:79]
    v_pk_mul_f32 v[18:19], v[18:19], -1.0 op_sel_hi:[1,0]
    v_pk_mul_f32 v[22:23], v[22:23], -1.0 op_sel_hi:[1,0]
    v_pk_mul_f32 v[26:27], v[26:27], -1.0 op_sel_hi:[1,0]
    v_pk_mul_f32 v[30:31], v[30:31], -1.0 op_sel_hi:[1,0]
    v_pk_mul_f32 v[34:35], v[34:35], -1.0 op_sel_hi:[1,0]
    v_pk_mul_f32 v[38:39], v[38:39], -1.0 op_sel_hi:[1,0]
    v_pk_mul_f32 v[42:43], v[42:43], -1.0 op_sel_hi:[1,0]
    v_pk_mul_f32 v[46:47], v[46:47], -1.0 op_sel_hi:[1,0]
    v_pk_mul_f32 v[50:51], v[50:51], -1.0 op_sel_hi:[1,0]
    v_pk_mul_f32 v[54:55], v[54:55], -1.0 op_sel_hi:[1,0]
    v_pk_mul_f32 v[58:59], v[58:59], -1.0 op_sel_hi:[1,0]
    v_pk_mul_f32 v[62:63], v[62:63], -1.0 op_sel_hi:[1,0]
    v_pk_mul_f32 v[66:67], v[66:67], -1.0 op_sel_hi:[1,0]
    v_pk_mul_f32 v[70:71], v[70:71], -1.0 op_sel_hi:[1,0]
    v_pk_mul_f32 v[74:75], v[74:75], -1.0 op_sel_hi:[1,0]
    v_pk_mul_f32 v[78:79], v[78:79], -1.0 op_sel_hi:[1,0]
    s_waitcnt lgkmcnt(4)
    v_mfma_f32_16x16x32_bf16 v[16:19], a[0:3], v[96:99], v[16:19]
    s_waitcnt vmcnt(13)
    ds_read_b64_tr_b16 v[80:81], v10 offset:24576
    ds_read_b64_tr_b16 v[82:83], v10 offset:26624
    ds_read_b64_tr_b16 v[84:85], v10 offset:24832
    ds_read_b64_tr_b16 v[86:87], v10 offset:26880
    v_mfma_f32_16x16x32_bf16 v[24:27], a[4:7], v[96:99], v[24:27]
    v_mfma_f32_16x16x32_bf16 v[32:35], a[8:11], v[96:99], v[32:35]
    v_mfma_f32_16x16x32_bf16 v[40:43], a[12:15], v[96:99], v[40:43]
    v_mfma_f32_16x16x32_bf16 v[20:23], a[16:19], v[100:103], v[20:23]
    v_mfma_f32_16x16x32_bf16 v[28:31], a[20:23], v[100:103], v[28:31]
    v_mfma_f32_16x16x32_bf16 v[36:39], a[24:27], v[100:103], v[36:39]
    v_mfma_f32_16x16x32_bf16 v[44:47], a[28:31], v[100:103], v[44:47]
    s_waitcnt lgkmcnt(4)
    v_mfma_f32_16x16x32_bf16 v[48:51], a[0:3], v[104:107], v[48:51]
    ds_read_b64_tr_b16 v[88:89], v11 offset:24576
    ds_read_b64_tr_b16 v[90:91], v11 offset:26624
    ds_read_b64_tr_b16 v[92:93], v11 offset:24832
    ds_read_b64_tr_b16 v[94:95], v11 offset:26880
    v_mfma_f32_16x16x32_bf16 v[56:59], a[4:7], v[104:107], v[56:59]
    v_mfma_f32_16x16x32_bf16 v[64:67], a[8:11], v[104:107], v[64:67]
    v_mfma_f32_16x16x32_bf16 v[72:75], a[12:15], v[104:107], v[72:75]
    v_mfma_f32_16x16x32_bf16 v[52:55], a[16:19], v[108:111], v[52:55]
    v_mfma_f32_16x16x32_bf16 v[60:63], a[20:23], v[108:111], v[60:63]
    v_mfma_f32_16x16x32_bf16 v[68:71], a[24:27], v[108:111], v[68:71]
    v_mfma_f32_16x16x32_bf16 v[76:79], a[28:31], v[108:111], v[76:79]
    s_waitcnt lgkmcnt(4)
    v_mfma_f32_16x16x32_bf16 v[16:19], a[32:35], v[80:83], v[16:19]
    s_waitcnt vmcnt(9)
    ds_read_b64_tr_b16 v[96:97], v10 offset:28672
    ds_read_b64_tr_b16 v[98:99], v10 offset:30720
    ds_read_b64_tr_b16 v[100:101], v10 offset:28928
    ds_read_b64_tr_b16 v[102:103], v10 offset:30976
    v_mfma_f32_16x16x32_bf16 v[24:27], a[36:39], v[80:83], v[24:27]
    v_mfma_f32_16x16x32_bf16 v[32:35], a[40:43], v[80:83], v[32:35]
    v_mfma_f32_16x16x32_bf16 v[40:43], a[44:47], v[80:83], v[40:43]
    v_mfma_f32_16x16x32_bf16 v[20:23], a[48:51], v[84:87], v[20:23]
    v_mfma_f32_16x16x32_bf16 v[28:31], a[52:55], v[84:87], v[28:31]
    v_mfma_f32_16x16x32_bf16 v[36:39], a[56:59], v[84:87], v[36:39]
    v_mfma_f32_16x16x32_bf16 v[44:47], a[60:63], v[84:87], v[44:47]
    s_waitcnt lgkmcnt(4)
    v_mfma_f32_16x16x32_bf16 v[48:51], a[32:35], v[88:91], v[48:51]
    ds_read_b64_tr_b16 v[104:105], v11 offset:28672
    ds_read_b64_tr_b16 v[106:107], v11 offset:30720
    ds_read_b64_tr_b16 v[108:109], v11 offset:28928
    ds_read_b64_tr_b16 v[110:111], v11 offset:30976
    v_mfma_f32_16x16x32_bf16 v[56:59], a[36:39], v[88:91], v[56:59]
    v_mfma_f32_16x16x32_bf16 v[64:67], a[40:43], v[88:91], v[64:67]
    v_mfma_f32_16x16x32_bf16 v[72:75], a[44:47], v[88:91], v[72:75]
    v_mfma_f32_16x16x32_bf16 v[52:55], a[48:51], v[92:95], v[52:55]
    v_mfma_f32_16x16x32_bf16 v[60:63], a[52:55], v[92:95], v[60:63]
    v_mfma_f32_16x16x32_bf16 v[68:71], a[56:59], v[92:95], v[68:71]
    v_mfma_f32_16x16x32_bf16 v[76:79], a[60:63], v[92:95], v[76:79]
    s_waitcnt lgkmcnt(4)
    v_mfma_f32_16x16x32_bf16 v[16:19], a[64:67], v[96:99], v[16:19]
    s_waitcnt vmcnt(5)
    ds_read_b64_tr_b16 v[80:81], v10 offset:32768
    ds_read_b64_tr_b16 v[82:83], v10 offset:34816
    ds_read_b64_tr_b16 v[84:85], v10 offset:33024
    ds_read_b64_tr_b16 v[86:87], v10 offset:35072
    v_mfma_f32_16x16x32_bf16 v[24:27], a[68:71], v[96:99], v[24:27]
    v_mfma_f32_16x16x32_bf16 v[32:35], a[72:75], v[96:99], v[32:35]
    v_mfma_f32_16x16x32_bf16 v[40:43], a[76:79], v[96:99], v[40:43]
    v_mfma_f32_16x16x32_bf16 v[20:23], a[80:83], v[100:103], v[20:23]
    v_mfma_f32_16x16x32_bf16 v[28:31], a[84:87], v[100:103], v[28:31]
    v_mfma_f32_16x16x32_bf16 v[36:39], a[88:91], v[100:103], v[36:39]
    v_mfma_f32_16x16x32_bf16 v[44:47], a[92:95], v[100:103], v[44:47]
    s_waitcnt lgkmcnt(4)
    v_mfma_f32_16x16x32_bf16 v[48:51], a[64:67], v[104:107], v[48:51]
    ds_read_b64_tr_b16 v[88:89], v11 offset:32768
    ds_read_b64_tr_b16 v[90:91], v11 offset:34816
    ds_read_b64_tr_b16 v[92:93], v11 offset:33024
    ds_read_b64_tr_b16 v[94:95], v11 offset:35072
    v_mfma_f32_16x16x32_bf16 v[56:59], a[68:71], v[104:107], v[56:59]
    v_mfma_f32_16x16x32_bf16 v[64:67], a[72:75], v[104:107], v[64:67]
    v_mfma_f32_16x16x32_bf16 v[72:75], a[76:79], v[104:107], v[72:75]
    v_mfma_f32_16x16x32_bf16 v[52:55], a[80:83], v[108:111], v[52:55]
    v_mfma_f32_16x16x32_bf16 v[60:63], a[84:87], v[108:111], v[60:63]
    v_mfma_f32_16x16x32_bf16 v[68:71], a[88:91], v[108:111], v[68:71]
    v_mfma_f32_16x16x32_bf16 v[76:79], a[92:95], v[108:111], v[76:79]
    s_waitcnt lgkmcnt(4)
    v_mfma_f32_16x16x32_bf16 v[16:19], a[96:99], v[80:83], v[16:19]
    s_waitcnt vmcnt(1)
    ds_read_b64_tr_b16 v[96:97], v10 offset:36864
    ds_read_b64_tr_b16 v[98:99], v10 offset:38912
    ds_read_b64_tr_b16 v[100:101], v10 offset:37120
    ds_read_b64_tr_b16 v[102:103], v10 offset:39168
    v_mfma_f32_16x16x32_bf16 v[24:27], a[100:103], v[80:83], v[24:27]
    v_mfma_f32_16x16x32_bf16 v[32:35], a[104:107], v[80:83], v[32:35]
    v_mfma_f32_16x16x32_bf16 v[40:43], a[108:111], v[80:83], v[40:43]
    v_mfma_f32_16x16x32_bf16 v[20:23], a[112:115], v[84:87], v[20:23]
    v_mfma_f32_16x16x32_bf16 v[28:31], a[116:119], v[84:87], v[28:31]
    v_mfma_f32_16x16x32_bf16 v[36:39], a[120:123], v[84:87], v[36:39]
    v_mfma_f32_16x16x32_bf16 v[44:47], a[124:127], v[84:87], v[44:47]
    s_waitcnt lgkmcnt(4)
    v_mfma_f32_16x16x32_bf16 v[48:51], a[96:99], v[88:91], v[48:51]
    ds_read_b64_tr_b16 v[104:105], v11 offset:36864
    ds_read_b64_tr_b16 v[106:107], v11 offset:38912
    ds_read_b64_tr_b16 v[108:109], v11 offset:37120
    ds_read_b64_tr_b16 v[110:111], v11 offset:39168
    v_mfma_f32_16x16x32_bf16 v[56:59], a[100:103], v[88:91], v[56:59]
    v_mfma_f32_16x16x32_bf16 v[64:67], a[104:107], v[88:91], v[64:67]
    v_mfma_f32_16x16x32_bf16 v[72:75], a[108:111], v[88:91], v[72:75]
    v_mfma_f32_16x16x32_bf16 v[52:55], a[112:115], v[92:95], v[52:55]
    v_mfma_f32_16x16x32_bf16 v[60:63], a[116:119], v[92:95], v[60:63]
    v_mfma_f32_16x16x32_bf16 v[68:71], a[120:123], v[92:95], v[68:71]
    v_mfma_f32_16x16x32_bf16 v[76:79], a[124:127], v[92:95], v[76:79]
    s_waitcnt lgkmcnt(4)
    v_mfma_f32_16x16x32_bf16 v[16:19], a[128:131], v[96:99], v[16:19]
    v_mfma_f32_16x16x32_bf16 v[24:27], a[132:135], v[96:99], v[24:27]
    v_mfma_f32_16x16x32_bf16 v[32:35], a[136:139], v[96:99], v[32:35]
    v_mfma_f32_16x16x32_bf16 v[40:43], a[140:143], v[96:99], v[40:43]
    v_mfma_f32_16x16x32_bf16 v[20:23], a[144:147], v[100:103], v[20:23]
    v_mfma_f32_16x16x32_bf16 v[28:31], a[148:151], v[100:103], v[28:31]
    v_mfma_f32_16x16x32_bf16 v[36:39], a[152:155], v[100:103], v[36:39]
    v_mfma_f32_16x16x32_bf16 v[44:47], a[156:159], v[100:103], v[44:47]
    s_waitcnt lgkmcnt(0)
    v_mfma_f32_16x16x32_bf16 v[48:51], a[128:131], v[104:107], v[48:51]
    v_mfma_f32_16x16x32_bf16 v[56:59], a[132:135], v[104:107], v[56:59]
    v_mfma_f32_16x16x32_bf16 v[64:67], a[136:139], v[104:107], v[64:67]
    v_mfma_f32_16x16x32_bf16 v[72:75], a[140:143], v[104:107], v[72:75]
    v_mfma_f32_16x16x32_bf16 v[52:55], a[144:147], v[108:111], v[52:55]
    v_mfma_f32_16x16x32_bf16 v[60:63], a[148:151], v[108:111], v[60:63]
    v_mfma_f32_16x16x32_bf16 v[68:71], a[152:155], v[108:111], v[68:71]
    v_mfma_f32_16x16x32_bf16 v[76:79], a[156:159], v[108:111], v[76:79]
    s_waitcnt vmcnt(0)
    v_cmp_gt_u32 vcc, 7, v14
    s_nop 1
    s_cbranch_vccnz P0_spin3
P0_rdy3:
    v_or_b32 v12, s44, v2
    v_cmp_eq_u32 vcc, 0, v12
    s_mul_i32 s48, s5, 43
    s_lshr_b32 s48, s48, 7
    s_mul_i32 s48, s48, 116736
    s_lshl_b32 s49, s5, 11
    s_add_u32 s48, s48, s49
    s_mul_i32 s49, s6, 12288
    s_add_u32 s48, s48, s49
    s_add_u32 s48, s48, 23068672
    s_add_u32 s49, s48, 61440
    s_mov_b32 s47, 0
    v_pk_add_f32 v[128:129], v[16:17], v[20:21]
    v_pk_add_f32 v[130:131], v[18:19], v[22:23] neg_lo:[1,1] neg_hi:[1,1]
    v_pk_add_f32 v[132:133], v[16:17], v[20:21] neg_lo:[0,1] neg_hi:[1,0]
    v_pk_add_f32 v[134:135], v[18:19], v[22:23] neg_lo:[1,0] neg_hi:[0,1]
    v_cndmask_b32 v12, v128, v132, vcc
    v_cndmask_b32 v132, v132, v129, vcc
    v_cndmask_b32 v129, v129, v128, vcc
    v_mov_b32 v128, v12
    v_pk_add_f32 v[136:137], v[24:25], v[28:29]
    v_pk_add_f32 v[138:139], v[26:27], v[30:31] neg_lo:[1,1] neg_hi:[1,1]
    v_pk_add_f32 v[140:141], v[24:25], v[28:29] neg_lo:[0,1] neg_hi:[1,0]
    v_pk_add_f32 v[142:143], v[26:27], v[30:31] neg_lo:[1,0] neg_hi:[0,1]
    v_cvt_pk_bf16_f32 v80, v128, v129
    v_cvt_pk_bf16_f32 v81, v130, v131
    v_cvt_pk_bf16_f32 v82, v136, v137
    v_cvt_pk_bf16_f32 v83, v138, v139
    buffer_store_dwordx4 v[80:83], v3, s[8:11], s48 offen offset:0 sc1
    v_cvt_pk_bf16_f32 v84, v132, v133
    v_cvt_pk_bf16_f32 v85, v134, v135
    v_cvt_pk_bf16_f32 v86, v140, v141
    v_cvt_pk_bf16_f32 v87, v142, v143
    buffer_store_dwordx4 v[84:87], v3, s[8:11], s49 offen offset:0 sc1
    v_pk_add_f32 v[160:161], v[48:49], v[52:53]
    v_pk_add_f32 v[162:163], v[50:51], v[54:55] neg_lo:[1,1] neg_hi:[1,1]
    v_pk_add_f32 v[164:165], v[48:49], v[52:53] neg_lo:[0,1] neg_hi:[1,0]
    v_pk_add_f32 v[166:167], v[50:51], v[54:55] neg_lo:[1,0] neg_hi:[0,1]
    v_cndmask_b32 v12, v160, v164, vcc
    v_cndmask_b32 v164, v164, v161, vcc
    v_cndmask_b32 v161, v161, v160, vcc
    v_mov_b32 v160, v12
    v_pk_add_f32 v[168:169], v[56:57], v[60:61]
    v_pk_add_f32 v[170:171], v[58:59], v[62:63] neg_lo:[1,1] neg_hi:[1,1]
    v_pk_add_f32 v[172:173], v[56:57], v[60:61] neg_lo:[0,1] neg_hi:[1,0]
    v_pk_add_f32 v[174:175], v[58:59], v[62:63] neg_lo:[1,0] neg_hi:[0,1]
    v_cvt_pk_bf16_f32 v88, v160, v161
    v_cvt_pk_bf16_f32 v89, v162, v163
    v_cvt_pk_bf16_f32 v90, v168, v169
    v_cvt_pk_bf16_f32 v91, v170, v171
    buffer_store_dwordx4 v[88:91], v3, s[8:11], s48 offen offset:1024 sc1
    v_cvt_pk_bf16_f32 v92, v164, v165
    v_cvt_pk_bf16_f32 v93, v166, v167
    v_cvt_pk_bf16_f32 v94, v172, v173
    v_cvt_pk_bf16_f32 v95, v174, v175
    buffer_store_dwordx4 v[92:95], v3, s[8:11], s49 offen offset:1024 sc1
    s_add_u32 s48, s48, 6144
    s_add_u32 s49, s49, 6144
    v_pk_add_f32 v[144:145], v[32:33], v[36:37]
    v_pk_add_f32 v[146:147], v[34:35], v[38:39] neg_lo:[1,1] neg_hi:[1,1]
    v_pk_add_f32 v[148:149], v[32:33], v[36:37] neg_lo:[0,1] neg_hi:[1,0]
    v_pk_add_f32 v[150:151], v[34:35], v[38:39] neg_lo:[1,0] neg_hi:[0,1]
    v_pk_add_f32 v[152:153], v[40:41], v[44:45]
    v_pk_add_f32 v[154:155], v[42:43], v[46:47] neg_lo:[1,1] neg_hi:[1,1]
    v_pk_add_f32 v[156:157], v[40:41], v[44:45] neg_lo:[0,1] neg_hi:[1,0]
    v_pk_add_f32 v[158:159], v[42:43], v[46:47] neg_lo:[1,0] neg_hi:[0,1]
    v_cvt_pk_bf16_f32 v96, v144, v145
    v_cvt_pk_bf16_f32 v97, v146, v147
    v_cvt_pk_bf16_f32 v98, v152, v153
    v_cvt_pk_bf16_f32 v99, v154, v155
    buffer_store_dwordx4 v[96:99], v3, s[8:11], s48 offen offset:0 sc1
    v_cvt_pk_bf16_f32 v100, v148, v149
    v_cvt_pk_bf16_f32 v101, v150, v151
    v_cvt_pk_bf16_f32 v102, v156, v157
    v_cvt_pk_bf16_f32 v103, v158, v159
    buffer_store_dwordx4 v[100:103], v3, s[8:11], s49 offen offset:0 sc1
    v_pk_add_f32 v[176:177], v[64:65], v[68:69]
    v_pk_add_f32 v[178:179], v[66:67], v[70:71] neg_lo:[1,1] neg_hi:[1,1]
    v_pk_add_f32 v[180:181], v[64:65], v[68:69] neg_lo:[0,1] neg_hi:[1,0]
    v_pk_add_f32 v[182:183], v[66:67], v[70:71] neg_lo:[1,0] neg_hi:[0,1]
    v_pk_add_f32 v[184:185], v[72:73], v[76:77]
    v_pk_add_f32 v[186:187], v[74:75], v[78:79] neg_lo:[1,1] neg_hi:[1,1]
    v_pk_add_f32 v[188:189], v[72:73], v[76:77] neg_lo:[0,1] neg_hi:[1,0]
    v_pk_add_f32 v[190:191], v[74:75], v[78:79] neg_lo:[1,0] neg_hi:[0,1]
    v_cvt_pk_bf16_f32 v104, v176, v177
    v_cvt_pk_bf16_f32 v105, v178, v179
    v_cvt_pk_bf16_f32 v106, v184, v185
    v_cvt_pk_bf16_f32 v107, v186, v187
    buffer_store_dwordx4 v[104:107], v3, s[8:11], s48 offen offset:1024 sc1
    v_cvt_pk_bf16_f32 v108, v180, v181
    v_cvt_pk_bf16_f32 v109, v182, v183
    v_cvt_pk_bf16_f32 v110, v188, v189
    v_cvt_pk_bf16_f32 v111, v190, v191
    buffer_store_dwordx4 v[108:111], v3, s[8:11], s49 offen offset:1024 sc1
    s_branch P0_done
P0_spin1:
    s_mov_b32 s40, 0
P0_sp1:
    buffer_load_dword v14, v15, s[36:39], 0 offen sc1
    s_add_u32 s40, s40, 1
    s_waitcnt vmcnt(0)
    v_cmp_gt_u32 vcc, 7, v14
    s_cmp_gt_u32 s40, 200000
    s_cbranch_scc1 P0_rdy1
    s_cbranch_vccnz P0_sp1
    s_branch P0_rdy1
P0_spin2:
    s_mov_b32 s40, 0
P0_sp2:
    buffer_load_dword v14, v15, s[36:39], 0 offen sc1
    s_add_u32 s40, s40, 1
    s_waitcnt vmcnt(0)
    v_cmp_gt_u32 vcc, 7, v14
    s_cmp_gt_u32 s40, 200000
    s_cbranch_scc1 P0_rdy2
    s_cbranch_vccnz P0_sp2
    s_branch P0_rdy2
P0_spin3:
    s_mov_b32 s40, 0
P0_sp3:
    buffer_load_dword v14, v15, s[36:39], 0 offen sc1
    s_add_u32 s40, s40, 1
    s_waitcnt vmcnt(0)
    v_cmp_gt_u32 vcc, 7, v14
    s_cmp_gt_u32 s40, 200000
    s_cbranch_scc1 P0_rdy3
    s_cbranch_vccnz P0_sp3
    s_branch P0_rdy3
P0_spare:
    s_sub_u32 s5, s5, 25
    s_lshl_b32 s5, s5, 3
    s_add_u32 s5, s5, s4
    v_mov_b32 v15, 0
    s_cmp_ge_u32 s5, 32
    s_cbranch_scc1 P0_side2
    s_and_b32 s6, s5, 3
    s_lshr_b32 s7, s5, 2
    s_lshl_b32 s12, s7, 2
    s_add_u32 s12, s12, s3
    s_lshl_b32 s12, s12, 2
    s_add_u32 s12, s12, s6
    s_mul_i32 s12, s12, 10272
    s_mul_i32 s13, s3, 11264
    s_mov_b32 m0, s13
    s_mov_b32 s26, 1314816
    s_mov_b32 s27, 0x00020000
    s_mov_b32 s30, 1314816
    s_mov_b32 s31, 0x00020000
    s_mov_b32 s14, s12
    s_waitcnt lgkmcnt(0)
    s_nop 0
    buffer_load_dwordx4 v3, s[24:27], s14 offen offset:0 lds
    buffer_load_dwordx4 v3, s[24:27], s14 offen offset:1024 lds
    buffer_load_dwordx4 v3, s[24:27], s14 offen offset:2048 lds
    buffer_load_dwordx4 v3, s[24:27], s14 offen offset:3072 lds
    s_add_u32 s14, s14, 4096
    s_add_u32 m0, m0, 4096
    s_nop 0
    s_nop 0
    buffer_load_dwordx4 v3, s[24:27], s14 offen offset:0 lds
    buffer_load_dwordx4 v3, s[24:27], s14 offen offset:1024 lds
    buffer_load_dwordx4 v3, s[24:27], s14 offen offset:2048 lds
    buffer_load_dwordx4 v3, s[24:27], s14 offen offset:3072 lds
    s_add_u32 s14, s14, 4096
    s_add_u32 m0, m0, 4096
    s_nop 0
    buffer_load_dwordx4 v3, s[24:27], s14 offen offset:0 lds
    buffer_load_dwordx4 v3, s[24:27], s14 offen offset:1024 lds
    buffer_load_dwordx4 v3, s[24:27], s14 offen offset:2048 lds
    s_mov_b32 s14, s12
    s_add_u32 m0, s13, 45056
    s_nop 0
    s_nop 0
    buffer_load_dwordx4 v3, s[28:31], s14 offen offset:0 lds
    buffer_load_dwordx4 v3, s[28:31], s14 offen offset:1024 lds
    buffer_load_dwordx4 v3, s[28:31], s14 offen offset:2048 lds
    buffer_load_dwordx4 v3, s[28:31], s14 offen offset:3072 lds
    s_add_u32 s14, s14, 4096
    s_add_u32 m0, m0, 4096
    s_nop 0
    s_nop 0
    buffer_load_dwordx4 v3, s[28:31], s14 offen offset:0 lds
    buffer_load_dwordx4 v3, s[28:31], s14 offen offset:1024 lds
    buffer_load_dwordx4 v3, s[28:31], s14 offen offset:2048 lds
    buffer_load_dwordx4 v3, s[28:31], s14 offen offset:3072 lds
    s_add_u32 s14, s14, 4096
    s_add_u32 m0, m0, 4096
    s_nop 0
    buffer_load_dwordx4 v3, s[28:31], s14 offen offset:0 lds
    buffer_load_dwordx4 v3, s[28:31], s14 offen offset:1024 lds
    buffer_load_dwordx4 v3, s[28:31], s14 offen offset:2048 lds
    v_and_b32 v4, 7, v0
    v_lshrrev_b32 v5, 3, v0
    s_and_b32 s46, s3, 1
    s_lshr_b32 s47, s3, 1
    v_lshl_add_u32 v6, v4, 1, s46
    v_mul_u32_u24 v6, 642, v6
    v_lshlrev_b32 v7, 1, v5
    v_sub_u32 v8, 640, v7
    s_cmp_eq_u32 s47, 1
    s_cselect_b64 vcc, -1, 0
    s_cselect_b32 s48, -16, 16
    s_movk_i32 s49, 640
    s_cselect_b32 s49, 320, s49
    v_cndmask_b32 v7, v7, v8, vcc
    v_add_u32 v8, v6, v7
    v_mov_b32 v9, s49
    v_cmp_eq_u32 vcc, 0, v5
    s_nop 1
    v_cndmask_b32 v7, v7, v9, vcc
    v_add_u32 v10, v6, v7
    v_lshlrev_b32 v12, 13, v5
    v_lshl_add_u32 v12, v4, 4, v12
    s_mul_i32 s50, s47, 1310720
    s_lshl_b32 s51, s46, 12
    s_add_u32 s50, s50, s51
    s_lshr_b32 s51, s6, 1
    s_lshl_b32 s51, s51, 11
    s_add_u32 s50, s50, s51
    s_lshl_b32 s51, s7, 8
    s_add_u32 s50, s50, s51
    s_and_b32 s51, s6, 1
    s_lshl_b32 s51, s51, 7
    s_add_u32 s50, s50, s51
    s_add_u32 s50, s50, 29818880
    s_mov_b32 s51, 0
    s_waitcnt vmcnt(0)
    s_barrier
    s_nop 0
P0_wl:
    v_add_u32 v11, 45056, v10
    ds_read_u16 v16, v10 offset:0
    ds_read_u16 v20, v11 offset:0
    ds_read_u16 v17, v10 offset:11264
    ds_read_u16 v21, v11 offset:11264
    ds_read_u16 v18, v10 offset:22528
    ds_read_u16 v22, v11 offset:22528
    ds_read_u16 v19, v10 offset:33792
    ds_read_u16 v23, v11 offset:33792
    v_add_u32 v8, s48, v8
    v_mov_b32 v10, v8
    s_waitcnt lgkmcnt(7)
    s_nop 0
    v_add_u32 v11, 45056, v10
    ds_read_u16 v24, v10 offset:0
    ds_read_u16 v28, v11 offset:0
    ds_read_u16 v25, v10 offset:11264
    ds_read_u16 v29, v11 offset:11264
    ds_read_u16 v26, v10 offset:22528
    ds_read_u16 v30, v11 offset:22528
    ds_read_u16 v27, v10 offset:33792
    ds_read_u16 v31, v11 offset:33792
    v_add_u32 v8, s48, v8
    v_mov_b32 v10, v8
    s_waitcnt lgkmcnt(8)
    s_nop 0
    v_lshl_or_b32 v32, v20, 16, v16
    v_lshl_or_b32 v33, v21, 16, v17
    v_lshl_or_b32 v34, v22, 16, v18
    v_lshl_or_b32 v35, v23, 16, v19
    buffer_store_dwordx4 v[32:35], v12, s[8:11], s50 offen sc1
    s_add_u32 s50, s50, 65536
    s_waitcnt lgkmcnt(0)
    s_nop 0
    v_lshl_or_b32 v36, v28, 16, v24
    v_lshl_or_b32 v37, v29, 16, v25
    v_lshl_or_b32 v38, v30, 16, v26
    v_lshl_or_b32 v39, v31, 16, v27
    buffer_store_dwordx4 v[36:39], v12, s[8:11], s50 offen sc1
    s_add_u32 s50, s50, 65536
    s_add_u32 s51, s51, 1
    s_cmp_lt_u32 s51, 10
    s_cbranch_scc1 P0_wl
    s_mov_b32 s47, 1
P0_chk:
    s_cmp_lg_u32 s3, 0
    s_cbranch_scc1 P0_done
    buffer_load_dword v14, v15, s[36:39], 0 offen sc1
    s_waitcnt vmcnt(0)
    v_cmp_gt_u32 vcc, 7, v14
    s_nop 1
    s_cbranch_vccnz P0_spin4
P0_rdy4:
    s_branch P0_done
P0_spin4:
    s_mov_b32 s40, 0
P0_sp4:
    s_sleep 16
    buffer_load_dword v14, v15, s[36:39], 0 offen sc1
    s_add_u32 s40, s40, 1
    s_waitcnt vmcnt(0)
    v_cmp_gt_u32 vcc, 7, v14
    s_cmp_gt_u32 s40, 200000
    s_cbranch_scc1 P0_rdy4
    s_cbranch_vccnz P0_sp4
    s_branch P0_rdy4
P0_side2:
    s_sub_u32 s6, s5, 32
    s_mov_b32 s7, 3
    s_mov_b32 s5, 0
    s_cmp_lt_u32 s6, 5
    s_cbranch_scc1 P0_typed
    s_mov_b32 s47, 0
    s_waitcnt lgkmcnt(0)
    s_cmp_ge_u32 s6, 12
    s_cbranch_scc1 P0_idle
    s_sub_u32 s5, s6, 5
    s_lshl_b32 s5, s5, 2
    s_add_u32 s5, s5, s3
    s_lshl_b32 s5, s5, 12
    s_add_u32 s5, s5, 32440320
    v_mov_b32 v16, 0
    v_mov_b32 v17, 0
    v_mov_b32 v18, 0
    v_mov_b32 v19, 0
    v_mov_b32_e64 v20, 1
    buffer_store_dwordx4 v[16:19], v3, s[8:11], s5 offen offset:0 sc1
    buffer_store_dwordx4 v[16:19], v3, s[8:11], s5 offen offset:1024 sc1
    buffer_store_dwordx4 v[16:19], v3, s[8:11], s5 offen offset:2048 sc1
    buffer_store_dwordx4 v[16:19], v3, s[8:11], s5 offen offset:3072 sc1
    s_waitcnt vmcnt(0)
    s_barrier
    s_cmp_lg_u32 s3, 0
    s_cbranch_scc1 P0_chk
    s_mov_b64 exec, 1
    buffer_atomic_add v20, v15, s[36:39], 0 offen sc1
    s_mov_b64 exec, -1
    s_sleep 16
    s_branch P0_chk
P0_idle:
    s_sub_u32 s12, s6, 12
    s_lshl_b32 s12, s12, 1
    s_lshr_b32 s13, s3, 1
    s_add_u32 s12, s12, s13
    s_mul_i32 s12, s12, 57344
    v_lshlrev_b32_e64 v4, 7, v0
    s_mov_b32 s26, 1314816
    s_mov_b32 s27, 0x00020000
    s_bitcmp1_b32 s3, 0
    s_cselect_b32 s24, s28, s24
    s_cselect_b32 s25, s29, s25
    s_nop 0
    buffer_load_dword v21, v4, s[24:27], s12 offen
    s_add_u32 s12, s12, 8192
    buffer_load_dword v21, v4, s[24:27], s12 offen
    s_add_u32 s12, s12, 8192
    buffer_load_dword v21, v4, s[24:27], s12 offen
    s_add_u32 s12, s12, 8192
    buffer_load_dword v21, v4, s[24:27], s12 offen
    s_add_u32 s12, s12, 8192
    buffer_load_dword v21, v4, s[24:27], s12 offen
    s_add_u32 s12, s12, 8192
    buffer_load_dword v21, v4, s[24:27], s12 offen
    s_add_u32 s12, s12, 8192
    buffer_load_dword v21, v4, s[24:27], s12 offen
    s_add_u32 s12, s12, 8192
    s_waitcnt vmcnt(0)
    s_branch P0_chk
P0_done:
    s_mov_b32 s48, 0
    s_nop 0
    s_mov_b32 s49, 2621440
    s_mov_b32 s50, 32440320
    s_mov_b32 s57, 10485760
    s_mov_b32 s58, 25034752
    s_mov_b32 s51, 245760
    s_mov_b32 s52, 32505856
    s_mov_b32 s61, 32473088
    s_mov_b32 s53, 0
    s_mov_b32 s44, s20
    s_mov_b32 s45, s21
    s_and_b32 s4, s2, 1
    s_lshl_b32 s4, s4, 3
    s_bfe_u32 s5, s2, 0x30003
    s_add_u32 s4, s4, s5
    s_mov_b32 s12, s96
    s_mov_b32 s13, s97
    s_mov_b32 s14, 3072
    s_mov_b32 s15, 0x00020000
    s_mov_b32 s28, s98
    s_mov_b32 s29, s99
    s_mov_b32 s30, 1280
    s_mov_b32 s31, 0x00020000
    s_mul_i32 s16, s4, 192
    s_and_b32 s17, s2, 1
    s_lshl_b32 s17, s17, 2
    s_bfe_u32 s18, s2, 0x20003
    s_add_u32 s17, s17, s18
    s_mul_i32 s17, s17, 160
    v_lshlrev_b32 v4, 2, v0
    buffer_load_dword a248, v4, s[12:15], s16 offen
    buffer_load_dword a249, v4, s[28:31], s17 offen
    s_mul_i32 s59, s4, 122880
    s_sub_u32 s5, s3, 1
    s_mul_i32 s5, s5, 40960
    s_mov_b32 m0, s5
    s_add_u32 s59, s59, s5
    s_add_u32 s59, s59, 23068672
KL_layer:
    s_cmp_ge_u32 s2, 160
    s_cbranch_scc1 KL_side
    s_and_b32 s4, s2, 7
    s_lshr_b32 s5, s2, 3
    s_and_b32 s6, s4, 1
    s_mul_i32 s6, s6, 983040
    s_lshl_b32 s7, s5, 2
    s_add_u32 s7, s7, s3
    s_mul_i32 s7, s7, 12288
    s_add_u32 s6, s6, s7
    s_add_u32 s6, s6, 23068672
    s_mul_i32 s4, s4, 20
    s_add_u32 s4, s4, s5
    s_lshl_b32 s5, s4, 14
    s_lshl_b32 s7, s3, 6
    s_add_u32 s7, s7, s5
    s_add_u32 s12, s7, s48
    s_add_u32 s13, s12, 4096
    s_add_u32 s14, s12, 8192
    s_add_u32 s15, s12, 12288
    s_add_u32 s28, s7, s49
    s_add_u32 s29, s28, 4096
    s_add_u32 s30, s28, 8192
    s_add_u32 s31, s28, 12288
    s_lshl_b32 s16, s3, 10
    s_add_u32 s16, s16, s50
    s_lshl_b32 s18, s3, 12
    s_add_u32 s18, s18, s5
    s_add_u32 s18, s18, 29818880
    s_lshl_b32 s19, s3, 3
    v_and_b32 v4, 1, v1
    v_lshrrev_b32 v5, 1, v1
    v_lshlrev_b32_e64 v7, 10, v2
    v_lshl_add_u32 v6, v1, 2, v7
    s_mov_b32 s20, 0x80008000
    v_mul_u32_u24 v217, 0x8000, v4
    v_lshl_or_b32 v217, v217, 16, v217
    v_xor_b32 v218, s20, v217
    v_cvt_f32_u32 v220, v1
    v_cvt_f32_u32_e64 v221, v2
    v_mul_f32 v222, 0x3d000000, v220
    v_mul_f32 v223, 4.0, v221
    v_mul_f32 v223, v223, v222
    v_cos_f32 v176, v223
    v_sin_f32 v177, v223
    v_add_f32 v223, v223, v222
    v_cos_f32 v178, v223
    v_sin_f32 v179, v223
    v_add_f32 v223, v223, v222
    v_cos_f32 v180, v223
    v_sin_f32 v181, v223
    v_add_f32 v223, v223, v222
    v_cos_f32 v182, v223
    v_sin_f32_e64 v183, v223
    v_cvt_pk_bf16_f32 v88, v176, v177
    v_cvt_pk_bf16_f32 v92, -v177, v176
    v_cvt_pk_bf16_f32 v89, v178, v179
    v_cvt_pk_bf16_f32 v93, -v179, v178
    v_cvt_pk_bf16_f32 v90, v180, v181
    v_cvt_pk_bf16_f32 v94, -v181, v180
    v_cvt_pk_bf16_f32 v91, v182, v183
    v_cvt_pk_bf16_f32 v95, -v183, v182
    v_xor_b32 v96, v217, v88
    v_xor_b32 v97, v217, v89
    v_xor_b32 v98, v217, v90
    v_xor_b32 v99, v217, v91
    v_xor_b32 v100, v217, v92
    v_xor_b32 v101, v217, v93
    v_xor_b32 v102, v217, v94
    v_xor_b32 v103, v217, v95
    v_mov_b32 v104, v88
    v_xor_b32 v105, s20, v89
    v_mov_b32 v106, v90
    v_xor_b32 v107, s20, v91
    v_mov_b32 v108, v92
    v_xor_b32 v109, s20, v93
    v_mov_b32 v110, v94
    v_xor_b32 v111, s20, v95
    v_xor_b32 v112, v217, v88
    v_xor_b32 v113, v218, v89
    v_xor_b32 v114, v217, v90
    v_xor_b32 v115, v218, v91
    v_xor_b32 v116, v217, v92
    v_xor_b32 v117, v218, v93
    v_xor_b32 v118, v217, v94
    v_xor_b32 v119, v218, v95
    v_add_f32_e64 v222, 0.5, v220
    v_mul_f32 v222, 0x3d000000, v222
    v_mul_f32 v223, 4.0, v221
    v_mul_f32 v223, v223, v222
    v_cos_f32 v176, v223
    v_sin_f32 v177, v223
    v_add_f32 v223, v223, v222
    v_cos_f32 v178, v223
    v_sin_f32 v179, v223
    v_add_f32 v223, v223, v222
    v_cos_f32 v180, v223
    v_sin_f32 v181, v223
    v_add_f32 v223, v223, v222
    v_cos_f32 v182, v223
    v_sin_f32_e64 v183, v223
    v_cvt_pk_bf16_f32 v168, v176, v177
    v_cvt_pk_bf16_f32 v172, -v177, v176
    v_cvt_pk_bf16_f32 v169, v178, v179
    v_cvt_pk_bf16_f32 v173, -v179, v178
    v_cvt_pk_bf16_f32 v170, v180, v181
    v_cvt_pk_bf16_f32 v174, -v181, v180
    v_cvt_pk_bf16_f32 v171, v182, v183
    v_cvt_pk_bf16_f32 v175, -v183, v182
    v_accvgpr_write_b32 a0, v168
    v_accvgpr_write_b32 a1, v169
    v_accvgpr_write_b32 a2, v170
    v_accvgpr_write_b32 a3, v171
    v_accvgpr_write_b32 a4, v172
    v_accvgpr_write_b32 a5, v173
    v_accvgpr_write_b32 a6, v174
    v_accvgpr_write_b32 a7, v175
    v_xor_b32_e64 v184, v217, v172
    v_accvgpr_write_b32 a8, v184
    v_xor_b32_e64 v185, v217, v173
    v_accvgpr_write_b32 a9, v185
    v_xor_b32_e64 v186, v217, v174
    v_accvgpr_write_b32 a10, v186
    v_xor_b32_e64 v187, v217, v175
    v_accvgpr_write_b32 a11, v187
    v_xor_b32_e64 v188, v218, v168
    v_accvgpr_write_b32 a12, v188
    v_xor_b32_e64 v189, v218, v169
    v_accvgpr_write_b32 a13, v189
    v_xor_b32_e64 v190, v218, v170
    v_accvgpr_write_b32 a14, v190
    v_xor_b32_e64 v191, v218, v171
    v_accvgpr_write_b32 a15, v191
    v_accvgpr_write_b32 a16, v168
    v_xor_b32_e64 v184, s20, v169
    v_accvgpr_write_b32 a17, v184
    v_accvgpr_write_b32 a18, v170
    v_xor_b32_e64 v185, s20, v171
    v_accvgpr_write_b32 a19, v185
    v_accvgpr_write_b32 a20, v172
    v_xor_b32_e64 v186, s20, v173
    v_accvgpr_write_b32 a21, v186
    v_accvgpr_write_b32 a22, v174
    v_xor_b32_e64 v187, s20, v175
    v_accvgpr_write_b32 a23, v187
    v_xor_b32_e64 v188, v217, v172
    v_accvgpr_write_b32 a24, v188
    v_xor_b32_e64 v189, v218, v173
    v_accvgpr_write_b32 a25, v189
    v_xor_b32_e64 v190, v217, v174
    v_accvgpr_write_b32 a26, v190
    v_xor_b32_e64 v191, v218, v175
    v_accvgpr_write_b32 a27, v191
    v_xor_b32_e64 v184, v218, v168
    v_accvgpr_write_b32 a28, v184
    v_xor_b32_e64 v185, v217, v169
    v_accvgpr_write_b32 a29, v185
    v_xor_b32_e64 v186, v218, v170
    v_accvgpr_write_b32 a30, v186
    v_xor_b32_e64 v187, v217, v171
    v_accvgpr_write_b32 a31, v187
    s_waitcnt vmcnt(0)
    s_barrier
    s_cmp_lg_u32 s3, 0
    s_cbranch_scc1 CA_skip
    s_sub_u32 s21, s52, 16384
    s_lshr_b32 s22, s2, 4
    s_lshl_b32 s22, s22, 7
    s_add_u32 s22, s22, s21
    v_mov_b32 v14, 1
    v_lshlrev_b32_e64 v15, 11, v0
    s_mov_b64 exec, 0xff
    buffer_atomic_add v14, v15, s[8:11], s22 offen sc1
    s_mov_b64 exec, -1
CA_skip:
    s_cmp_eq_u32 s53, 0
    s_cbranch_scc1 CA_nore
    s_nop 0
    buffer_load_dwordx4 v3, s[8:11], s59 offen offset:0 sc1 lds
    buffer_load_dwordx4 v3, s[8:11], s59 offen offset:1024 sc1 lds
    buffer_load_dwordx4 v3, s[8:11], s59 offen offset:2048 sc1 lds
    buffer_load_dwordx4 v3, s[8:11], s59 offen offset:3072 sc1 lds
    s_add_u32 m0, m0, 4096
    s_add_u32 s59, s59, 4096
    buffer_load_dwordx4 v3, s[8:11], s59 offen offset:0 sc1 lds
CA_nore:
    v_lshl_add_u32 v222, v2, 1, s19
    v_cvt_f32_u32 v222, v222
    v_add_f32 v223, 0x00000000, v220
    v_mul_f32 v223, 0x3a800000, v223
    v_mul_f32 v219, v223, v222
    v_cos_f32 v120, v219
    v_sin_f32 v128, v219
    v_add_f32 v219, v219, v223
    v_cos_f32 v121, v219
    v_sin_f32 v129, v219
    v_add_f32 v223, 0x41800000, v220
    v_mul_f32 v223, 0x3a800000, v223
    v_mul_f32 v219, v223, v222
    v_cos_f32 v122, v219
    v_sin_f32 v130, v219
    v_add_f32 v219, v219, v223
    v_cos_f32 v123, v219
    v_sin_f32 v131, v219
    v_add_f32_e64 v223, 0x3f000000, v220
    v_mul_f32 v223, 0x3a800000, v223
    v_mul_f32 v219, v223, v222
    v_cos_f32 v124, v219
    v_sin_f32 v132, v219
    v_add_f32 v219, v219, v223
    v_cos_f32 v125, v219
    v_sin_f32 v133, v219
    v_add_f32 v223, 0x41840000, v220
    v_mul_f32 v223, 0x3a800000, v223
    v_mul_f32 v219, v223, v222
    v_cos_f32 v126, v219
    v_sin_f32 v134, v219
    v_add_f32 v219, v219, v223
    v_cos_f32 v127, v219
    v_sin_f32 v135, v219
    v_and_b32 v224, 7, v1
    v_lshrrev_b32 v222, 1, v2
    s_lshl_b32 s21, s3, 1
    v_add_u32 v222, s21, v222
    v_xor_b32 v222, v222, v224
    v_lshlrev_b32 v222, 4, v222
    v_lshl_add_u32 v222, v1, 7, v222
    v_and_b32_e64 v223, 1, v2
    v_lshl_add_u32 v225, v223, 3, v222
    v_add_u32 v225, 122880, v225
    v_xor_b32 v222, v2, v224
    v_lshlrev_b32 v222, 4, v222
    v_lshl_add_u32 v223, v1, 7, v222
    s_lshl_b32 s21, s3, 12
    s_add_u32 s21, s21, 122880
    v_add_u32 v226, s21, v223
    v_xor_b32 v227, 64, v226
    s_and_b32 s21, s3, 1
    s_lshl_b32 s21, s21, 13
    s_lshr_b32 s22, s3, 1
    s_lshl_b32 s22, s22, 7
    s_add_u32 s21, s21, s22
    s_add_u32 s21, s21, 139264
    v_lshl_add_u32 v223, v1, 8, v222
    v_add_u32 v228, s21, v223
    v_xor_b32 v229, 64, v228
    v_xor_b32 v222, v2, v5
    v_lshlrev_b32 v222, 4, v222
    v_lshl_add_u32 v223, v1, 7, v222
    s_lshl_b32 s21, s3, 11
    s_add_u32 s21, s21, 139264
    v_add_u32 v230, s21, v223
    v_xor_b32 v231, 64, v230
    v_lshlrev_b32 v233, 6, v224
    v_lshrrev_b32_e64 v222, 3, v1
    v_lshl_add_u32 v233, v222, 4, v233
    v_lshl_add_u32 v233, v2, 2, v233
    s_lshl_b32 s21, s3, 9
    s_add_u32 s21, s21, 122880
    v_add_u32 v233, s21, v233
    v_add_u32 v7, s19, v5
    v_lshlrev_b32 v7, 4, v7
    v_lshl_add_u32 v7, v2, 9, v7
    v_add_u32 v7, 122880, v7
    s_mov_b32 s23, 0x45cccccd
    v_mov_b32 v236, 0x4227c5ac
    v_or_b32 v222, s4, v4
    v_cmp_eq_u32 vcc, 0, v222
    v_mov_b32 v222, 0x40000
    s_nop 0
    v_cndmask_b32 v232, 1.0, 0, vcc
    v_cndmask_b32 v216, v7, v222, vcc
    v_mul_f32 v222, 0x3d000000, v220
    v_fma_f32 v223, v221, 4.0, 0.5
    v_mul_f32 v223, v223, v222
    v_cos_f32 v176, v223
    v_sin_f32 v177, v223
    v_add_f32 v223, v223, v222
    v_cos_f32 v178, v223
    v_sin_f32 v179, v223
    v_add_f32 v223, v223, v222
    v_cos_f32 v180, v223
    v_sin_f32 v181, v223
    v_add_f32 v223, v223, v222
    v_cos_f32 v182, v223
    v_sin_f32 v183, v223
    v_cvt_pk_bf16_f32 v168, v176, v177
    v_cvt_pk_bf16_f32 v172, -v177, v176
    v_cvt_pk_bf16_f32 v169, v178, v179
    v_cvt_pk_bf16_f32 v173, -v179, v178
    v_cvt_pk_bf16_f32 v170, v180, v181
    v_cvt_pk_bf16_f32 v174, -v181, v180
    v_cvt_pk_bf16_f32 v171, v182, v183
    v_cvt_pk_bf16_f32 v175, -v183, v182
    v_accvgpr_write_b32 a32, v168
    v_accvgpr_write_b32 a33, v169
    v_accvgpr_write_b32 a34, v170
    v_accvgpr_write_b32 a35, v171
    v_accvgpr_write_b32 a36, v172
    v_accvgpr_write_b32 a37, v173
    v_accvgpr_write_b32 a38, v174
    v_accvgpr_write_b32 a39, v175
    v_xor_b32_e64 v184, v217, v168
    v_accvgpr_write_b32 a40, v184
    v_xor_b32_e64 v185, v217, v169
    v_accvgpr_write_b32 a41, v185
    v_xor_b32_e64 v186, v217, v170
    v_accvgpr_write_b32 a42, v186
    v_xor_b32_e64 v187, v217, v171
    v_accvgpr_write_b32 a43, v187
    v_xor_b32_e64 v188, v217, v172
    v_accvgpr_write_b32 a44, v188
    v_xor_b32_e64 v189, v217, v173
    v_accvgpr_write_b32 a45, v189
    v_xor_b32_e64 v190, v217, v174
    v_accvgpr_write_b32 a46, v190
    v_xor_b32_e64 v191, v217, v175
    v_accvgpr_write_b32 a47, v191
    v_accvgpr_write_b32 a48, v172
    v_xor_b32_e64 v184, s20, v173
    v_accvgpr_write_b32 a49, v184
    v_accvgpr_write_b32 a50, v174
    v_xor_b32_e64 v185, s20, v175
    v_accvgpr_write_b32 a51, v185
    v_xor_b32_e64 v186, s20, v168
    v_accvgpr_write_b32 a52, v186
    v_accvgpr_write_b32 a53, v169
    v_xor_b32_e64 v187, s20, v170
    v_accvgpr_write_b32 a54, v187
    v_accvgpr_write_b32 a55, v171
    v_xor_b32_e64 v188, v217, v172
    v_accvgpr_write_b32 a56, v188
    v_xor_b32_e64 v189, v218, v173
    v_accvgpr_write_b32 a57, v189
    v_xor_b32_e64 v190, v217, v174
    v_accvgpr_write_b32 a58, v190
    v_xor_b32_e64 v191, v218, v175
    v_accvgpr_write_b32 a59, v191
    v_xor_b32_e64 v184, v218, v168
    v_accvgpr_write_b32 a60, v184
    v_xor_b32_e64 v185, v217, v169
    v_accvgpr_write_b32 a61, v185
    v_xor_b32_e64 v186, v218, v170
    v_accvgpr_write_b32 a62, v186
    v_xor_b32_e64 v187, v217, v171
    v_accvgpr_write_b32 a63, v187
    s_and_b32 s21, s3, 1
    v_lshl_add_u32 v223, v2, 3, s21
    v_cvt_f32_u32 v223, v223
    v_add_f32_e64 v222, 0x00000000, v220
    v_mul_f32 v222, 0x3a000000, v222
    v_mul_f32 v219, v223, v222
    v_add_f32 v222, v222, v222
    v_cos_f32 v136, v219
    v_sin_f32 v152, v219
    v_add_f32 v219, v219, v222
    v_cos_f32 v137, v219
    v_sin_f32 v153, v219
    v_add_f32 v219, v219, v222
    v_cos_f32 v138, v219
    v_sin_f32 v154, v219
    v_add_f32 v219, v219, v222
    v_cos_f32 v139, v219
    v_sin_f32_e64 v155, v219
    v_add_f32 v222, 0x41800000, v220
    v_mul_f32 v222, 0x3a000000, v222
    v_mul_f32 v219, v223, v222
    v_add_f32 v222, v222, v222
    v_cos_f32 v140, v219
    v_sin_f32 v156, v219
    v_add_f32 v219, v219, v222
    v_cos_f32 v141, v219
    v_sin_f32 v157, v219
    v_add_f32 v219, v219, v222
    v_cos_f32 v142, v219
    v_sin_f32 v158, v219
    v_add_f32 v219, v219, v222
    v_cos_f32 v143, v219
    v_sin_f32_e64 v159, v219
    v_add_f32 v223, 0x42000000, v223
    v_add_f32_e64 v222, 0x00000000, v220
    v_mul_f32 v222, 0x3a000000, v222
    v_mul_f32 v219, v223, v222
    v_add_f32 v222, v222, v222
    v_cos_f32 v144, v219
    v_sin_f32 v160, v219
    v_add_f32 v219, v219, v222
    v_cos_f32 v145, v219
    v_sin_f32 v161, v219
    v_add_f32 v219, v219, v222
    v_cos_f32 v146, v219
    v_sin_f32 v162, v219
    v_add_f32 v219, v219, v222
    v_cos_f32 v147, v219
    v_sin_f32_e64 v163, v219
    v_add_f32 v222, 0x41800000, v220
    v_mul_f32 v222, 0x3a000000, v222
    v_mul_f32 v219, v223, v222
    v_add_f32 v222, v222, v222
    v_cos_f32 v148, v219
    v_sin_f32 v164, v219
    v_add_f32 v219, v219, v222
    v_cos_f32 v149, v219
    v_sin_f32 v165, v219
    v_add_f32 v219, v219, v222
    v_cos_f32 v150, v219
    v_sin_f32 v166, v219
    v_add_f32 v219, v219, v222
    v_cos_f32 v151, v219
    v_sin_f32_e64 v167, v219
    s_sub_u32 s21, s52, 16384
    s_cmp_lg_u32 s3, 0
    s_cbranch_scc1 CS_go
    s_and_b32 s22, s2, 7
    s_lshl_b32 s22, s22, 11
    s_add_u32 s22, s22, s21
    v_lshlrev_b32 v9, 7, v0
    s_mov_b64 exec, 65535
    s_mov_b32 s17, 0
CS_poll:
    buffer_load_dword v8, v9, s[8:11], s22 offen sc1
    s_add_u32 s17, s17, 1
    s_waitcnt vmcnt(0)
    v_cmp_gt_u32 vcc, 16, v8
    s_cmp_gt_u32 s17, 200000
    s_cbranch_scc1 CS_brk
    s_cbranch_vccnz CS_poll
CS_brk:
    s_mov_b64 exec, -1
CS_go:
    s_barrier
    buffer_load_dwordx4 v[40:43], v3, s[8:11], s16 offen sc1
    s_add_u32 s16, s16, 4096
    buffer_load_dwordx4 v[44:47], v3, s[8:11], s16 offen sc1
    s_add_u32 s16, s16, 4096
    buffer_load_dwordx4 v[48:51], v3, s[8:11], s16 offen sc1
    s_add_u32 s16, s16, 4096
    buffer_load_dwordx4 v[52:55], v3, s[8:11], s16 offen sc1
    s_add_u32 s16, s16, 4096
    buffer_load_dword v8, v6, s[8:11], s12 offen offset:0 sc1
    buffer_load_dword v9, v6, s[8:11], s12 offen offset:256 sc1
    buffer_load_dword v10, v6, s[8:11], s12 offen offset:512 sc1
    buffer_load_dword v11, v6, s[8:11], s12 offen offset:768 sc1
    buffer_load_dword v12, v6, s[8:11], s13 offen offset:0 sc1
    buffer_load_dword v13, v6, s[8:11], s13 offen offset:256 sc1
    buffer_load_dword v14, v6, s[8:11], s13 offen offset:512 sc1
    buffer_load_dword v15, v6, s[8:11], s13 offen offset:768 sc1
    buffer_load_dword v16, v6, s[8:11], s14 offen offset:0 sc1
    buffer_load_dword v17, v6, s[8:11], s14 offen offset:256 sc1
    buffer_load_dword v18, v6, s[8:11], s14 offen offset:512 sc1
    buffer_load_dword v19, v6, s[8:11], s14 offen offset:768 sc1
    buffer_load_dword v20, v6, s[8:11], s15 offen offset:0 sc1
    buffer_load_dword v21, v6, s[8:11], s15 offen offset:256 sc1
    buffer_load_dword v22, v6, s[8:11], s15 offen offset:512 sc1
    buffer_load_dword v23, v6, s[8:11], s15 offen offset:768 sc1
    s_waitcnt vmcnt(16)
    v_cvt_f32_f64 v200, v[40:41]
    v_cvt_f32_f64 v201, v[42:43]
    v_cvt_f32_f64 v202, v[44:45]
    v_cvt_f32_f64 v203, v[46:47]
    v_cvt_f32_f64 v204, v[48:49]
    v_cvt_f32_f64 v205, v[50:51]
    v_cvt_f32_f64 v206, v[52:53]
    v_cvt_f32_f64_e64 v207, v[54:55]
    v_fma_f32 v200, v200, s23, v236
    v_fma_f32 v201, v201, s23, v236
    v_fma_f32 v202, v202, s23, v236
    v_fma_f32 v203, v203, s23, v236
    v_fma_f32 v204, v204, s23, v236
    v_fma_f32 v205, v205, s23, v236
    v_fma_f32 v206, v206, s23, v236
    v_fma_f32 v207, v207, s23, v236
    v_rsq_f32 v200, v200
    v_rsq_f32 v201, v201
    v_rsq_f32 v202, v202
    v_rsq_f32 v203, v203
    v_rsq_f32 v204, v204
    v_rsq_f32 v205, v205
    v_rsq_f32 v206, v206
    v_rsq_f32 v207, v207
    ds_write_b32 v233, v200 offset:32768
    ds_write_b32 v233, v201 offset:32800
    ds_write_b32 v233, v202 offset:34816
    ds_write_b32 v233, v203 offset:34848
    ds_write_b32 v233, v204 offset:36864
    ds_write_b32 v233, v205 offset:36896
    ds_write_b32 v233, v206 offset:38912
    ds_write_b32 v233, v207 offset:38944
    buffer_load_dwordx4 v[56:59], v3, s[8:11], s18 offen offset:0 sc1
    buffer_load_dwordx4 v[60:63], v3, s[8:11], s18 offen offset:1024 sc1
    buffer_load_dwordx4 v[64:67], v3, s[8:11], s18 offen offset:2048 sc1
    buffer_load_dwordx4 v[68:71], v3, s[8:11], s18 offen offset:3072 sc1
    s_waitcnt lgkmcnt(0)
    s_barrier
    ds_read_b128 v[40:43], v7 offset:32768
    ds_read_b128 v[200:203], v216 offset:32768
    ds_read_b128 v[44:47], v7 offset:34816
    ds_read_b128 v[204:207], v216 offset:34816
    ds_read_b128 v[48:51], v7 offset:36864
    ds_read_b128 v[208:211], v216 offset:36864
    ds_read_b128 v[52:55], v7 offset:38912
    ds_read_b128 v[212:215], v216 offset:38912
    s_waitcnt vmcnt(12)
    v_lshlrev_b32 v24, 16, v8
    v_and_b32 v8, 0xffff0000, v8
    v_lshlrev_b32_e64 v25, 16, v9
    v_and_b32 v9, 0xffff0000, v9
    v_lshlrev_b32_e64 v26, 16, v10
    v_and_b32 v10, 0xffff0000, v10
    v_lshlrev_b32_e64 v27, 16, v11
    v_and_b32 v11, 0xffff0000, v11
    v_lshlrev_b32_e64 v28, 16, v12
    v_and_b32 v12, 0xffff0000, v12
    v_lshlrev_b32_e64 v29, 16, v13
    v_and_b32 v13, 0xffff0000, v13
    v_lshlrev_b32_e64 v30, 16, v14
    v_and_b32 v14, 0xffff0000, v14
    v_lshlrev_b32_e64 v31, 16, v15
    v_and_b32 v15, 0xffff0000, v15
    s_waitcnt lgkmcnt(4)
    s_nop 0
    v_pk_mul_f32 v[168:169], v[24:25], v[40:41]
    v_pk_mul_f32 v[176:177], v[8:9], v[200:201]
    v_pk_mul_f32 v[170:171], v[26:27], v[42:43]
    v_pk_mul_f32 v[178:179], v[10:11], v[202:203]
    v_pk_mul_f32 v[172:173], v[28:29], v[44:45]
    v_pk_mul_f32 v[180:181], v[12:13], v[204:205]
    v_pk_mul_f32 v[174:175], v[30:31], v[46:47]
    v_pk_mul_f32 v[182:183], v[14:15], v[206:207]
    s_waitcnt vmcnt(4)
    v_lshlrev_b32 v32, 16, v16
    v_and_b32 v16, 0xffff0000, v16
    v_lshlrev_b32_e64 v33, 16, v17
    v_and_b32 v17, 0xffff0000, v17
    v_lshlrev_b32_e64 v34, 16, v18
    v_and_b32 v18, 0xffff0000, v18
    v_lshlrev_b32_e64 v35, 16, v19
    v_and_b32 v19, 0xffff0000, v19
    v_lshlrev_b32_e64 v36, 16, v20
    v_and_b32 v20, 0xffff0000, v20
    v_lshlrev_b32_e64 v37, 16, v21
    v_and_b32 v21, 0xffff0000, v21
    v_lshlrev_b32_e64 v38, 16, v22
    v_and_b32 v22, 0xffff0000, v22
    v_lshlrev_b32_e64 v39, 16, v23
    v_and_b32 v23, 0xffff0000, v23
    s_waitcnt lgkmcnt(0)
    s_nop 0
    v_pk_fma_f32 v[184:185], v[32:33], v[48:49], v[168:169]
    v_pk_fma_f32 v[192:193], v[16:17], v[208:209], v[176:177]
    v_pk_fma_f32 v[168:169], v[32:33], v[48:49], v[168:169] neg_lo:[1,0,0] neg_hi:[1,0,0]
    v_pk_fma_f32 v[176:177], v[16:17], v[208:209], v[176:177] neg_lo:[1,0,0] neg_hi:[1,0,0]
    v_pk_fma_f32 v[186:187], v[34:35], v[50:51], v[170:171]
    v_pk_fma_f32 v[194:195], v[18:19], v[210:211], v[178:179]
    v_pk_fma_f32 v[170:171], v[34:35], v[50:51], v[170:171] neg_lo:[1,0,0] neg_hi:[1,0,0]
    v_pk_fma_f32 v[178:179], v[18:19], v[210:211], v[178:179] neg_lo:[1,0,0] neg_hi:[1,0,0]
    v_pk_fma_f32 v[188:189], v[36:37], v[52:53], v[172:173]
    v_pk_fma_f32 v[196:197], v[20:21], v[212:213], v[180:181]
    v_pk_fma_f32 v[172:173], v[36:37], v[52:53], v[172:173] neg_lo:[1,0,0] neg_hi:[1,0,0]
    v_pk_fma_f32 v[180:181], v[20:21], v[212:213], v[180:181] neg_lo:[1,0,0] neg_hi:[1,0,0]
    v_pk_fma_f32 v[190:191], v[38:39], v[54:55], v[174:175]
    v_pk_fma_f32 v[198:199], v[22:23], v[214:215], v[182:183]
    v_pk_fma_f32 v[174:175], v[38:39], v[54:55], v[174:175] neg_lo:[1,0,0] neg_hi:[1,0,0]
    v_pk_fma_f32 v[182:183], v[22:23], v[214:215], v[182:183] neg_lo:[1,0,0] neg_hi:[1,0,0]
    v_cvt_pk_bf16_f32 v200, v184, v192
    v_cvt_pk_bf16_f32 v201, v185, v193
    v_cvt_pk_bf16_f32 v202, v186, v194
    v_cvt_pk_bf16_f32 v203, v187, v195
    v_cvt_pk_bf16_f32 v204, v188, v196
    v_cvt_pk_bf16_f32 v205, v189, v197
    v_cvt_pk_bf16_f32 v206, v190, v198
    v_cvt_pk_bf16_f32 v207, v191, v199
    v_cvt_pk_bf16_f32 v208, v168, v176
    v_cvt_pk_bf16_f32 v209, v169, v177
    v_cvt_pk_bf16_f32 v210, v170, v178
    v_cvt_pk_bf16_f32 v211, v171, v179
    v_cvt_pk_bf16_f32 v212, v172, v180
    v_cvt_pk_bf16_f32 v213, v173, v181
    v_cvt_pk_bf16_f32 v214, v174, v182
    v_cvt_pk_bf16_f32 v215, v175, v183
    v_mfma_f32_16x16x32_bf16 v[168:171], v[200:203], v[88:91], 0
    v_mfma_f32_16x16x32_bf16 v[172:175], v[200:203], v[92:95], 0
    v_mfma_f32_16x16x32_bf16 v[168:171], v[204:207], v[96:99], v[168:171]
    v_mfma_f32_16x16x32_bf16 v[172:175], v[204:207], v[100:103], v[172:175]
    v_mfma_f32_16x16x32_bf16 v[176:179], v[200:203], v[104:107], 0
    v_mfma_f32_16x16x32_bf16 v[180:183], v[200:203], v[108:111], 0
    v_mfma_f32_16x16x32_bf16 v[176:179], v[204:207], v[112:115], v[176:179]
    v_mfma_f32_16x16x32_bf16 v[180:183], v[204:207], v[116:119], v[180:183]
    v_mfma_f32_16x16x32_bf16 v[184:187], v[208:211], a[0:3], 0
    v_mfma_f32_16x16x32_bf16 v[188:191], v[208:211], a[4:7], 0
    v_mfma_f32_16x16x32_bf16 v[184:187], v[212:215], a[8:11], v[184:187]
    v_mfma_f32_16x16x32_bf16 v[188:191], v[212:215], a[12:15], v[188:191]
    v_mfma_f32_16x16x32_bf16 v[192:195], v[208:211], a[16:19], 0
    v_mfma_f32_16x16x32_bf16 v[196:199], v[208:211], a[20:23], 0
    v_mfma_f32_16x16x32_bf16 v[192:195], v[212:215], a[24:27], v[192:195]
    v_mfma_f32_16x16x32_bf16 v[196:199], v[212:215], a[28:31], v[196:199]
    v_pk_mul_f32 v[40:41], v[168:169], v[120:121] op_sel:[0,0] op_sel_hi:[1,0]
    v_pk_mul_f32 v[44:45], v[172:173], v[120:121] op_sel:[0,0] op_sel_hi:[1,0]
    v_pk_mul_f32 v[42:43], v[170:171], v[120:121] op_sel:[0,1] op_sel_hi:[1,1]
    v_pk_mul_f32 v[46:47], v[174:175], v[120:121] op_sel:[0,1] op_sel_hi:[1,1]
    v_pk_fma_f32 v[40:41], v[172:173], v[128:129], v[40:41] op_sel:[0,0,0] op_sel_hi:[1,0,1]
    v_pk_fma_f32 v[44:45], v[168:169], v[128:129], v[44:45] op_sel:[0,0,0] op_sel_hi:[1,0,1] neg_lo:[1,0,0] neg_hi:[1,0,0]
    v_pk_fma_f32 v[42:43], v[174:175], v[128:129], v[42:43] op_sel:[0,1,0] op_sel_hi:[1,1,1]
    v_pk_fma_f32 v[46:47], v[170:171], v[128:129], v[46:47] op_sel:[0,1,0] op_sel_hi:[1,1,1] neg_lo:[1,0,0] neg_hi:[1,0,0]
    v_cvt_pk_bf16_f32 v200, v40, v44
    v_cvt_pk_bf16_f32 v202, v41, v45
    v_cvt_pk_bf16_f32 v201, v42, v46
    v_cvt_pk_bf16_f32 v203, v43, v47
    ds_write_b64 v225, v[200:201] offset:0
    ds_write_b64 v225, v[202:203] offset:8192
    v_pk_mul_f32 v[48:49], v[176:177], v[122:123] op_sel:[0,0] op_sel_hi:[1,0]
    v_pk_mul_f32 v[52:53], v[180:181], v[122:123] op_sel:[0,0] op_sel_hi:[1,0]
    v_pk_mul_f32 v[50:51], v[178:179], v[122:123] op_sel:[0,1] op_sel_hi:[1,1]
    v_pk_mul_f32 v[54:55], v[182:183], v[122:123] op_sel:[0,1] op_sel_hi:[1,1]
    v_pk_fma_f32 v[48:49], v[180:181], v[130:131], v[48:49] op_sel:[0,0,0] op_sel_hi:[1,0,1]
    v_pk_fma_f32 v[52:53], v[176:177], v[130:131], v[52:53] op_sel:[0,0,0] op_sel_hi:[1,0,1] neg_lo:[1,0,0] neg_hi:[1,0,0]
    v_pk_fma_f32 v[50:51], v[182:183], v[130:131], v[50:51] op_sel:[0,1,0] op_sel_hi:[1,1,1]
    v_pk_fma_f32 v[54:55], v[178:179], v[130:131], v[54:55] op_sel:[0,1,0] op_sel_hi:[1,1,1] neg_lo:[1,0,0] neg_hi:[1,0,0]
    v_cvt_pk_bf16_f32 v204, v48, v52
    v_cvt_pk_bf16_f32 v206, v49, v53
    v_cvt_pk_bf16_f32 v205, v50, v54
    v_cvt_pk_bf16_f32 v207, v51, v55
    ds_write_b64 v225, v[204:205] offset:2048
    ds_write_b64 v225, v[206:207] offset:10240
    v_pk_mul_f32 v[40:41], v[184:185], v[124:125] op_sel:[0,0] op_sel_hi:[1,0]
    v_pk_mul_f32 v[44:45], v[188:189], v[124:125] op_sel:[0,0] op_sel_hi:[1,0]
    v_pk_mul_f32 v[42:43], v[186:187], v[124:125] op_sel:[0,1] op_sel_hi:[1,1]
    v_pk_mul_f32 v[46:47], v[190:191], v[124:125] op_sel:[0,1] op_sel_hi:[1,1]
    v_pk_fma_f32 v[40:41], v[188:189], v[132:133], v[40:41] op_sel:[0,0,0] op_sel_hi:[1,0,1]
    v_pk_fma_f32 v[44:45], v[184:185], v[132:133], v[44:45] op_sel:[0,0,0] op_sel_hi:[1,0,1] neg_lo:[1,0,0] neg_hi:[1,0,0]
    v_pk_fma_f32 v[42:43], v[190:191], v[132:133], v[42:43] op_sel:[0,1,0] op_sel_hi:[1,1,1]
    v_pk_fma_f32 v[46:47], v[186:187], v[132:133], v[46:47] op_sel:[0,1,0] op_sel_hi:[1,1,1] neg_lo:[1,0,0] neg_hi:[1,0,0]
    v_cvt_pk_bf16_f32 v208, v40, v44
    v_cvt_pk_bf16_f32 v210, v41, v45
    v_cvt_pk_bf16_f32 v209, v42, v46
    v_cvt_pk_bf16_f32 v211, v43, v47
    ds_write_b64 v225, v[208:209] offset:4096
    ds_write_b64 v225, v[210:211] offset:12288
    v_pk_mul_f32 v[48:49], v[192:193], v[126:127] op_sel:[0,0] op_sel_hi:[1,0]
    v_pk_mul_f32 v[52:53], v[196:197], v[126:127] op_sel:[0,0] op_sel_hi:[1,0]
    v_pk_mul_f32 v[50:51], v[194:195], v[126:127] op_sel:[0,1] op_sel_hi:[1,1]
    v_pk_mul_f32 v[54:55], v[198:199], v[126:127] op_sel:[0,1] op_sel_hi:[1,1]
    v_pk_fma_f32 v[48:49], v[196:197], v[134:135], v[48:49] op_sel:[0,0,0] op_sel_hi:[1,0,1]
    v_pk_fma_f32 v[52:53], v[192:193], v[134:135], v[52:53] op_sel:[0,0,0] op_sel_hi:[1,0,1] neg_lo:[1,0,0] neg_hi:[1,0,0]
    v_pk_fma_f32 v[50:51], v[198:199], v[134:135], v[50:51] op_sel:[0,1,0] op_sel_hi:[1,1,1]
    v_pk_fma_f32 v[54:55], v[194:195], v[134:135], v[54:55] op_sel:[0,1,0] op_sel_hi:[1,1,1] neg_lo:[1,0,0] neg_hi:[1,0,0]
    v_cvt_pk_bf16_f32 v212, v48, v52
    v_cvt_pk_bf16_f32 v214, v49, v53
    v_cvt_pk_bf16_f32 v213, v50, v54
    v_cvt_pk_bf16_f32 v215, v51, v55
    ds_write_b64 v225, v[212:213] offset:6144
    ds_write_b64 v225, v[214:215] offset:14336
    s_waitcnt lgkmcnt(0)
    s_barrier
    ds_read_b128 v[200:203], v226 offset:0
    ds_read_b128 v[204:207], v227 offset:0
    ds_read_b128 v[208:211], v226 offset:2048
    ds_read_b128 v[212:215], v227 offset:2048
    s_waitcnt vmcnt(0)
    v_lshlrev_b32 v72, 16, v56
    v_and_b32 v56, 0xffff0000, v56
    v_lshlrev_b32_e64 v73, 16, v57
    v_and_b32 v57, 0xffff0000, v57
    v_lshlrev_b32_e64 v74, 16, v58
    v_and_b32 v58, 0xffff0000, v58
    v_lshlrev_b32_e64 v75, 16, v59
    v_and_b32 v59, 0xffff0000, v59
    s_waitcnt lgkmcnt(0)
    v_mfma_f32_16x16x32_bf16 v[168:171], v[88:91], v[200:203], 0
    v_lshlrev_b32 v76, 16, v60
    v_and_b32 v60, 0xffff0000, v60
    v_mfma_f32_16x16x32_bf16 v[172:175], v[92:95], v[200:203], 0
    v_lshlrev_b32_e64 v77, 16, v61
    v_and_b32 v61, 0xffff0000, v61
    v_mfma_f32_16x16x32_bf16 v[168:171], v[96:99], v[204:207], v[168:171]
    v_lshlrev_b32_e64 v78, 16, v62
    v_and_b32 v62, 0xffff0000, v62
    v_mfma_f32_16x16x32_bf16 v[172:175], v[100:103], v[204:207], v[172:175]
    v_lshlrev_b32_e64 v79, 16, v63
    v_and_b32 v63, 0xffff0000, v63
    v_mfma_f32_16x16x32_bf16 v[176:179], v[104:107], v[200:203], 0
    v_lshlrev_b32_e64 v80, 16, v64
    v_and_b32 v64, 0xffff0000, v64
    v_mfma_f32_16x16x32_bf16 v[180:183], v[108:111], v[200:203], 0
    v_lshlrev_b32_e64 v81, 16, v65
    v_and_b32 v65, 0xffff0000, v65
    v_mfma_f32_16x16x32_bf16 v[176:179], v[112:115], v[204:207], v[176:179]
    v_lshlrev_b32_e64 v82, 16, v66
    v_and_b32 v66, 0xffff0000, v66
    v_mfma_f32_16x16x32_bf16 v[180:183], v[116:119], v[204:207], v[180:183]
    v_lshlrev_b32_e64 v83, 16, v67
    v_and_b32 v67, 0xffff0000, v67
    v_mfma_f32_16x16x32_bf16 v[184:187], v[88:91], v[208:211], 0
    v_lshlrev_b32_e64 v84, 16, v68
    v_and_b32 v68, 0xffff0000, v68
    v_mfma_f32_16x16x32_bf16 v[188:191], v[92:95], v[208:211], 0
    v_lshlrev_b32_e64 v85, 16, v69
    v_and_b32 v69, 0xffff0000, v69
    v_mfma_f32_16x16x32_bf16 v[184:187], v[96:99], v[212:215], v[184:187]
    v_lshlrev_b32_e64 v86, 16, v70
    v_and_b32 v70, 0xffff0000, v70
    v_mfma_f32_16x16x32_bf16 v[188:191], v[100:103], v[212:215], v[188:191]
    v_lshlrev_b32_e64 v87, 16, v71
    v_and_b32 v71, 0xffff0000, v71
    v_mfma_f32_16x16x32_bf16 v[192:195], v[104:107], v[208:211], 0
    v_mfma_f32_16x16x32_bf16 v[196:199], v[108:111], v[208:211], 0
    v_mfma_f32_16x16x32_bf16 v[192:195], v[112:115], v[212:215], v[192:195]
    v_mfma_f32_16x16x32_bf16 v[196:199], v[116:119], v[212:215], v[196:199]
    v_pk_mul_f32 v[40:41], v[168:169], v[72:73]
    v_pk_mul_f32 v[44:45], v[172:173], v[72:73]
    v_pk_mul_f32 v[42:43], v[170:171], v[74:75]
    v_pk_mul_f32 v[46:47], v[174:175], v[74:75]
    v_pk_fma_f32 v[40:41], v[172:173], v[56:57], v[40:41] neg_lo:[1,0,0] neg_hi:[1,0,0]
    v_pk_fma_f32 v[44:45], v[168:169], v[56:57], v[44:45]
    v_pk_fma_f32 v[42:43], v[174:175], v[58:59], v[42:43] neg_lo:[1,0,0] neg_hi:[1,0,0]
    v_pk_fma_f32 v[46:47], v[170:171], v[58:59], v[46:47]
    v_cvt_pk_bf16_f32 v200, v44, v40
    v_cvt_pk_bf16_f32 v201, v45, v41
    v_cvt_pk_bf16_f32 v202, v46, v42
    v_cvt_pk_bf16_f32 v203, v47, v43
    v_pk_mul_f32 v[48:49], v[176:177], v[76:77]
    v_pk_mul_f32 v[52:53], v[180:181], v[76:77]
    v_pk_mul_f32 v[50:51], v[178:179], v[78:79]
    v_pk_mul_f32 v[54:55], v[182:183], v[78:79]
    v_pk_fma_f32 v[48:49], v[180:181], v[60:61], v[48:49] neg_lo:[1,0,0] neg_hi:[1,0,0]
    v_pk_fma_f32 v[52:53], v[176:177], v[60:61], v[52:53]
    v_pk_fma_f32 v[50:51], v[182:183], v[62:63], v[50:51] neg_lo:[1,0,0] neg_hi:[1,0,0]
    v_pk_fma_f32 v[54:55], v[178:179], v[62:63], v[54:55]
    v_cvt_pk_bf16_f32 v204, v52, v48
    v_cvt_pk_bf16_f32 v205, v53, v49
    v_cvt_pk_bf16_f32 v206, v54, v50
    v_cvt_pk_bf16_f32 v207, v55, v51
    v_pk_mul_f32 v[40:41], v[184:185], v[80:81]
    v_pk_mul_f32 v[44:45], v[188:189], v[80:81]
    v_pk_mul_f32 v[42:43], v[186:187], v[82:83]
    v_pk_mul_f32 v[46:47], v[190:191], v[82:83]
    v_pk_fma_f32 v[40:41], v[188:189], v[64:65], v[40:41] neg_lo:[1,0,0] neg_hi:[1,0,0]
    v_pk_fma_f32 v[44:45], v[184:185], v[64:65], v[44:45]
    v_pk_fma_f32 v[42:43], v[190:191], v[66:67], v[42:43] neg_lo:[1,0,0] neg_hi:[1,0,0]
    v_pk_fma_f32 v[46:47], v[186:187], v[66:67], v[46:47]
    v_cvt_pk_bf16_f32 v208, v44, v40
    v_cvt_pk_bf16_f32 v209, v45, v41
    v_cvt_pk_bf16_f32 v210, v46, v42
    v_cvt_pk_bf16_f32 v211, v47, v43
    v_pk_mul_f32 v[48:49], v[192:193], v[84:85]
    v_pk_mul_f32 v[52:53], v[196:197], v[84:85]
    v_pk_mul_f32 v[50:51], v[194:195], v[86:87]
    v_pk_mul_f32 v[54:55], v[198:199], v[86:87]
    v_pk_fma_f32 v[48:49], v[196:197], v[68:69], v[48:49] neg_lo:[1,0,0] neg_hi:[1,0,0]
    v_pk_fma_f32 v[52:53], v[192:193], v[68:69], v[52:53]
    v_pk_fma_f32 v[50:51], v[198:199], v[70:71], v[50:51] neg_lo:[1,0,0] neg_hi:[1,0,0]
    v_pk_fma_f32 v[54:55], v[194:195], v[70:71], v[54:55]
    v_cvt_pk_bf16_f32 v212, v52, v48
    v_cvt_pk_bf16_f32 v213, v53, v49
    v_cvt_pk_bf16_f32 v214, v54, v50
    v_cvt_pk_bf16_f32 v215, v55, v51
    v_mfma_f32_16x16x32_bf16 v[168:171], v[200:203], v[88:91], 0
    v_mfma_f32_16x16x32_bf16 v[172:175], v[200:203], v[92:95], 0
    v_mfma_f32_16x16x32_bf16 v[168:171], v[204:207], v[96:99], v[168:171]
    v_mfma_f32_16x16x32_bf16 v[172:175], v[204:207], v[100:103], v[172:175]
    v_mfma_f32_16x16x32_bf16 v[176:179], v[200:203], v[104:107], 0
    v_mfma_f32_16x16x32_bf16 v[180:183], v[200:203], v[108:111], 0
    v_mfma_f32_16x16x32_bf16 v[176:179], v[204:207], v[112:115], v[176:179]
    v_mfma_f32_16x16x32_bf16 v[180:183], v[204:207], v[116:119], v[180:183]
    v_mfma_f32_16x16x32_bf16 v[184:187], v[208:211], v[88:91], 0
    v_mfma_f32_16x16x32_bf16 v[188:191], v[208:211], v[92:95], 0
    v_mfma_f32_16x16x32_bf16 v[184:187], v[212:215], v[96:99], v[184:187]
    v_mfma_f32_16x16x32_bf16 v[188:191], v[212:215], v[100:103], v[188:191]
    v_mfma_f32_16x16x32_bf16 v[192:195], v[208:211], v[104:107], 0
    v_mfma_f32_16x16x32_bf16 v[196:199], v[208:211], v[108:111], 0
    v_mfma_f32_16x16x32_bf16 v[192:195], v[212:215], v[112:115], v[192:195]
    v_mfma_f32_16x16x32_bf16 v[196:199], v[212:215], v[116:119], v[196:199]
    v_pk_mul_f32 v[40:41], v[168:169], v[136:137]
    v_pk_mul_f32 v[44:45], v[172:173], v[136:137]
    v_pk_mul_f32 v[42:43], v[170:171], v[138:139]
    v_pk_mul_f32 v[46:47], v[174:175], v[138:139]
    v_pk_fma_f32 v[40:41], v[172:173], v[152:153], v[40:41]
    v_pk_fma_f32 v[44:45], v[168:169], v[152:153], v[44:45] neg_lo:[1,0,0] neg_hi:[1,0,0]
    v_pk_fma_f32 v[42:43], v[174:175], v[154:155], v[42:43]
    v_pk_fma_f32 v[46:47], v[170:171], v[154:155], v[46:47] neg_lo:[1,0,0] neg_hi:[1,0,0]
    v_cvt_pk_bf16_f32 v200, v40, v44
    v_cvt_pk_bf16_f32 v201, v41, v45
    v_cvt_pk_bf16_f32 v202, v42, v46
    v_cvt_pk_bf16_f32 v203, v43, v47
    ds_write_b128 v228, v[200:203] offset:0
    v_pk_mul_f32 v[48:49], v[176:177], v[140:141]
    v_pk_mul_f32 v[52:53], v[180:181], v[140:141]
    v_pk_mul_f32 v[50:51], v[178:179], v[142:143]
    v_pk_mul_f32 v[54:55], v[182:183], v[142:143]
    v_pk_fma_f32 v[48:49], v[180:181], v[156:157], v[48:49]
    v_pk_fma_f32 v[52:53], v[176:177], v[156:157], v[52:53] neg_lo:[1,0,0] neg_hi:[1,0,0]
    v_pk_fma_f32 v[50:51], v[182:183], v[158:159], v[50:51]
    v_pk_fma_f32 v[54:55], v[178:179], v[158:159], v[54:55] neg_lo:[1,0,0] neg_hi:[1,0,0]
    v_cvt_pk_bf16_f32 v204, v48, v52
    v_cvt_pk_bf16_f32 v205, v49, v53
    v_cvt_pk_bf16_f32 v206, v50, v54
    v_cvt_pk_bf16_f32 v207, v51, v55
    ds_write_b128 v228, v[204:207] offset:4096
    v_pk_mul_f32 v[40:41], v[184:185], v[144:145]
    v_pk_mul_f32 v[44:45], v[188:189], v[144:145]
    v_pk_mul_f32 v[42:43], v[186:187], v[146:147]
    v_pk_mul_f32 v[46:47], v[190:191], v[146:147]
    v_pk_fma_f32 v[40:41], v[188:189], v[160:161], v[40:41]
    v_pk_fma_f32 v[44:45], v[184:185], v[160:161], v[44:45] neg_lo:[1,0,0] neg_hi:[1,0,0]
    v_pk_fma_f32 v[42:43], v[190:191], v[162:163], v[42:43]
    v_pk_fma_f32 v[46:47], v[186:187], v[162:163], v[46:47] neg_lo:[1,0,0] neg_hi:[1,0,0]
    v_cvt_pk_bf16_f32 v208, v40, v44
    v_cvt_pk_bf16_f32 v209, v41, v45
    v_cvt_pk_bf16_f32 v210, v42, v46
    v_cvt_pk_bf16_f32 v211, v43, v47
    ds_write_b128 v229, v[208:211] offset:0
    v_pk_mul_f32 v[48:49], v[192:193], v[148:149]
    v_pk_mul_f32 v[52:53], v[196:197], v[148:149]
    v_pk_mul_f32 v[50:51], v[194:195], v[150:151]
    v_pk_mul_f32 v[54:55], v[198:199], v[150:151]
    v_pk_fma_f32 v[48:49], v[196:197], v[164:165], v[48:49]
    v_pk_fma_f32 v[52:53], v[192:193], v[164:165], v[52:53] neg_lo:[1,0,0] neg_hi:[1,0,0]
    v_pk_fma_f32 v[50:51], v[198:199], v[166:167], v[50:51]
    v_pk_fma_f32 v[54:55], v[194:195], v[166:167], v[54:55] neg_lo:[1,0,0] neg_hi:[1,0,0]
    v_cvt_pk_bf16_f32 v212, v48, v52
    v_cvt_pk_bf16_f32 v213, v49, v53
    v_cvt_pk_bf16_f32 v214, v50, v54
    v_cvt_pk_bf16_f32 v215, v51, v55
    ds_write_b128 v229, v[212:215] offset:4096
    s_waitcnt lgkmcnt(0)
    s_barrier
    ds_read_b128 v[200:203], v230 offset:0
    ds_read_b128 v[204:207], v231 offset:0
    ds_read_b128 v[208:211], v230 offset:8192
    ds_read_b128 v[212:215], v231 offset:8192
    s_waitcnt lgkmcnt(0)
    s_nop 0
    v_mfma_f32_16x16x32_bf16 v[168:171], v[88:91], v[200:203], 0
    v_mfma_f32_16x16x32_bf16 v[172:175], v[92:95], v[200:203], 0
    v_mfma_f32_16x16x32_bf16 v[168:171], v[96:99], v[204:207], v[168:171]
    v_mfma_f32_16x16x32_bf16 v[172:175], v[100:103], v[204:207], v[172:175]
    v_mfma_f32_16x16x32_bf16 v[176:179], v[104:107], v[200:203], 0
    v_mfma_f32_16x16x32_bf16 v[180:183], v[108:111], v[200:203], 0
    v_mfma_f32_16x16x32_bf16 v[176:179], v[112:115], v[204:207], v[176:179]
    v_mfma_f32_16x16x32_bf16 v[180:183], v[116:119], v[204:207], v[180:183]
    v_mfma_f32_16x16x32_bf16 v[184:187], a[32:35], v[208:211], 0
    v_mfma_f32_16x16x32_bf16 v[188:191], a[36:39], v[208:211], 0
    v_mfma_f32_16x16x32_bf16 v[184:187], a[40:43], v[212:215], v[184:187]
    v_mfma_f32_16x16x32_bf16 v[188:191], a[44:47], v[212:215], v[188:191]
    v_mfma_f32_16x16x32_bf16 v[192:195], a[48:51], v[208:211], 0
    v_mfma_f32_16x16x32_bf16 v[196:199], a[52:55], v[208:211], 0
    v_mfma_f32_16x16x32_bf16 v[192:195], a[56:59], v[212:215], v[192:195]
    v_mfma_f32_16x16x32_bf16 v[196:199], a[60:63], v[212:215], v[196:199]
    v_pk_add_f32 v[24:25], v[24:25], v[172:173]
    v_pk_add_f32 v[32:33], v[32:33], v[172:173]
    v_pk_fma_f32 v[8:9], v[168:169], v[232:233], v[8:9] op_sel_hi:[1,0,1]
    v_pk_fma_f32 v[16:17], v[168:169], v[232:233], v[16:17] op_sel_hi:[1,0,1]
    v_pk_add_f32 v[26:27], v[26:27], v[174:175]
    v_pk_add_f32 v[34:35], v[34:35], v[174:175]
    v_pk_fma_f32 v[10:11], v[170:171], v[232:233], v[10:11] op_sel_hi:[1,0,1]
    v_pk_fma_f32 v[18:19], v[170:171], v[232:233], v[18:19] op_sel_hi:[1,0,1]
    v_pk_add_f32 v[24:25], v[24:25], v[188:189]
    v_pk_add_f32 v[32:33], v[32:33], v[188:189] neg_lo:[0,1] neg_hi:[0,1]
    v_pk_fma_f32 v[8:9], v[184:185], v[232:233], v[8:9] op_sel_hi:[1,0,1]
    v_pk_fma_f32 v[16:17], v[184:185], v[232:233], v[16:17] op_sel_hi:[1,0,1] neg_lo:[1,0,0] neg_hi:[1,0,0]
    v_pk_add_f32 v[26:27], v[26:27], v[190:191]
    v_pk_add_f32 v[34:35], v[34:35], v[190:191] neg_lo:[0,1] neg_hi:[0,1]
    v_pk_fma_f32 v[10:11], v[186:187], v[232:233], v[10:11] op_sel_hi:[1,0,1]
    v_pk_fma_f32 v[18:19], v[186:187], v[232:233], v[18:19] op_sel_hi:[1,0,1] neg_lo:[1,0,0] neg_hi:[1,0,0]
    v_cvt_pk_bf16_f32 v200, v24, v8
    buffer_store_dword v200, v6, s[8:11], s28 offen offset:0 sc1
    v_cvt_pk_bf16_f32 v201, v25, v9
    buffer_store_dword v201, v6, s[8:11], s28 offen offset:256 sc1
    v_cvt_pk_bf16_f32 v202, v26, v10
    buffer_store_dword v202, v6, s[8:11], s28 offen offset:512 sc1
    v_cvt_pk_bf16_f32 v203, v27, v11
    buffer_store_dword v203, v6, s[8:11], s28 offen offset:768 sc1
    v_cvt_pk_bf16_f32 v208, v32, v16
    buffer_store_dword v208, v6, s[8:11], s30 offen offset:0 sc1
    v_cvt_pk_bf16_f32 v209, v33, v17
    buffer_store_dword v209, v6, s[8:11], s30 offen offset:256 sc1
    v_cvt_pk_bf16_f32 v210, v34, v18
    buffer_store_dword v210, v6, s[8:11], s30 offen offset:512 sc1
    v_cvt_pk_bf16_f32 v211, v35, v19
    buffer_store_dword v211, v6, s[8:11], s30 offen offset:768 sc1
    v_pk_add_f32 v[28:29], v[28:29], v[180:181]
    v_pk_add_f32 v[36:37], v[36:37], v[180:181]
    v_pk_fma_f32 v[12:13], v[176:177], v[232:233], v[12:13] op_sel_hi:[1,0,1]
    v_pk_fma_f32 v[20:21], v[176:177], v[232:233], v[20:21] op_sel_hi:[1,0,1]
    v_pk_add_f32 v[30:31], v[30:31], v[182:183]
    v_pk_add_f32 v[38:39], v[38:39], v[182:183]
    v_pk_fma_f32 v[14:15], v[178:179], v[232:233], v[14:15] op_sel_hi:[1,0,1]
    v_pk_fma_f32 v[22:23], v[178:179], v[232:233], v[22:23] op_sel_hi:[1,0,1]
    v_pk_add_f32 v[28:29], v[28:29], v[196:197]
    v_pk_add_f32 v[36:37], v[36:37], v[196:197] neg_lo:[0,1] neg_hi:[0,1]
    v_pk_fma_f32 v[12:13], v[192:193], v[232:233], v[12:13] op_sel_hi:[1,0,1]
    v_pk_fma_f32 v[20:21], v[192:193], v[232:233], v[20:21] op_sel_hi:[1,0,1] neg_lo:[1,0,0] neg_hi:[1,0,0]
    v_pk_add_f32 v[30:31], v[30:31], v[198:199]
    v_pk_add_f32 v[38:39], v[38:39], v[198:199] neg_lo:[0,1] neg_hi:[0,1]
    v_pk_fma_f32 v[14:15], v[194:195], v[232:233], v[14:15] op_sel_hi:[1,0,1]
    v_pk_fma_f32 v[22:23], v[194:195], v[232:233], v[22:23] op_sel_hi:[1,0,1] neg_lo:[1,0,0] neg_hi:[1,0,0]
    v_cvt_pk_bf16_f32 v204, v28, v12
    buffer_store_dword v204, v6, s[8:11], s29 offen offset:0 sc1
    v_cvt_pk_bf16_f32 v205, v29, v13
    buffer_store_dword v205, v6, s[8:11], s29 offen offset:256 sc1
    v_cvt_pk_bf16_f32 v206, v30, v14
    buffer_store_dword v206, v6, s[8:11], s29 offen offset:512 sc1
    v_cvt_pk_bf16_f32 v207, v31, v15
    buffer_store_dword v207, v6, s[8:11], s29 offen offset:768 sc1
    v_cvt_pk_bf16_f32 v212, v36, v20
    buffer_store_dword v212, v6, s[8:11], s31 offen offset:0 sc1
    v_cvt_pk_bf16_f32 v213, v37, v21
    buffer_store_dword v213, v6, s[8:11], s31 offen offset:256 sc1
    v_cvt_pk_bf16_f32 v214, v38, v22
    buffer_store_dword v214, v6, s[8:11], s31 offen offset:512 sc1
    v_cvt_pk_bf16_f32 v215, v39, v23
    buffer_store_dword v215, v6, s[8:11], s31 offen offset:768 sc1
    v_add_u32 v4, 61440, v3
    v_lshlrev_b32_e64 v5, 14, v2
    v_lshl_add_u32 v5, v1, 4, v5
    v_add_u32 v9, 4096, v3
    s_and_b32 s4, s2, 7
    s_lshr_b32 s5, s2, 3
    s_lshr_b32 s6, s4, 1
    s_lshl_b32 s6, s6, 2
    s_lshr_b32 s7, s5, 3
    s_add_u32 s6, s6, s7
    s_and_b32 s4, s4, 1
    s_lshl_b32 s7, s4, 3
    s_and_b32 s16, s5, 7
    s_add_u32 s7, s7, s16
    s_lshl_b32 s16, s6, 2
    s_add_u32 s16, s16, s3
    s_mul_i32 s20, s16, 98304
    s_lshl_b32 s16, s16, 8
    s_add_u32 s16, s16, s49
    s_mul_i32 s19, s7, 192
    s_mul_i32 s21, s7, 3072
    s_add_u32 s20, s20, s21
    s_add_u32 s20, s20, s57
    s_add_u32 s21, s20, 49152
    s_lshl_b32 s56, s6, 7
    s_add_u32 s56, s56, s61
    s_lshl_b32 s4, s4, 2
    s_and_b32 s17, s5, 3
    s_add_u32 s4, s4, s17
    s_lshl_b32 s6, s6, 1
    s_bfe_u32 s17, s5, 0x10002
    s_add_u32 s6, s6, s17
    s_mul_i32 s54, s4, s51
    s_add_u32 s54, s54, s58
    s_mul_i32 s55, s3, 25600
    s_add_u32 s55, s55, s54
    s_add_u32 s55, s55, 245760
    s_mul_i32 s17, s3, 61440
    s_add_u32 s54, s54, s17
    s_add_u32 s60, s54, 51200
    s_cmp_eq_u32 s3, 0
    s_cbranch_scc1 KL_arr
    s_cmp_eq_u32 s53, 1
    s_cbranch_scc1 KL_l1a
    s_nop 0
    buffer_load_dwordx4 v3, s[8:11], s59 offen offset:0 sc1 lds
    buffer_load_dwordx4 v3, s[8:11], s59 offen offset:1024 sc1 lds
    buffer_load_dwordx4 v3, s[8:11], s59 offen offset:2048 sc1 lds
    buffer_load_dwordx4 v3, s[8:11], s59 offen offset:3072 sc1 lds
    s_add_u32 m0, m0, 4096
    s_add_u32 s59, s59, 4096
    buffer_load_dwordx4 v3, s[8:11], s59 offen offset:0 sc1 lds
    buffer_load_dwordx4 v3, s[8:11], s59 offen offset:1024 sc1 lds
    buffer_load_dwordx4 v3, s[8:11], s59 offen offset:2048 sc1 lds
    buffer_load_dwordx4 v3, s[8:11], s59 offen offset:3072 sc1 lds
    s_add_u32 m0, m0, 4096
    s_add_u32 s59, s59, 4096
    buffer_load_dwordx4 v3, s[8:11], s59 offen offset:0 sc1 lds
    buffer_load_dwordx4 v3, s[8:11], s59 offen offset:1024 sc1 lds
    buffer_load_dwordx4 v3, s[8:11], s59 offen offset:2048 sc1 lds
    buffer_load_dwordx4 v3, s[8:11], s59 offen offset:3072 sc1 lds
    s_add_u32 m0, m0, 4096
    s_add_u32 s59, s59, 4096
    buffer_load_dwordx4 v3, s[8:11], s59 offen offset:0 sc1 lds
    buffer_load_dwordx4 v3, s[8:11], s59 offen offset:1024 sc1 lds
    buffer_load_dwordx4 v3, s[8:11], s59 offen offset:2048 sc1 lds
    buffer_load_dwordx4 v3, s[8:11], s59 offen offset:3072 sc1 lds
    s_add_u32 m0, m0, 4096
    s_add_u32 s59, s59, 4096
    s_waitcnt vmcnt(16)
    s_barrier
KL_dma2:
    buffer_load_dwordx4 v3, s[8:11], s59 offen offset:0 sc1 lds
    buffer_load_dwordx4 v3, s[8:11], s59 offen offset:1024 sc1 lds
    buffer_load_dwordx4 v3, s[8:11], s59 offen offset:2048 sc1 lds
    buffer_load_dwordx4 v3, s[8:11], s59 offen offset:3072 sc1 lds
    s_add_u32 m0, m0, 4096
    s_add_u32 s59, s59, 4096
    buffer_load_dwordx4 v3, s[8:11], s59 offen offset:0 sc1 lds
    buffer_load_dwordx4 v3, s[8:11], s59 offen offset:1024 sc1 lds
    buffer_load_dwordx4 v3, s[8:11], s59 offen offset:2048 sc1 lds
    buffer_load_dwordx4 v3, s[8:11], s59 offen offset:3072 sc1 lds
    s_add_u32 m0, m0, 4096
    s_add_u32 s59, s59, 4096
    buffer_load_dwordx4 v3, s[8:11], s59 offen offset:0 sc1 lds
    buffer_load_dwordx4 v3, s[8:11], s59 offen offset:1024 sc1 lds
    buffer_load_dwordx4 v3, s[8:11], s59 offen offset:2048 sc1 lds
    buffer_load_dwordx4 v3, s[8:11], s59 offen offset:3072 sc1 lds
    s_add_u32 m0, m0, 4096
    s_add_u32 s59, s59, 4096
    buffer_load_dwordx4 v3, s[8:11], s59 offen offset:0 sc1 lds
    buffer_load_dwordx4 v3, s[8:11], s59 offen offset:1024 sc1 lds
    buffer_load_dwordx4 v3, s[8:11], s59 offen offset:2048 sc1 lds
    buffer_load_dwordx4 v3, s[8:11], s59 offen offset:3072 sc1 lds
    s_add_u32 m0, m0, 4096
    s_add_u32 s59, s59, 4096
    buffer_load_dwordx4 v3, s[8:11], s59 offen offset:0 sc1 lds
    buffer_load_dwordx4 v3, s[8:11], s59 offen offset:1024 sc1 lds
    buffer_load_dwordx4 v3, s[8:11], s59 offen offset:2048 sc1 lds
    buffer_load_dwordx4 v3, s[8:11], s59 offen offset:3072 sc1 lds
    s_add_u32 m0, m0, 4096
    s_add_u32 s59, s59, 4096
    buffer_load_dwordx4 v3, s[8:11], s59 offen offset:0 sc1 lds
    buffer_load_dwordx4 v3, s[8:11], s59 offen offset:1024 sc1 lds
    buffer_load_dwordx4 v3, s[8:11], s59 offen offset:2048 sc1 lds
    buffer_load_dwordx4 v3, s[8:11], s59 offen offset:3072 sc1 lds
    s_add_u32 m0, m0, 4096
    s_add_u32 s59, s59, 4096
    s_branch KL_join
    s_nop 0
KL_l1a:
    buffer_load_dwordx4 a[200:203], v3, s[8:11], s60 offen offset:0 sc1
    buffer_load_dwordx4 a[204:207], v3, s[8:11], s60 offen offset:1024 sc1
    buffer_load_dwordx4 a[208:211], v3, s[8:11], s60 offen offset:2048 sc1
    buffer_load_dwordx4 a[212:215], v3, s[8:11], s60 offen offset:3072 sc1
    buffer_load_dwordx4 a[216:219], v9, s[8:11], s60 offen sc1
    s_add_u32 s60, s60, 5120
    buffer_load_dwordx4 a[220:223], v3, s[8:11], s60 offen offset:0 sc1
    buffer_load_dwordx4 a[224:227], v3, s[8:11], s60 offen offset:1024 sc1
    buffer_load_dwordx4 a[228:231], v3, s[8:11], s60 offen offset:2048 sc1
    buffer_load_dwordx4 a[232:235], v3, s[8:11], s60 offen offset:3072 sc1
    buffer_load_dwordx4 a[236:239], v9, s[8:11], s60 offen sc1
    s_add_u32 s60, s60, 5120
    s_waitcnt vmcnt(10)
    s_barrier
    s_branch KL_l1c
KL_arr:
    s_waitcnt vmcnt(0)
    s_barrier
KL_arr1:
    s_and_b32 s22, s2, 7
    s_lshl_b32 s22, s22, 7
    s_add_u32 s22, s22, s52
    s_add_u32 s23, s52, 2048
    v_mov_b32 v14, 1
    v_mov_b32 v13, 1
    v_lshlrev_b32 v15, 7, v0
    s_mov_b64 exec, 1
    buffer_atomic_add v14, v15, s[8:11], s22 offen sc0 sc1
    s_waitcnt vmcnt(0)
    v_cmp_eq_u32 vcc, 31, v14
    s_mov_b64 exec, 0xff
    s_nop 1
    s_cbranch_vccz KL_notlast
    buffer_atomic_add v13, v15, s[8:11], s23 offen sc1
KL_notlast:
    s_mov_b64 exec, -1
KL_arr2:
    s_cmp_eq_u32 s53, 0
    s_cbranch_scc1 KL_join
    s_nop 0
KL_l1b:
    buffer_load_dwordx4 a[200:203], v3, s[8:11], s60 offen offset:0 sc1
    buffer_load_dwordx4 a[204:207], v3, s[8:11], s60 offen offset:1024 sc1
    buffer_load_dwordx4 a[208:211], v3, s[8:11], s60 offen offset:2048 sc1
    buffer_load_dwordx4 a[212:215], v3, s[8:11], s60 offen offset:3072 sc1
    buffer_load_dwordx4 a[216:219], v9, s[8:11], s60 offen sc1
    s_add_u32 s60, s60, 5120
    buffer_load_dwordx4 a[220:223], v3, s[8:11], s60 offen offset:0 sc1
    buffer_load_dwordx4 a[224:227], v3, s[8:11], s60 offen offset:1024 sc1
    buffer_load_dwordx4 a[228:231], v3, s[8:11], s60 offen offset:2048 sc1
    buffer_load_dwordx4 a[232:235], v3, s[8:11], s60 offen offset:3072 sc1
    buffer_load_dwordx4 a[236:239], v9, s[8:11], s60 offen sc1
    s_add_u32 s60, s60, 5120
KL_l1c:
    s_mul_i32 s17, s3, 10240
    s_add_u32 m0, s17, 122880
    s_add_u32 s59, s55, 5120
    buffer_load_dwordx4 v3, s[8:11], s59 offen offset:0 sc1 lds
    buffer_load_dwordx4 v3, s[8:11], s59 offen offset:1024 sc1 lds
    buffer_load_dwordx4 v3, s[8:11], s59 offen offset:2048 sc1 lds
    buffer_load_dwordx4 v3, s[8:11], s59 offen offset:3072 sc1 lds
    s_add_u32 m0, m0, 4096
    s_add_u32 s59, s59, 4096
    buffer_load_dwordx4 v3, s[8:11], s59 offen offset:0 sc1 lds
    buffer_load_dwordx4 v3, s[8:11], s59 offen offset:1024 sc1 lds
    buffer_load_dwordx4 v3, s[8:11], s59 offen offset:2048 sc1 lds
    buffer_load_dwordx4 v3, s[8:11], s59 offen offset:3072 sc1 lds
    s_add_u32 m0, m0, 4096
    s_add_u32 s59, s59, 4096
    buffer_load_dwordx4 v3, s[8:11], s59 offen offset:0 sc1 lds
    buffer_load_dwordx4 v3, s[8:11], s59 offen offset:1024 sc1 lds
KL_join:
    s_mov_b32 s32, s100
    s_mov_b32 s33, s101
    v_add_u32 v6, 65536, v5
    v_lshlrev_b32 v7, 3, v2
    v_cmp_eq_u32 vcc, 0, v2
    v_mov_b32 v8, 0xffff
    s_nop 0
    v_cndmask_b32 v8, -1, v8, vcc
    s_mov_b32 s34, 2621440
    s_mov_b32 s35, 0x00020000
    s_mul_i32 s40, s4, 160
    v_accvgpr_read_b32 v224, a248
    buffer_load_dwordx4 a[0:3], v3, s[8:11], s54 offen offset:0 sc1
    buffer_load_dwordx4 a[4:7], v3, s[8:11], s54 offen offset:1024 sc1
    buffer_load_dwordx4 a[8:11], v3, s[8:11], s54 offen offset:2048 sc1
    buffer_load_dwordx4 a[12:15], v3, s[8:11], s54 offen offset:3072 sc1
    buffer_load_dwordx4 a[16:19], v9, s[8:11], s54 offen sc1
    s_add_u32 s54, s54, 5120
    buffer_load_dwordx4 a[20:23], v3, s[8:11], s54 offen offset:0 sc1
    buffer_load_dwordx4 a[24:27], v3, s[8:11], s54 offen offset:1024 sc1
    buffer_load_dwordx4 a[28:31], v3, s[8:11], s54 offen offset:2048 sc1
    buffer_load_dwordx4 a[32:35], v3, s[8:11], s54 offen offset:3072 sc1
    buffer_load_dwordx4 a[36:39], v9, s[8:11], s54 offen sc1
    s_add_u32 s54, s54, 5120
    buffer_load_dwordx4 a[40:43], v3, s[8:11], s54 offen offset:0 sc1
    buffer_load_dwordx4 a[44:47], v3, s[8:11], s54 offen offset:1024 sc1
    buffer_load_dwordx4 a[48:51], v3, s[8:11], s54 offen offset:2048 sc1
    buffer_load_dwordx4 a[52:55], v3, s[8:11], s54 offen offset:3072 sc1
    buffer_load_dwordx4 a[56:59], v9, s[8:11], s54 offen sc1
    s_add_u32 s54, s54, 5120
    buffer_load_dwordx4 a[60:63], v3, s[8:11], s54 offen offset:0 sc1
    s_mul_i32 s22, s3, 12288
    s_lshl_b32 s23, s6, 2
    s_and_b32 s47, s3, 1
    s_mul_i32 s18, s3, 655360
    s_add_u32 s18, s18, s49
    s_xor_b32 s17, s3, 0
    s_add_u32 s17, s17, s23
    s_mul_i32 s24, s17, 49152
    s_add_u32 s24, s24, s22
    s_add_u32 s24, s24, s57
    s_lshr_b32 s36, s17, 1
    s_mov_b32 s46, s36
    s_lshl_b32 s36, s36, 8
    s_and_b32 s17, s17, 1
    s_lshl_b32 s17, s17, 16
    s_add_u32 s36, s36, s17
    s_add_u32 s36, s36, s18
    s_xor_b32 s17, s3, 1
    s_add_u32 s17, s17, s23
    s_mul_i32 s25, s17, 49152
    s_add_u32 s25, s25, s22
    s_add_u32 s25, s25, s57
    s_lshr_b32 s37, s17, 1
    s_lshl_b32 s37, s37, 8
    s_and_b32 s17, s17, 1
    s_lshl_b32 s17, s17, 16
    s_add_u32 s37, s37, s17
    s_add_u32 s37, s37, s18
    s_xor_b32 s17, s3, 2
    s_add_u32 s17, s17, s23
    s_mul_i32 s26, s17, 49152
    s_add_u32 s26, s26, s22
    s_add_u32 s26, s26, s57
    s_lshr_b32 s38, s17, 1
    s_lshl_b32 s38, s38, 8
    s_and_b32 s17, s17, 1
    s_lshl_b32 s17, s17, 16
    s_add_u32 s38, s38, s17
    s_add_u32 s38, s38, s18
    s_xor_b32 s17, s3, 3
    s_add_u32 s17, s17, s23
    s_mul_i32 s27, s17, 49152
    s_add_u32 s27, s27, s22
    s_add_u32 s27, s27, s57
    s_lshr_b32 s39, s17, 1
    s_lshl_b32 s39, s39, 8
    s_and_b32 s17, s17, 1
    s_lshl_b32 s17, s17, 16
    s_add_u32 s39, s39, s17
    s_add_u32 s39, s39, s18
    s_cmp_eq_u32 s53, 1
    s_cbranch_scc1 SU2_done
    s_mul_i32 s37, s4, 327680
    s_lshl_b32 s17, s46, 8
    s_add_u32 s37, s37, s17
    s_add_u32 s44, s37, 5242880
    s_add_u32 s37, s37, s49
    s_add_u32 s38, s37, 65536
    s_add_u32 s36, s37, 131072
    s_add_u32 s39, s37, 196608
    s_mul_i32 s55, s4, 5120
    s_add_u32 s55, s55, 32571392
    s_lshl_b32 s42, s47, 15
    s_add_u32 s42, s42, s44
    s_add_u32 s42, s42, 131072
    s_mul_i32 s43, s47, 196608
    s_add_u32 s44, s44, s43
    s_add_u32 s43, s44, 65536
    s_lshl_b32 s45, s47, 7
    s_add_u32 s45, s45, s17
    s_add_u32 s45, s45, 32456704
SU2_done:
    ds_bpermute_b32 v228, v7, v224 offset:0
    ds_bpermute_b32 v229, v7, v224 offset:4
    ds_bpermute_b32 v230, v7, v224 offset:32
    ds_bpermute_b32 v231, v7, v224 offset:36
    ds_bpermute_b32 v232, v7, v224 offset:64
    ds_bpermute_b32 v233, v7, v224 offset:68
    ds_bpermute_b32 v234, v7, v224 offset:96
    ds_bpermute_b32 v235, v7, v224 offset:100
    v_mov_b32 v10, 1
    s_cmp_eq_u32 s3, 0
    s_cselect_b32 s17, 0, 0x20000000
    v_mov_b32_e64 v11, s17
    v_mov_b32 v12, 0xc0135761
    v_lshrrev_b32_e64 v13, 2, v1
    v_lshl_add_u32 v13, v13, 4, v1
    v_lshlrev_b32 v13, 2, v13
    s_waitcnt lgkmcnt(0)
    v_lshlrev_b32_e64 v208, 16, v228
    v_and_b32 v209, 0xffff0000, v228
    v_lshlrev_b32_e64 v210, 16, v229
    v_and_b32 v211, 0xffff0000, v229
    v_lshlrev_b32_e64 v212, 16, v230
    v_and_b32 v213, 0xffff0000, v230
    v_lshlrev_b32_e64 v214, 16, v231
    v_and_b32 v215, 0xffff0000, v231
    v_lshlrev_b32_e64 v216, 16, v232
    v_and_b32 v217, 0xffff0000, v232
    v_lshlrev_b32_e64 v218, 16, v233
    v_and_b32 v219, 0xffff0000, v233
    v_lshlrev_b32_e64 v220, 16, v234
    v_and_b32 v221, 0xffff0000, v234
    v_lshlrev_b32_e64 v222, 16, v235
    v_and_b32 v223, 0xffff0000, v235
    s_and_b32 s22, s2, 7
    s_lshl_b32 s22, s22, 7
    s_add_u32 s22, s22, s52
    s_add_u32 s22, s22, 2048
    s_cmp_lg_u32 s3, 0
    s_cbranch_scc1 GS_go
    s_mov_b64 exec, 1
    v_mov_b32 v15, 0
    s_mov_b32 s17, 0
GS_poll:
    buffer_load_dword v14, v15, s[8:11], s22 offen sc1
    s_add_u32 s17, s17, 1
    s_waitcnt vmcnt(0)
    v_cmp_le_u32 vcc, 8, v14
    s_cmp_gt_u32 s17, 200000
    s_cbranch_scc1 GS_brk
    s_cbranch_vccz GS_poll
GS_brk:
    s_mov_b64 exec, -1
GS_go:
    s_waitcnt vmcnt(16)
    s_barrier
    buffer_load_dwordx4 v[16:19], v5, s[8:11], s16 offen sc1
    buffer_load_dwordx4 v[20:23], v6, s[8:11], s16 offen sc1
    s_add_u32 s16, s16, 131072
    buffer_load_dwordx4 v[24:27], v5, s[8:11], s16 offen sc1
    buffer_load_dwordx4 v[28:31], v6, s[8:11], s16 offen sc1
    s_add_u32 s16, s16, 131072
    buffer_load_dwordx4 v[32:35], v5, s[8:11], s16 offen sc1
    buffer_load_dwordx4 v[36:39], v6, s[8:11], s16 offen sc1
    s_add_u32 s16, s16, 131072
    buffer_load_dwordx4 v[40:43], v5, s[8:11], s16 offen sc1
    buffer_load_dwordx4 v[44:47], v6, s[8:11], s16 offen sc1
    s_add_u32 s16, s16, 131072
    buffer_load_dwordx4 v[48:51], v5, s[8:11], s16 offen sc1
    buffer_load_dwordx4 v[52:55], v6, s[8:11], s16 offen sc1
    s_add_u32 s16, s16, 131072
    buffer_load_dwordx4 v[56:59], v5, s[8:11], s16 offen sc1
    buffer_load_dwordx4 v[60:63], v6, s[8:11], s16 offen sc1
    s_add_u32 s16, s16, 131072
    buffer_load_dwordx4 v[64:67], v5, s[8:11], s16 offen sc1
    buffer_load_dwordx4 v[68:71], v6, s[8:11], s16 offen sc1
    s_add_u32 s16, s16, 131072
    ds_read_b128 v[224:227], v3 offset:0
    ds_read_b128 v[228:231], v3 offset:1024
    ds_read_b128 v[232:235], v3 offset:2048
    ds_read_b128 v[236:239], v3 offset:3072
    ds_read_b128 v[240:243], v3 offset:6144
    ds_read_b128 v[244:247], v3 offset:7168
    s_waitcnt vmcnt(12)
    v_swap_b32 v18, v20
    v_swap_b32 v19, v21
    v_and_b32 v16, v8, v16
    v_and_b32 v20, v8, v20
    s_waitcnt lgkmcnt(4)
    v_mfma_f32_16x16x32_bf16 v[176:179], v[224:227], v[16:19], 0
    ds_read_b128 v[248:251], v3 offset:8192
    v_mfma_f32_16x16x32_bf16 v[192:195], v[224:227], v[20:23], 0
    buffer_load_dwordx4 v[72:75], v5, s[8:11], s16 offen sc1
    v_mfma_f32_16x16x32_bf16 v[180:183], v[228:231], v[16:19], 0
    ds_read_b128 v[252:255], v3 offset:9216
    v_mfma_f32_16x16x32_bf16 v[196:199], v[228:231], v[20:23], 0
    buffer_load_dwordx4 v[76:79], v6, s[8:11], s16 offen sc1
    s_add_u32 s16, s16, 131072
    v_mfma_f32_16x16x32_bf16 a[240:243], v[16:19], v[16:19], 0
    s_waitcnt lgkmcnt(4)
    v_mfma_f32_16x16x32_bf16 v[184:187], v[232:235], v[16:19], 0
    ds_read_b128 v[224:227], v3 offset:12288
    v_mfma_f32_16x16x32_bf16 v[200:203], v[232:235], v[20:23], 0
    s_waitcnt vmcnt(12)
    v_swap_b32 v26, v28
    v_mfma_f32_16x16x32_bf16 v[188:191], v[236:239], v[16:19], 0
    ds_read_b128 v[228:231], v3 offset:13312
    v_mfma_f32_16x16x32_bf16 v[204:207], v[236:239], v[20:23], 0
    v_swap_b32 v27, v29
    v_mfma_f32_16x16x32_bf16 a[244:247], v[20:23], v[20:23], 0
    s_waitcnt lgkmcnt(4)
    v_mfma_f32_16x16x32_bf16 v[176:179], v[240:243], v[24:27], v[176:179]
    ds_read_b128 v[232:235], v3 offset:14336
    v_mfma_f32_16x16x32_bf16 v[192:195], v[240:243], v[28:31], v[192:195]
    buffer_load_dwordx4 v[80:83], v5, s[8:11], s16 offen sc1
    v_mfma_f32_16x16x32_bf16 v[180:183], v[244:247], v[24:27], v[180:183]
    ds_read_b128 v[236:239], v3 offset:15360
    v_mfma_f32_16x16x32_bf16 v[196:199], v[244:247], v[28:31], v[196:199]
    buffer_load_dwordx4 v[84:87], v6, s[8:11], s16 offen sc1
    s_add_u32 s16, s16, 131072
    v_mfma_f32_16x16x32_bf16 a[240:243], v[24:27], v[24:27], a[240:243]
    s_waitcnt lgkmcnt(4)
    v_mfma_f32_16x16x32_bf16 v[184:187], v[248:251], v[24:27], v[184:187]
    ds_read_b128 v[240:243], v3 offset:18432
    v_mfma_f32_16x16x32_bf16 v[200:203], v[248:251], v[28:31], v[200:203]
    s_waitcnt vmcnt(12)
    v_swap_b32 v34, v36
    v_mfma_f32_16x16x32_bf16 v[188:191], v[252:255], v[24:27], v[188:191]
    ds_read_b128 v[244:247], v3 offset:19456
    v_mfma_f32_16x16x32_bf16 v[204:207], v[252:255], v[28:31], v[204:207]
    v_swap_b32 v35, v37
    v_mfma_f32_16x16x32_bf16 a[244:247], v[28:31], v[28:31], a[244:247]
    s_waitcnt lgkmcnt(4)
    v_mfma_f32_16x16x32_bf16 v[176:179], v[224:227], v[32:35], v[176:179]
    ds_read_b128 v[248:251], v3 offset:20480
    v_mfma_f32_16x16x32_bf16 v[192:195], v[224:227], v[36:39], v[192:195]
    buffer_load_dwordx4 v[88:91], v5, s[8:11], s16 offen sc1
    v_mfma_f32_16x16x32_bf16 v[180:183], v[228:231], v[32:35], v[180:183]
    ds_read_b128 v[252:255], v3 offset:21504
    v_mfma_f32_16x16x32_bf16 v[196:199], v[228:231], v[36:39], v[196:199]
    buffer_load_dwordx4 v[92:95], v6, s[8:11], s16 offen sc1
    s_add_u32 s16, s16, 131072
    v_mfma_f32_16x16x32_bf16 a[240:243], v[32:35], v[32:35], a[240:243]
    s_waitcnt lgkmcnt(4)
    v_mfma_f32_16x16x32_bf16 v[184:187], v[232:235], v[32:35], v[184:187]
    ds_read_b128 v[224:227], v3 offset:24576
    v_mfma_f32_16x16x32_bf16 v[200:203], v[232:235], v[36:39], v[200:203]
    s_waitcnt vmcnt(12)
    v_swap_b32 v42, v44
    v_mfma_f32_16x16x32_bf16 v[188:191], v[236:239], v[32:35], v[188:191]
    ds_read_b128 v[228:231], v3 offset:25600
    v_mfma_f32_16x16x32_bf16 v[204:207], v[236:239], v[36:39], v[204:207]
    v_swap_b32 v43, v45
    v_mfma_f32_16x16x32_bf16 a[244:247], v[36:39], v[36:39], a[244:247]
    s_waitcnt lgkmcnt(4)
    v_mfma_f32_16x16x32_bf16 v[176:179], v[240:243], v[40:43], v[176:179]
    ds_read_b128 v[232:235], v3 offset:26624
    v_mfma_f32_16x16x32_bf16 v[192:195], v[240:243], v[44:47], v[192:195]
    buffer_load_dwordx4 v[96:99], v5, s[8:11], s16 offen sc1
    v_mfma_f32_16x16x32_bf16 v[180:183], v[244:247], v[40:43], v[180:183]
    ds_read_b128 v[236:239], v3 offset:27648
    v_mfma_f32_16x16x32_bf16 v[196:199], v[244:247], v[44:47], v[196:199]
    buffer_load_dwordx4 v[100:103], v6, s[8:11], s16 offen sc1
    s_add_u32 s16, s16, 131072
    v_mfma_f32_16x16x32_bf16 a[240:243], v[40:43], v[40:43], a[240:243]
    s_waitcnt lgkmcnt(4)
    v_mfma_f32_16x16x32_bf16 v[184:187], v[248:251], v[40:43], v[184:187]
    ds_read_b128 v[240:243], v3 offset:30720
    v_mfma_f32_16x16x32_bf16 v[200:203], v[248:251], v[44:47], v[200:203]
    s_waitcnt vmcnt(12)
    v_swap_b32 v50, v52
    v_mfma_f32_16x16x32_bf16 v[188:191], v[252:255], v[40:43], v[188:191]
    ds_read_b128 v[244:247], v3 offset:31744
    v_mfma_f32_16x16x32_bf16 v[204:207], v[252:255], v[44:47], v[204:207]
    v_swap_b32 v51, v53
    v_mfma_f32_16x16x32_bf16 a[244:247], v[44:47], v[44:47], a[244:247]
    s_waitcnt lgkmcnt(4)
    v_mfma_f32_16x16x32_bf16 v[176:179], v[224:227], v[48:51], v[176:179]
    ds_read_b128 v[248:251], v3 offset:32768
    v_mfma_f32_16x16x32_bf16 v[192:195], v[224:227], v[52:55], v[192:195]
    buffer_load_dwordx4 v[104:107], v5, s[8:11], s16 offen sc1
    v_mfma_f32_16x16x32_bf16 v[180:183], v[228:231], v[48:51], v[180:183]
    ds_read_b128 v[252:255], v3 offset:33792
    v_mfma_f32_16x16x32_bf16 v[196:199], v[228:231], v[52:55], v[196:199]
    buffer_load_dwordx4 v[108:111], v6, s[8:11], s16 offen sc1
    s_add_u32 s16, s16, 131072
    v_mfma_f32_16x16x32_bf16 a[240:243], v[48:51], v[48:51], a[240:243]
    s_waitcnt lgkmcnt(4)
    v_mfma_f32_16x16x32_bf16 v[184:187], v[232:235], v[48:51], v[184:187]
    ds_read_b128 v[224:227], v3 offset:36864
    v_mfma_f32_16x16x32_bf16 v[200:203], v[232:235], v[52:55], v[200:203]
    s_waitcnt vmcnt(12)
    v_swap_b32 v58, v60
    v_mfma_f32_16x16x32_bf16 v[188:191], v[236:239], v[48:51], v[188:191]
    ds_read_b128 v[228:231], v3 offset:37888
    v_mfma_f32_16x16x32_bf16 v[204:207], v[236:239], v[52:55], v[204:207]
    v_swap_b32 v59, v61
    v_mfma_f32_16x16x32_bf16 a[244:247], v[52:55], v[52:55], a[244:247]
    s_waitcnt lgkmcnt(4)
    v_mfma_f32_16x16x32_bf16 v[176:179], v[240:243], v[56:59], v[176:179]
    ds_read_b128 v[232:235], v3 offset:38912
    v_mfma_f32_16x16x32_bf16 v[192:195], v[240:243], v[60:63], v[192:195]
    buffer_load_dwordx4 v[112:115], v5, s[8:11], s16 offen sc1
    v_mfma_f32_16x16x32_bf16 v[180:183], v[244:247], v[56:59], v[180:183]
    ds_read_b128 v[236:239], v3 offset:39936
    v_mfma_f32_16x16x32_bf16 v[196:199], v[244:247], v[60:63], v[196:199]
    buffer_load_dwordx4 v[116:119], v6, s[8:11], s16 offen sc1
    s_add_u32 s16, s16, 131072
    v_mfma_f32_16x16x32_bf16 a[240:243], v[56:59], v[56:59], a[240:243]
    s_waitcnt lgkmcnt(4)
    v_mfma_f32_16x16x32_bf16 v[184:187], v[248:251], v[56:59], v[184:187]
    ds_read_b128 v[240:243], v3 offset:43008
    v_mfma_f32_16x16x32_bf16 v[200:203], v[248:251], v[60:63], v[200:203]
    s_waitcnt vmcnt(12)
    v_swap_b32 v66, v68
    v_mfma_f32_16x16x32_bf16 v[188:191], v[252:255], v[56:59], v[188:191]
    ds_read_b128 v[244:247], v3 offset:44032
    v_mfma_f32_16x16x32_bf16 v[204:207], v[252:255], v[60:63], v[204:207]
    v_swap_b32 v67, v69
    v_mfma_f32_16x16x32_bf16 a[244:247], v[60:63], v[60:63], a[244:247]
    s_waitcnt lgkmcnt(4)
    v_mfma_f32_16x16x32_bf16 v[176:179], v[224:227], v[64:67], v[176:179]
    ds_read_b128 v[248:251], v3 offset:45056
    v_mfma_f32_16x16x32_bf16 v[192:195], v[224:227], v[68:71], v[192:195]
    buffer_load_dwordx4 v[120:123], v5, s[8:11], s16 offen sc1
    v_mfma_f32_16x16x32_bf16 v[180:183], v[228:231], v[64:67], v[180:183]
    ds_read_b128 v[252:255], v3 offset:46080
    v_mfma_f32_16x16x32_bf16 v[196:199], v[228:231], v[68:71], v[196:199]
    buffer_load_dwordx4 v[124:127], v6, s[8:11], s16 offen sc1
    s_add_u32 s16, s16, 131072
    v_mfma_f32_16x16x32_bf16 a[240:243], v[64:67], v[64:67], a[240:243]
    s_waitcnt lgkmcnt(4)
    v_mfma_f32_16x16x32_bf16 v[184:187], v[232:235], v[64:67], v[184:187]
    ds_read_b128 v[224:227], v3 offset:49152
    v_mfma_f32_16x16x32_bf16 v[200:203], v[232:235], v[68:71], v[200:203]
    s_waitcnt vmcnt(12)
    v_swap_b32 v74, v76
    v_mfma_f32_16x16x32_bf16 v[188:191], v[236:239], v[64:67], v[188:191]
    ds_read_b128 v[228:231], v3 offset:50176
    v_mfma_f32_16x16x32_bf16 v[204:207], v[236:239], v[68:71], v[204:207]
    v_swap_b32 v75, v77
    v_mfma_f32_16x16x32_bf16 a[244:247], v[68:71], v[68:71], a[244:247]
    s_waitcnt lgkmcnt(4)
    v_mfma_f32_16x16x32_bf16 v[176:179], v[240:243], v[72:75], v[176:179]
    ds_read_b128 v[232:235], v3 offset:51200
    v_mfma_f32_16x16x32_bf16 v[192:195], v[240:243], v[76:79], v[192:195]
    buffer_load_dwordx4 v[128:131], v5, s[8:11], s16 offen sc1
    v_mfma_f32_16x16x32_bf16 v[180:183], v[244:247], v[72:75], v[180:183]
    ds_read_b128 v[236:239], v3 offset:52224
    v_mfma_f32_16x16x32_bf16 v[196:199], v[244:247], v[76:79], v[196:199]
    buffer_load_dwordx4 v[132:135], v6, s[8:11], s16 offen sc1
    s_add_u32 s16, s16, 131072
    v_mfma_f32_16x16x32_bf16 a[240:243], v[72:75], v[72:75], a[240:243]
    s_waitcnt lgkmcnt(4)
    v_mfma_f32_16x16x32_bf16 v[184:187], v[248:251], v[72:75], v[184:187]
    ds_read_b128 v[240:243], v3 offset:55296
    v_mfma_f32_16x16x32_bf16 v[200:203], v[248:251], v[76:79], v[200:203]
    s_waitcnt vmcnt(12)
    v_swap_b32 v82, v84
    v_mfma_f32_16x16x32_bf16 v[188:191], v[252:255], v[72:75], v[188:191]
    ds_read_b128 v[244:247], v3 offset:56320
    v_mfma_f32_16x16x32_bf16 v[204:207], v[252:255], v[76:79], v[204:207]
    v_swap_b32 v83, v85
    v_mfma_f32_16x16x32_bf16 a[244:247], v[76:79], v[76:79], a[244:247]
    s_waitcnt lgkmcnt(4)
    v_mfma_f32_16x16x32_bf16 v[176:179], v[224:227], v[80:83], v[176:179]
    ds_read_b128 v[248:251], v3 offset:57344
    v_mfma_f32_16x16x32_bf16 v[192:195], v[224:227], v[84:87], v[192:195]
    buffer_load_dwordx4 v[136:139], v5, s[8:11], s16 offen sc1
    v_mfma_f32_16x16x32_bf16 v[180:183], v[228:231], v[80:83], v[180:183]
    ds_read_b128 v[252:255], v3 offset:58368
    v_mfma_f32_16x16x32_bf16 v[196:199], v[228:231], v[84:87], v[196:199]
    buffer_load_dwordx4 v[140:143], v6, s[8:11], s16 offen sc1
    s_add_u32 s16, s16, 131072
    v_mfma_f32_16x16x32_bf16 a[240:243], v[80:83], v[80:83], a[240:243]
    s_waitcnt lgkmcnt(4)
    v_mfma_f32_16x16x32_bf16 v[184:187], v[232:235], v[80:83], v[184:187]
    ds_read_b128 v[224:227], v4 offset:0
    v_mfma_f32_16x16x32_bf16 v[200:203], v[232:235], v[84:87], v[200:203]
    s_waitcnt vmcnt(12)
    v_swap_b32 v90, v92
    v_mfma_f32_16x16x32_bf16 v[188:191], v[236:239], v[80:83], v[188:191]
    ds_read_b128 v[228:231], v4 offset:1024
    v_mfma_f32_16x16x32_bf16 v[204:207], v[236:239], v[84:87], v[204:207]
    v_swap_b32 v91, v93
    v_mfma_f32_16x16x32_bf16 a[244:247], v[84:87], v[84:87], a[244:247]
    s_waitcnt lgkmcnt(4)
    v_mfma_f32_16x16x32_bf16 v[176:179], v[240:243], v[88:91], v[176:179]
    ds_read_b128 v[232:235], v4 offset:2048
    v_mfma_f32_16x16x32_bf16 v[192:195], v[240:243], v[92:95], v[192:195]
    buffer_load_dwordx4 v[144:147], v5, s[8:11], s16 offen sc1
    v_mfma_f32_16x16x32_bf16 v[180:183], v[244:247], v[88:91], v[180:183]
    ds_read_b128 v[236:239], v4 offset:3072
    v_mfma_f32_16x16x32_bf16 v[196:199], v[244:247], v[92:95], v[196:199]
    buffer_load_dwordx4 v[148:151], v6, s[8:11], s16 offen sc1
    s_add_u32 s16, s16, 131072
    v_mfma_f32_16x16x32_bf16 a[240:243], v[88:91], v[88:91], a[240:243]
    s_waitcnt lgkmcnt(4)
    v_mfma_f32_16x16x32_bf16 v[184:187], v[248:251], v[88:91], v[184:187]
    ds_read_b128 v[240:243], v4 offset:6144
    v_mfma_f32_16x16x32_bf16 v[200:203], v[248:251], v[92:95], v[200:203]
    s_waitcnt vmcnt(12)
    v_swap_b32 v98, v100
    v_mfma_f32_16x16x32_bf16 v[188:191], v[252:255], v[88:91], v[188:191]
    ds_read_b128 v[244:247], v4 offset:7168
    v_mfma_f32_16x16x32_bf16 v[204:207], v[252:255], v[92:95], v[204:207]
    v_swap_b32 v99, v101
    v_mfma_f32_16x16x32_bf16 a[244:247], v[92:95], v[92:95], a[244:247]
    s_waitcnt lgkmcnt(4)
    v_mfma_f32_16x16x32_bf16 v[176:179], v[224:227], v[96:99], v[176:179]
    ds_read_b128 v[248:251], v4 offset:8192
    v_mfma_f32_16x16x32_bf16 v[192:195], v[224:227], v[100:103], v[192:195]
    buffer_load_dwordx4 v[152:155], v5, s[8:11], s16 offen sc1
    v_mfma_f32_16x16x32_bf16 v[180:183], v[228:231], v[96:99], v[180:183]
    ds_read_b128 v[252:255], v4 offset:9216
    v_mfma_f32_16x16x32_bf16 v[196:199], v[228:231], v[100:103], v[196:199]
    buffer_load_dwordx4 v[156:159], v6, s[8:11], s16 offen sc1
    s_add_u32 s16, s16, 131072
    v_mfma_f32_16x16x32_bf16 a[240:243], v[96:99], v[96:99], a[240:243]
    s_waitcnt lgkmcnt(4)
    v_mfma_f32_16x16x32_bf16 v[184:187], v[232:235], v[96:99], v[184:187]
    ds_read_b128 v[224:227], v4 offset:12288
    v_mfma_f32_16x16x32_bf16 v[200:203], v[232:235], v[100:103], v[200:203]
    s_waitcnt vmcnt(12)
    v_swap_b32 v106, v108
    v_mfma_f32_16x16x32_bf16 v[188:191], v[236:239], v[96:99], v[188:191]
    ds_read_b128 v[228:231], v4 offset:13312
    v_mfma_f32_16x16x32_bf16 v[204:207], v[236:239], v[100:103], v[204:207]
    v_swap_b32 v107, v109
    v_mfma_f32_16x16x32_bf16 a[244:247], v[100:103], v[100:103], a[244:247]
    s_waitcnt lgkmcnt(4)
    v_mfma_f32_16x16x32_bf16 v[176:179], v[240:243], v[104:107], v[176:179]
    ds_read_b128 v[232:235], v4 offset:14336
    v_mfma_f32_16x16x32_bf16 v[192:195], v[240:243], v[108:111], v[192:195]
    buffer_load_dwordx4 v[160:163], v5, s[8:11], s16 offen sc1
    v_mfma_f32_16x16x32_bf16 v[180:183], v[244:247], v[104:107], v[180:183]
    ds_read_b128 v[236:239], v4 offset:15360
    v_mfma_f32_16x16x32_bf16 v[196:199], v[244:247], v[108:111], v[196:199]
    buffer_load_dwordx4 v[164:167], v6, s[8:11], s16 offen sc1
    s_add_u32 s16, s16, 131072
    v_mfma_f32_16x16x32_bf16 a[240:243], v[104:107], v[104:107], a[240:243]
    s_waitcnt lgkmcnt(4)
    v_mfma_f32_16x16x32_bf16 v[184:187], v[248:251], v[104:107], v[184:187]
    ds_read_b128 v[240:243], v4 offset:18432
    v_mfma_f32_16x16x32_bf16 v[200:203], v[248:251], v[108:111], v[200:203]
    s_waitcnt vmcnt(12)
    v_swap_b32 v114, v116
    v_mfma_f32_16x16x32_bf16 v[188:191], v[252:255], v[104:107], v[188:191]
    ds_read_b128 v[244:247], v4 offset:19456
    v_mfma_f32_16x16x32_bf16 v[204:207], v[252:255], v[108:111], v[204:207]
    v_swap_b32 v115, v117
    v_mfma_f32_16x16x32_bf16 a[244:247], v[108:111], v[108:111], a[244:247]
    s_waitcnt lgkmcnt(4)
    v_mfma_f32_16x16x32_bf16 v[176:179], v[224:227], v[112:115], v[176:179]
    ds_read_b128 v[248:251], v4 offset:20480
    v_mfma_f32_16x16x32_bf16 v[192:195], v[224:227], v[116:119], v[192:195]
    buffer_load_dwordx4 v[168:171], v5, s[8:11], s16 offen sc1
    v_mfma_f32_16x16x32_bf16 v[180:183], v[228:231], v[112:115], v[180:183]
    ds_read_b128 v[252:255], v4 offset:21504
    v_mfma_f32_16x16x32_bf16 v[196:199], v[228:231], v[116:119], v[196:199]
    buffer_load_dwordx4 v[172:175], v6, s[8:11], s16 offen sc1
    s_add_u32 s16, s16, 131072
    v_mfma_f32_16x16x32_bf16 a[240:243], v[112:115], v[112:115], a[240:243]
    s_waitcnt lgkmcnt(4)
    v_mfma_f32_16x16x32_bf16 v[184:187], v[232:235], v[112:115], v[184:187]
    ds_read_b128 v[224:227], v4 offset:24576
    v_mfma_f32_16x16x32_bf16 v[200:203], v[232:235], v[116:119], v[200:203]
    s_waitcnt vmcnt(12)
    v_swap_b32 v122, v124
    v_mfma_f32_16x16x32_bf16 v[188:191], v[236:239], v[112:115], v[188:191]
    ds_read_b128 v[228:231], v4 offset:25600
    v_mfma_f32_16x16x32_bf16 v[204:207], v[236:239], v[116:119], v[204:207]
    v_swap_b32 v123, v125
    v_mfma_f32_16x16x32_bf16 a[244:247], v[116:119], v[116:119], a[244:247]
    s_waitcnt lgkmcnt(4)
    v_mfma_f32_16x16x32_bf16 v[176:179], v[240:243], v[120:123], v[176:179]
    ds_read_b128 v[232:235], v4 offset:26624
    v_mfma_f32_16x16x32_bf16 v[192:195], v[240:243], v[124:127], v[192:195]
    buffer_load_dwordx4 a[64:67], v3, s[8:11], s54 offen offset:1024 sc1
    v_mfma_f32_16x16x32_bf16 v[180:183], v[244:247], v[120:123], v[180:183]
    ds_read_b128 v[236:239], v4 offset:27648
    v_mfma_f32_16x16x32_bf16 v[196:199], v[244:247], v[124:127], v[196:199]
    buffer_load_dwordx4 a[68:71], v3, s[8:11], s54 offen offset:2048 sc1
    v_mfma_f32_16x16x32_bf16 a[240:243], v[120:123], v[120:123], a[240:243]
    buffer_load_dwordx4 a[72:75], v3, s[8:11], s54 offen offset:3072 sc1
    s_waitcnt lgkmcnt(4)
    v_mfma_f32_16x16x32_bf16 v[184:187], v[248:251], v[120:123], v[184:187]
    ds_read_b128 v[240:243], v4 offset:30720
    v_mfma_f32_16x16x32_bf16 v[200:203], v[248:251], v[124:127], v[200:203]
    s_waitcnt vmcnt(13)
    v_swap_b32 v130, v132
    v_mfma_f32_16x16x32_bf16 v[188:191], v[252:255], v[120:123], v[188:191]
    ds_read_b128 v[244:247], v4 offset:31744
    v_mfma_f32_16x16x32_bf16 v[204:207], v[252:255], v[124:127], v[204:207]
    v_swap_b32 v131, v133
    v_mfma_f32_16x16x32_bf16 a[244:247], v[124:127], v[124:127], a[244:247]
    s_waitcnt lgkmcnt(4)
    v_mfma_f32_16x16x32_bf16 v[176:179], v[224:227], v[128:131], v[176:179]
    ds_read_b128 v[248:251], v4 offset:32768
    v_mfma_f32_16x16x32_bf16 v[192:195], v[224:227], v[132:135], v[192:195]
    buffer_load_dwordx4 a[76:79], v9, s[8:11], s54 offen sc1
    s_add_u32 s54, s54, 5120
    v_mfma_f32_16x16x32_bf16 v[180:183], v[228:231], v[128:131], v[180:183]
    ds_read_b128 v[252:255], v4 offset:33792
    v_mfma_f32_16x16x32_bf16 v[196:199], v[228:231], v[132:135], v[196:199]
    buffer_load_dwordx4 a[80:83], v3, s[8:11], s54 offen offset:0 sc1
    v_mfma_f32_16x16x32_bf16 a[240:243], v[128:131], v[128:131], a[240:243]
    s_waitcnt lgkmcnt(4)
    v_mfma_f32_16x16x32_bf16 v[184:187], v[232:235], v[128:131], v[184:187]
    ds_read_b128 v[224:227], v4 offset:36864
    v_mfma_f32_16x16x32_bf16 v[200:203], v[232:235], v[132:135], v[200:203]
    s_waitcnt vmcnt(13)
    v_swap_b32 v138, v140
    v_mfma_f32_16x16x32_bf16 v[188:191], v[236:239], v[128:131], v[188:191]
    ds_read_b128 v[228:231], v4 offset:37888
    v_mfma_f32_16x16x32_bf16 v[204:207], v[236:239], v[132:135], v[204:207]
    v_swap_b32 v139, v141
    v_mfma_f32_16x16x32_bf16 a[244:247], v[132:135], v[132:135], a[244:247]
    s_waitcnt lgkmcnt(4)
    v_mfma_f32_16x16x32_bf16 v[176:179], v[240:243], v[136:139], v[176:179]
    ds_read_b128 v[232:235], v4 offset:38912
    v_mfma_f32_16x16x32_bf16 v[192:195], v[240:243], v[140:143], v[192:195]
    buffer_load_dwordx4 a[84:87], v3, s[8:11], s54 offen offset:1024 sc1
    v_mfma_f32_16x16x32_bf16 v[180:183], v[244:247], v[136:139], v[180:183]
    ds_read_b128 v[236:239], v4 offset:39936
    v_mfma_f32_16x16x32_bf16 v[196:199], v[244:247], v[140:143], v[196:199]
    buffer_load_dwordx4 a[88:91], v3, s[8:11], s54 offen offset:2048 sc1
    v_mfma_f32_16x16x32_bf16 a[240:243], v[136:139], v[136:139], a[240:243]
    buffer_load_dwordx4 a[92:95], v3, s[8:11], s54 offen offset:3072 sc1
    s_waitcnt lgkmcnt(4)
    v_mfma_f32_16x16x32_bf16 v[184:187], v[248:251], v[136:139], v[184:187]
    ds_read_b128 v[240:243], v4 offset:43008
    v_mfma_f32_16x16x32_bf16 v[200:203], v[248:251], v[140:143], v[200:203]
    s_waitcnt vmcnt(14)
    v_swap_b32 v146, v148
    v_mfma_f32_16x16x32_bf16 v[188:191], v[252:255], v[136:139], v[188:191]
    ds_read_b128 v[244:247], v4 offset:44032
    v_mfma_f32_16x16x32_bf16 v[204:207], v[252:255], v[140:143], v[204:207]
    v_swap_b32 v147, v149
    v_mfma_f32_16x16x32_bf16 a[244:247], v[140:143], v[140:143], a[244:247]
    s_waitcnt lgkmcnt(4)
    v_mfma_f32_16x16x32_bf16 v[176:179], v[224:227], v[144:147], v[176:179]
    ds_read_b128 v[248:251], v4 offset:45056
    v_mfma_f32_16x16x32_bf16 v[192:195], v[224:227], v[148:151], v[192:195]
    buffer_load_dwordx4 a[96:99], v9, s[8:11], s54 offen sc1
    s_add_u32 s54, s54, 5120
    v_mfma_f32_16x16x32_bf16 v[180:183], v[228:231], v[144:147], v[180:183]
    ds_read_b128 v[252:255], v4 offset:46080
    v_mfma_f32_16x16x32_bf16 v[196:199], v[228:231], v[148:151], v[196:199]
    buffer_load_dwordx4 a[100:103], v3, s[8:11], s54 offen offset:0 sc1
    v_mfma_f32_16x16x32_bf16 a[240:243], v[144:147], v[144:147], a[240:243]
    s_waitcnt lgkmcnt(4)
    v_mfma_f32_16x16x32_bf16 v[184:187], v[232:235], v[144:147], v[184:187]
    ds_read_b128 v[224:227], v4 offset:49152
    v_mfma_f32_16x16x32_bf16 v[200:203], v[232:235], v[148:151], v[200:203]
    s_waitcnt vmcnt(14)
    v_swap_b32 v154, v156
    v_mfma_f32_16x16x32_bf16 v[188:191], v[236:239], v[144:147], v[188:191]
    ds_read_b128 v[228:231], v4 offset:50176
    v_mfma_f32_16x16x32_bf16 v[204:207], v[236:239], v[148:151], v[204:207]
    v_swap_b32 v155, v157
    v_mfma_f32_16x16x32_bf16 a[244:247], v[148:151], v[148:151], a[244:247]
    s_waitcnt lgkmcnt(4)
    v_mfma_f32_16x16x32_bf16 v[176:179], v[240:243], v[152:155], v[176:179]
    ds_read_b128 v[232:235], v4 offset:51200
    v_mfma_f32_16x16x32_bf16 v[192:195], v[240:243], v[156:159], v[192:195]
    buffer_load_dwordx4 a[104:107], v3, s[8:11], s54 offen offset:1024 sc1
    v_mfma_f32_16x16x32_bf16 v[180:183], v[244:247], v[152:155], v[180:183]
    ds_read_b128 v[236:239], v4 offset:52224
    v_mfma_f32_16x16x32_bf16 v[196:199], v[244:247], v[156:159], v[196:199]
    buffer_load_dwordx4 a[108:111], v3, s[8:11], s54 offen offset:2048 sc1
    v_mfma_f32_16x16x32_bf16 a[240:243], v[152:155], v[152:155], a[240:243]
    buffer_load_dwordx4 a[112:115], v3, s[8:11], s54 offen offset:3072 sc1
    s_waitcnt lgkmcnt(4)
    v_mfma_f32_16x16x32_bf16 v[184:187], v[248:251], v[152:155], v[184:187]
    ds_read_b128 v[240:243], v4 offset:55296
    v_mfma_f32_16x16x32_bf16 v[200:203], v[248:251], v[156:159], v[200:203]
    s_waitcnt vmcnt(15)
    v_swap_b32 v162, v164
    v_mfma_f32_16x16x32_bf16 v[188:191], v[252:255], v[152:155], v[188:191]
    ds_read_b128 v[244:247], v4 offset:56320
    v_mfma_f32_16x16x32_bf16 v[204:207], v[252:255], v[156:159], v[204:207]
    v_swap_b32 v163, v165
    v_mfma_f32_16x16x32_bf16 a[244:247], v[156:159], v[156:159], a[244:247]
    s_waitcnt lgkmcnt(4)
    v_mfma_f32_16x16x32_bf16 v[176:179], v[224:227], v[160:163], v[176:179]
    ds_read_b128 v[248:251], v4 offset:57344
    v_mfma_f32_16x16x32_bf16 v[192:195], v[224:227], v[164:167], v[192:195]
    buffer_load_dwordx4 a[116:119], v9, s[8:11], s54 offen sc1
    s_add_u32 s54, s54, 5120
    v_mfma_f32_16x16x32_bf16 v[180:183], v[228:231], v[160:163], v[180:183]
    ds_read_b128 v[252:255], v4 offset:58368
    v_mfma_f32_16x16x32_bf16 v[196:199], v[228:231], v[164:167], v[196:199]
    buffer_load_dwordx4 a[120:123], v3, s[8:11], s54 offen offset:0 sc1
    v_mfma_f32_16x16x32_bf16 a[240:243], v[160:163], v[160:163], a[240:243]
    s_waitcnt lgkmcnt(4)
    v_mfma_f32_16x16x32_bf16 v[184:187], v[232:235], v[160:163], v[184:187]
    v_mfma_f32_16x16x32_bf16 v[200:203], v[232:235], v[164:167], v[200:203]
    s_waitcnt vmcnt(15)
    v_swap_b32 v170, v172
    v_mfma_f32_16x16x32_bf16 v[188:191], v[236:239], v[160:163], v[188:191]
    v_mfma_f32_16x16x32_bf16 v[204:207], v[236:239], v[164:167], v[204:207]
    v_swap_b32 v171, v173
    v_mfma_f32_16x16x32_bf16 a[244:247], v[164:167], v[164:167], a[244:247]
    s_waitcnt lgkmcnt(2)
    v_mfma_f32_16x16x32_bf16 v[176:179], v[240:243], v[168:171], v[176:179]
    v_mfma_f32_16x16x32_bf16 v[192:195], v[240:243], v[172:175], v[192:195]
    buffer_load_dwordx4 a[124:127], v3, s[8:11], s54 offen offset:1024 sc1
    v_mfma_f32_16x16x32_bf16 v[180:183], v[244:247], v[168:171], v[180:183]
    v_mfma_f32_16x16x32_bf16 v[196:199], v[244:247], v[172:175], v[196:199]
    buffer_load_dwordx4 a[128:131], v3, s[8:11], s54 offen offset:2048 sc1
    v_mfma_f32_16x16x32_bf16 a[240:243], v[168:171], v[168:171], a[240:243]
    buffer_load_dwordx4 a[132:135], v3, s[8:11], s54 offen offset:3072 sc1
    s_waitcnt lgkmcnt(0)
    v_mfma_f32_16x16x32_bf16 v[184:187], v[248:251], v[168:171], v[184:187]
    v_mfma_f32_16x16x32_bf16 v[200:203], v[248:251], v[172:175], v[200:203]
    v_mfma_f32_16x16x32_bf16 v[188:191], v[252:255], v[168:171], v[188:191]
    v_mfma_f32_16x16x32_bf16 v[204:207], v[252:255], v[172:175], v[204:207]
    v_mfma_f32_16x16x32_bf16 a[244:247], v[172:175], v[172:175], a[244:247]
    v_and_b32 v14, 2, v0
    v_cmp_ne_u32 vcc, 0, v14
    v_and_b32_e64 v14, 1, v0
    v_cmp_ne_u32 s[22:23], 0, v14
    v_accvgpr_read_b32 v248, a240
    v_accvgpr_read_b32 v249, a241
    v_accvgpr_read_b32 v250, a242
    v_accvgpr_read_b32 v251, a243
    v_accvgpr_read_b32 v252, a244
    v_accvgpr_read_b32 v253, a245
    v_accvgpr_read_b32 v254, a246
    v_accvgpr_read_b32 v255, a247
    v_cndmask_b32 v248, v248, v250, vcc
    v_cndmask_b32 v249, v249, v251, vcc
    v_cndmask_b32 v252, v252, v254, vcc
    v_cndmask_b32 v253, v253, v255, vcc
    v_cndmask_b32 v248, v248, v249, s[22:23]
    v_cndmask_b32 v252, v252, v253, s[22:23]
    ds_bpermute_b32 v14, v13, v248
    ds_bpermute_b32 v15, v13, v252
    s_mov_b32 s22, 0x3acccccd
    v_mov_b32 v13, 0x3727c5ac
    buffer_load_dwordx4 a[136:139], v9, s[8:11], s54 offen sc1
    s_add_u32 s54, s54, 5120
    buffer_load_dwordx4 a[140:143], v3, s[8:11], s54 offen offset:0 sc1
    s_waitcnt lgkmcnt(0)
    v_fma_f32 v14, v14, s22, v13
    v_fma_f32 v15, v15, s22, v13
    v_rsq_f32 v14, v14
    v_rsq_f32_e64 v15, v15
    s_mov_b32 s22, 0xbdd2d3e8
    v_pk_fma_f32 v[176:177], v[176:177], v[14:15], v[208:209] op_sel:[0,0,0] op_sel_hi:[1,0,1]
    v_pk_fma_f32 v[178:179], v[178:179], v[14:15], v[210:211] op_sel:[0,0,0] op_sel_hi:[1,0,1]
    v_pk_fma_f32 v[180:181], v[180:181], v[14:15], v[212:213] op_sel:[0,0,0] op_sel_hi:[1,0,1]
    v_pk_fma_f32 v[182:183], v[182:183], v[14:15], v[214:215] op_sel:[0,0,0] op_sel_hi:[1,0,1]
    v_pk_mul_f32 v[232:233], v[176:177], v[176:177]
    v_pk_mul_f32 v[234:235], v[178:179], v[178:179]
    v_pk_mul_f32 v[236:237], v[180:181], v[180:181]
    v_pk_mul_f32 v[238:239], v[182:183], v[182:183]
    v_pk_fma_f32 v[232:233], v[232:233], s[22:23], v[12:13] op_sel_hi:[1,0,0]
    v_pk_fma_f32 v[234:235], v[234:235], s[22:23], v[12:13] op_sel_hi:[1,0,0]
    v_pk_fma_f32 v[236:237], v[236:237], s[22:23], v[12:13] op_sel_hi:[1,0,0]
    v_pk_fma_f32 v[238:239], v[238:239], s[22:23], v[12:13] op_sel_hi:[1,0,0]
    v_pk_mul_f32 v[232:233], v[232:233], v[176:177]
    v_pk_mul_f32 v[234:235], v[234:235], v[178:179]
    v_pk_mul_f32 v[236:237], v[236:237], v[180:181]
    v_pk_mul_f32 v[238:239], v[238:239], v[182:183]
    v_exp_f32 v232, v232
    v_exp_f32 v233, v233
    v_exp_f32 v234, v234
    v_exp_f32 v235, v235
    v_exp_f32 v236, v236
    v_exp_f32 v237, v237
    v_exp_f32 v238, v238
    v_exp_f32 v239, v239
    buffer_load_dwordx4 a[144:147], v3, s[8:11], s54 offen offset:1024 sc1
    v_pk_add_f32 v[232:233], v[232:233], 1.0 op_sel_hi:[1,0]
    v_pk_add_f32 v[234:235], v[234:235], 1.0 op_sel_hi:[1,0]
    v_pk_add_f32 v[236:237], v[236:237], 1.0 op_sel_hi:[1,0]
    v_pk_add_f32 v[238:239], v[238:239], 1.0 op_sel_hi:[1,0]
    v_rcp_f32 v232, v232
    v_rcp_f32 v233, v233
    v_rcp_f32 v234, v234
    v_rcp_f32 v235, v235
    v_rcp_f32 v236, v236
    v_rcp_f32 v237, v237
    v_rcp_f32 v238, v238
    v_rcp_f32 v239, v239
    v_pk_mul_f32 v[232:233], v[232:233], v[176:177]
    v_pk_mul_f32 v[234:235], v[234:235], v[178:179]
    v_pk_mul_f32 v[236:237], v[236:237], v[180:181]
    v_pk_mul_f32 v[238:239], v[238:239], v[182:183]
    v_cvt_pk_bf16_f32 v176, v232, v233
    v_cvt_pk_bf16_f32 v177, v234, v235
    v_cvt_pk_bf16_f32 v178, v236, v237
    v_cvt_pk_bf16_f32 v179, v238, v239
    buffer_store_dwordx4 v[176:179], v3, s[8:11], s20 offen offset:0 sc1
    v_pk_fma_f32 v[192:193], v[192:193], v[14:15], v[208:209] op_sel:[0,1,0] op_sel_hi:[1,1,1]
    v_pk_fma_f32 v[194:195], v[194:195], v[14:15], v[210:211] op_sel:[0,1,0] op_sel_hi:[1,1,1]
    v_pk_fma_f32 v[196:197], v[196:197], v[14:15], v[212:213] op_sel:[0,1,0] op_sel_hi:[1,1,1]
    v_pk_fma_f32 v[198:199], v[198:199], v[14:15], v[214:215] op_sel:[0,1,0] op_sel_hi:[1,1,1]
    v_pk_mul_f32 v[240:241], v[192:193], v[192:193]
    v_pk_mul_f32 v[242:243], v[194:195], v[194:195]
    v_pk_mul_f32 v[244:245], v[196:197], v[196:197]
    v_pk_mul_f32 v[246:247], v[198:199], v[198:199]
    v_pk_fma_f32 v[240:241], v[240:241], s[22:23], v[12:13] op_sel_hi:[1,0,0]
    v_pk_fma_f32 v[242:243], v[242:243], s[22:23], v[12:13] op_sel_hi:[1,0,0]
    v_pk_fma_f32 v[244:245], v[244:245], s[22:23], v[12:13] op_sel_hi:[1,0,0]
    v_pk_fma_f32 v[246:247], v[246:247], s[22:23], v[12:13] op_sel_hi:[1,0,0]
    v_pk_mul_f32 v[240:241], v[240:241], v[192:193]
    v_pk_mul_f32 v[242:243], v[242:243], v[194:195]
    v_pk_mul_f32 v[244:245], v[244:245], v[196:197]
    v_pk_mul_f32 v[246:247], v[246:247], v[198:199]
    v_exp_f32 v240, v240
    v_exp_f32 v241, v241
    v_exp_f32 v242, v242
    v_exp_f32 v243, v243
    v_exp_f32 v244, v244
    v_exp_f32 v245, v245
    v_exp_f32 v246, v246
    v_exp_f32 v247, v247
    buffer_load_dwordx4 a[148:151], v3, s[8:11], s54 offen offset:2048 sc1
    v_pk_add_f32 v[240:241], v[240:241], 1.0 op_sel_hi:[1,0]
    v_pk_add_f32 v[242:243], v[242:243], 1.0 op_sel_hi:[1,0]
    v_pk_add_f32 v[244:245], v[244:245], 1.0 op_sel_hi:[1,0]
    v_pk_add_f32 v[246:247], v[246:247], 1.0 op_sel_hi:[1,0]
    v_rcp_f32 v240, v240
    v_rcp_f32 v241, v241
    v_rcp_f32 v242, v242
    v_rcp_f32 v243, v243
    v_rcp_f32 v244, v244
    v_rcp_f32 v245, v245
    v_rcp_f32 v246, v246
    v_rcp_f32 v247, v247
    v_pk_mul_f32 v[240:241], v[240:241], v[192:193]
    v_pk_mul_f32 v[242:243], v[242:243], v[194:195]
    v_pk_mul_f32 v[244:245], v[244:245], v[196:197]
    v_pk_mul_f32 v[246:247], v[246:247], v[198:199]
    v_cvt_pk_bf16_f32 v192, v240, v241
    v_cvt_pk_bf16_f32 v193, v242, v243
    v_cvt_pk_bf16_f32 v194, v244, v245
    v_cvt_pk_bf16_f32 v195, v246, v247
    buffer_store_dwordx4 v[192:195], v3, s[8:11], s21 offen offset:0 sc1
    v_pk_fma_f32 v[184:185], v[184:185], v[14:15], v[216:217] op_sel:[0,0,0] op_sel_hi:[1,0,1]
    v_pk_fma_f32 v[186:187], v[186:187], v[14:15], v[218:219] op_sel:[0,0,0] op_sel_hi:[1,0,1]
    v_pk_fma_f32 v[188:189], v[188:189], v[14:15], v[220:221] op_sel:[0,0,0] op_sel_hi:[1,0,1]
    v_pk_fma_f32 v[190:191], v[190:191], v[14:15], v[222:223] op_sel:[0,0,0] op_sel_hi:[1,0,1]
    v_pk_mul_f32 v[232:233], v[184:185], v[184:185]
    v_pk_mul_f32 v[234:235], v[186:187], v[186:187]
    v_pk_mul_f32 v[236:237], v[188:189], v[188:189]
    v_pk_mul_f32 v[238:239], v[190:191], v[190:191]
    v_pk_fma_f32 v[232:233], v[232:233], s[22:23], v[12:13] op_sel_hi:[1,0,0]
    v_pk_fma_f32 v[234:235], v[234:235], s[22:23], v[12:13] op_sel_hi:[1,0,0]
    v_pk_fma_f32 v[236:237], v[236:237], s[22:23], v[12:13] op_sel_hi:[1,0,0]
    v_pk_fma_f32 v[238:239], v[238:239], s[22:23], v[12:13] op_sel_hi:[1,0,0]
    v_pk_mul_f32 v[232:233], v[232:233], v[184:185]
    v_pk_mul_f32 v[234:235], v[234:235], v[186:187]
    v_pk_mul_f32 v[236:237], v[236:237], v[188:189]
    v_pk_mul_f32 v[238:239], v[238:239], v[190:191]
    v_exp_f32 v232, v232
    v_exp_f32 v233, v233
    v_exp_f32 v234, v234
    v_exp_f32 v235, v235
    v_exp_f32 v236, v236
    v_exp_f32 v237, v237
    v_exp_f32 v238, v238
    v_exp_f32 v239, v239
    buffer_load_dwordx4 a[152:155], v3, s[8:11], s54 offen offset:3072 sc1
    v_pk_add_f32 v[232:233], v[232:233], 1.0 op_sel_hi:[1,0]
    v_pk_add_f32 v[234:235], v[234:235], 1.0 op_sel_hi:[1,0]
    v_pk_add_f32 v[236:237], v[236:237], 1.0 op_sel_hi:[1,0]
    v_pk_add_f32 v[238:239], v[238:239], 1.0 op_sel_hi:[1,0]
    v_rcp_f32 v232, v232
    v_rcp_f32 v233, v233
    v_rcp_f32 v234, v234
    v_rcp_f32 v235, v235
    v_rcp_f32 v236, v236
    v_rcp_f32 v237, v237
    v_rcp_f32 v238, v238
    v_rcp_f32 v239, v239
    v_pk_mul_f32 v[232:233], v[232:233], v[184:185]
    v_pk_mul_f32 v[234:235], v[234:235], v[186:187]
    v_pk_mul_f32 v[236:237], v[236:237], v[188:189]
    v_pk_mul_f32 v[238:239], v[238:239], v[190:191]
    v_cvt_pk_bf16_f32 v184, v232, v233
    v_cvt_pk_bf16_f32 v185, v234, v235
    v_cvt_pk_bf16_f32 v186, v236, v237
    v_cvt_pk_bf16_f32 v187, v238, v239
    buffer_store_dwordx4 v[184:187], v3, s[8:11], s20 offen offset:1024 sc1
    v_pk_fma_f32 v[200:201], v[200:201], v[14:15], v[216:217] op_sel:[0,1,0] op_sel_hi:[1,1,1]
    v_pk_fma_f32 v[202:203], v[202:203], v[14:15], v[218:219] op_sel:[0,1,0] op_sel_hi:[1,1,1]
    v_pk_fma_f32 v[204:205], v[204:205], v[14:15], v[220:221] op_sel:[0,1,0] op_sel_hi:[1,1,1]
    v_pk_fma_f32 v[206:207], v[206:207], v[14:15], v[222:223] op_sel:[0,1,0] op_sel_hi:[1,1,1]
    v_pk_mul_f32 v[240:241], v[200:201], v[200:201]
    v_pk_mul_f32 v[242:243], v[202:203], v[202:203]
    v_pk_mul_f32 v[244:245], v[204:205], v[204:205]
    v_pk_mul_f32 v[246:247], v[206:207], v[206:207]
    v_pk_fma_f32 v[240:241], v[240:241], s[22:23], v[12:13] op_sel_hi:[1,0,0]
    v_pk_fma_f32 v[242:243], v[242:243], s[22:23], v[12:13] op_sel_hi:[1,0,0]
    v_pk_fma_f32 v[244:245], v[244:245], s[22:23], v[12:13] op_sel_hi:[1,0,0]
    v_pk_fma_f32 v[246:247], v[246:247], s[22:23], v[12:13] op_sel_hi:[1,0,0]
    v_pk_mul_f32 v[240:241], v[240:241], v[200:201]
    v_pk_mul_f32 v[242:243], v[242:243], v[202:203]
    v_pk_mul_f32 v[244:245], v[244:245], v[204:205]
    v_pk_mul_f32 v[246:247], v[246:247], v[206:207]
    v_exp_f32 v240, v240
    v_exp_f32 v241, v241
    v_exp_f32 v242, v242
    v_exp_f32 v243, v243
    v_exp_f32 v244, v244
    v_exp_f32 v245, v245
    v_exp_f32 v246, v246
    v_exp_f32 v247, v247
    buffer_load_dwordx4 a[156:159], v9, s[8:11], s54 offen sc1
    s_add_u32 s54, s54, 5120
    ds_read_b128 v[248:251], v3 offset:4096
    ds_read_b128 v[252:255], v3 offset:5120
    ds_read_b128 v[224:227], v3 offset:10240
    ds_read_b128 v[228:231], v3 offset:11264
    v_pk_add_f32 v[240:241], v[240:241], 1.0 op_sel_hi:[1,0]
    v_pk_add_f32 v[242:243], v[242:243], 1.0 op_sel_hi:[1,0]
    v_pk_add_f32 v[244:245], v[244:245], 1.0 op_sel_hi:[1,0]
    v_pk_add_f32 v[246:247], v[246:247], 1.0 op_sel_hi:[1,0]
    v_rcp_f32 v240, v240
    v_rcp_f32 v241, v241
    v_rcp_f32 v242, v242
    v_rcp_f32 v243, v243
    v_rcp_f32 v244, v244
    v_rcp_f32 v245, v245
    v_rcp_f32 v246, v246
    v_rcp_f32 v247, v247
    v_pk_mul_f32 v[240:241], v[240:241], v[200:201]
    v_pk_mul_f32 v[242:243], v[242:243], v[202:203]
    v_pk_mul_f32 v[244:245], v[244:245], v[204:205]
    v_pk_mul_f32 v[246:247], v[246:247], v[206:207]
    v_cvt_pk_bf16_f32 v200, v240, v241
    v_cvt_pk_bf16_f32 v201, v242, v243
    v_cvt_pk_bf16_f32 v202, v244, v245
    v_cvt_pk_bf16_f32 v203, v246, v247
    buffer_store_dwordx4 v[200:203], v3, s[8:11], s21 offen offset:1024 sc1
    ds_read_b128 v[232:235], v3 offset:16384
    ds_read_b128 v[236:239], v3 offset:17408
    s_waitcnt lgkmcnt(4)
    v_mfma_f32_16x16x32_bf16 v[208:211], v[248:251], v[16:19], 0
    ds_read_b128 v[240:243], v3 offset:22528
    v_mfma_f32_16x16x32_bf16 v[216:219], v[248:251], v[20:23], 0
    buffer_load_dwordx4 a[160:163], v3, s[8:11], s54 offen offset:0 sc1
    v_mfma_f32_16x16x32_bf16 v[212:215], v[252:255], v[16:19], 0
    ds_read_b128 v[244:247], v3 offset:23552
    v_mfma_f32_16x16x32_bf16 v[220:223], v[252:255], v[20:23], 0
    s_waitcnt lgkmcnt(4)
    v_mfma_f32_16x16x32_bf16 v[208:211], v[224:227], v[24:27], v[208:211]
    ds_read_b128 v[248:251], v3 offset:28672
    v_mfma_f32_16x16x32_bf16 v[216:219], v[224:227], v[28:31], v[216:219]
    buffer_load_dwordx4 a[164:167], v3, s[8:11], s54 offen offset:1024 sc1
    v_mfma_f32_16x16x32_bf16 v[212:215], v[228:231], v[24:27], v[212:215]
    ds_read_b128 v[252:255], v3 offset:29696
    v_mfma_f32_16x16x32_bf16 v[220:223], v[228:231], v[28:31], v[220:223]
    v_accvgpr_read_b32 v188, a248
    s_waitcnt lgkmcnt(4)
    v_mfma_f32_16x16x32_bf16 v[208:211], v[232:235], v[32:35], v[208:211]
    ds_read_b128 v[224:227], v3 offset:34816
    v_mfma_f32_16x16x32_bf16 v[216:219], v[232:235], v[36:39], v[216:219]
    buffer_load_dwordx4 a[168:171], v3, s[8:11], s54 offen offset:2048 sc1
    v_mfma_f32_16x16x32_bf16 v[212:215], v[236:239], v[32:35], v[212:215]
    ds_read_b128 v[228:231], v3 offset:35840
    v_mfma_f32_16x16x32_bf16 v[220:223], v[236:239], v[36:39], v[220:223]
    s_waitcnt lgkmcnt(4)
    v_mfma_f32_16x16x32_bf16 v[208:211], v[240:243], v[40:43], v[208:211]
    ds_read_b128 v[232:235], v3 offset:40960
    v_mfma_f32_16x16x32_bf16 v[216:219], v[240:243], v[44:47], v[216:219]
    buffer_load_dwordx4 a[172:175], v3, s[8:11], s54 offen offset:3072 sc1
    v_mfma_f32_16x16x32_bf16 v[212:215], v[244:247], v[40:43], v[212:215]
    ds_read_b128 v[236:239], v3 offset:41984
    v_mfma_f32_16x16x32_bf16 v[220:223], v[244:247], v[44:47], v[220:223]
    s_waitcnt lgkmcnt(4)
    v_mfma_f32_16x16x32_bf16 v[208:211], v[248:251], v[48:51], v[208:211]
    ds_read_b128 v[240:243], v3 offset:47104
    v_mfma_f32_16x16x32_bf16 v[216:219], v[248:251], v[52:55], v[216:219]
    buffer_load_dwordx4 a[176:179], v9, s[8:11], s54 offen sc1
    s_add_u32 s54, s54, 5120
    v_mfma_f32_16x16x32_bf16 v[212:215], v[252:255], v[48:51], v[212:215]
    ds_read_b128 v[244:247], v3 offset:48128
    v_mfma_f32_16x16x32_bf16 v[220:223], v[252:255], v[52:55], v[220:223]
    s_waitcnt lgkmcnt(4)
    v_mfma_f32_16x16x32_bf16 v[208:211], v[224:227], v[56:59], v[208:211]
    ds_read_b128 v[248:251], v3 offset:53248
    v_mfma_f32_16x16x32_bf16 v[216:219], v[224:227], v[60:63], v[216:219]
    buffer_load_dwordx4 a[180:183], v3, s[8:11], s54 offen offset:0 sc1
    v_mfma_f32_16x16x32_bf16 v[212:215], v[228:231], v[56:59], v[212:215]
    ds_read_b128 v[252:255], v3 offset:54272
    v_mfma_f32_16x16x32_bf16 v[220:223], v[228:231], v[60:63], v[220:223]
    s_waitcnt lgkmcnt(4)
    v_mfma_f32_16x16x32_bf16 v[208:211], v[232:235], v[64:67], v[208:211]
    ds_read_b128 v[224:227], v3 offset:59392
    v_mfma_f32_16x16x32_bf16 v[216:219], v[232:235], v[68:71], v[216:219]
    buffer_load_dwordx4 a[184:187], v3, s[8:11], s54 offen offset:1024 sc1
    v_mfma_f32_16x16x32_bf16 v[212:215], v[236:239], v[64:67], v[212:215]
    ds_read_b128 v[228:231], v3 offset:60416
    v_mfma_f32_16x16x32_bf16 v[220:223], v[236:239], v[68:71], v[220:223]
    s_waitcnt lgkmcnt(4)
    v_mfma_f32_16x16x32_bf16 v[208:211], v[240:243], v[72:75], v[208:211]
    ds_read_b128 v[232:235], v4 offset:4096
    v_mfma_f32_16x16x32_bf16 v[216:219], v[240:243], v[76:79], v[216:219]
    buffer_load_dwordx4 a[188:191], v3, s[8:11], s54 offen offset:2048 sc1
    v_mfma_f32_16x16x32_bf16 v[212:215], v[244:247], v[72:75], v[212:215]
    ds_read_b128 v[236:239], v4 offset:5120
    v_mfma_f32_16x16x32_bf16 v[220:223], v[244:247], v[76:79], v[220:223]
    s_waitcnt lgkmcnt(4)
    v_mfma_f32_16x16x32_bf16 v[208:211], v[248:251], v[80:83], v[208:211]
    ds_read_b128 v[240:243], v4 offset:10240
    v_mfma_f32_16x16x32_bf16 v[216:219], v[248:251], v[84:87], v[216:219]
    buffer_load_dwordx4 a[192:195], v3, s[8:11], s54 offen offset:3072 sc1
    v_mfma_f32_16x16x32_bf16 v[212:215], v[252:255], v[80:83], v[212:215]
    ds_read_b128 v[244:247], v4 offset:11264
    v_mfma_f32_16x16x32_bf16 v[220:223], v[252:255], v[84:87], v[220:223]
    s_waitcnt lgkmcnt(4)
    v_mfma_f32_16x16x32_bf16 v[208:211], v[224:227], v[88:91], v[208:211]
    ds_read_b128 v[248:251], v4 offset:16384
    v_mfma_f32_16x16x32_bf16 v[216:219], v[224:227], v[92:95], v[216:219]
    buffer_load_dwordx4 a[196:199], v9, s[8:11], s54 offen sc1
    s_add_u32 s54, s54, 5120
    v_mfma_f32_16x16x32_bf16 v[212:215], v[228:231], v[88:91], v[212:215]
    ds_read_b128 v[252:255], v4 offset:17408
    v_mfma_f32_16x16x32_bf16 v[220:223], v[228:231], v[92:95], v[220:223]
    s_waitcnt lgkmcnt(4)
    v_mfma_f32_16x16x32_bf16 v[208:211], v[232:235], v[96:99], v[208:211]
    ds_read_b128 v[224:227], v4 offset:22528
    v_mfma_f32_16x16x32_bf16 v[216:219], v[232:235], v[100:103], v[216:219]
    buffer_load_dwordx4 v[16:19], v5, s[8:11], s36 offen sc1
    s_add_u32 s36, s36, 131072
    v_mfma_f32_16x16x32_bf16 v[212:215], v[236:239], v[96:99], v[212:215]
    ds_read_b128 v[228:231], v4 offset:23552
    v_mfma_f32_16x16x32_bf16 v[220:223], v[236:239], v[100:103], v[220:223]
    s_waitcnt lgkmcnt(4)
    v_mfma_f32_16x16x32_bf16 v[208:211], v[240:243], v[104:107], v[208:211]
    ds_read_b128 v[232:235], v4 offset:28672
    v_mfma_f32_16x16x32_bf16 v[216:219], v[240:243], v[108:111], v[216:219]
    buffer_load_dwordx4 v[20:23], v5, s[8:11], s37 offen sc1
    s_add_u32 s37, s37, 131072
    v_mfma_f32_16x16x32_bf16 v[212:215], v[244:247], v[104:107], v[212:215]
    ds_read_b128 v[236:239], v4 offset:29696
    v_mfma_f32_16x16x32_bf16 v[220:223], v[244:247], v[108:111], v[220:223]
    s_waitcnt lgkmcnt(4)
    v_mfma_f32_16x16x32_bf16 v[208:211], v[248:251], v[112:115], v[208:211]
    ds_read_b128 v[240:243], v4 offset:34816
    v_mfma_f32_16x16x32_bf16 v[216:219], v[248:251], v[116:119], v[216:219]
    buffer_load_dwordx4 v[24:27], v5, s[8:11], s38 offen sc1
    s_add_u32 s38, s38, 131072
    v_mfma_f32_16x16x32_bf16 v[212:215], v[252:255], v[112:115], v[212:215]
    ds_read_b128 v[244:247], v4 offset:35840
    v_mfma_f32_16x16x32_bf16 v[220:223], v[252:255], v[116:119], v[220:223]
    s_waitcnt lgkmcnt(4)
    v_mfma_f32_16x16x32_bf16 v[208:211], v[224:227], v[120:123], v[208:211]
    ds_read_b128 v[248:251], v4 offset:40960
    v_mfma_f32_16x16x32_bf16 v[216:219], v[224:227], v[124:127], v[216:219]
    buffer_load_dwordx4 v[28:31], v5, s[8:11], s39 offen sc1
    s_add_u32 s39, s39, 131072
    v_mfma_f32_16x16x32_bf16 v[212:215], v[228:231], v[120:123], v[212:215]
    ds_read_b128 v[252:255], v4 offset:41984
    v_mfma_f32_16x16x32_bf16 v[220:223], v[228:231], v[124:127], v[220:223]
    s_waitcnt lgkmcnt(4)
    v_mfma_f32_16x16x32_bf16 v[208:211], v[232:235], v[128:131], v[208:211]
    ds_read_b128 v[224:227], v4 offset:47104
    v_mfma_f32_16x16x32_bf16 v[216:219], v[232:235], v[132:135], v[216:219]
    buffer_load_dwordx4 v[32:35], v3, s[8:11], s55 offen offset:0 sc1
    v_mfma_f32_16x16x32_bf16 v[212:215], v[236:239], v[128:131], v[212:215]
    ds_read_b128 v[228:231], v4 offset:48128
    v_mfma_f32_16x16x32_bf16 v[220:223], v[236:239], v[132:135], v[220:223]
    s_waitcnt lgkmcnt(4)
    v_mfma_f32_16x16x32_bf16 v[208:211], v[240:243], v[136:139], v[208:211]
    ds_read_b128 v[232:235], v4 offset:53248
    v_mfma_f32_16x16x32_bf16 v[216:219], v[240:243], v[140:143], v[216:219]
    buffer_load_dwordx4 v[36:39], v3, s[8:11], s55 offen offset:1024 sc1
    v_mfma_f32_16x16x32_bf16 v[212:215], v[244:247], v[136:139], v[212:215]
    ds_read_b128 v[236:239], v4 offset:54272
    v_mfma_f32_16x16x32_bf16 v[220:223], v[244:247], v[140:143], v[220:223]
    s_waitcnt vmcnt(16)
    s_barrier
    s_mov_b64 exec, 1
    buffer_atomic_add v10, v11, s[8:11], s56 offen offset:0 sc1
    s_mov_b64 exec, -1
    s_waitcnt lgkmcnt(4)
    v_mfma_f32_16x16x32_bf16 v[208:211], v[248:251], v[144:147], v[208:211]
    ds_read_b128 v[240:243], v4 offset:59392
    v_mfma_f32_16x16x32_bf16 v[216:219], v[248:251], v[148:151], v[216:219]
    buffer_load_dwordx4 v[40:43], v3, s[8:11], s55 offen offset:2048 sc1
    v_mfma_f32_16x16x32_bf16 v[212:215], v[252:255], v[144:147], v[212:215]
    ds_read_b128 v[244:247], v4 offset:60416
    v_mfma_f32_16x16x32_bf16 v[220:223], v[252:255], v[148:151], v[220:223]
    s_waitcnt lgkmcnt(4)
    v_mfma_f32_16x16x32_bf16 v[208:211], v[224:227], v[152:155], v[208:211]
    v_mfma_f32_16x16x32_bf16 v[216:219], v[224:227], v[156:159], v[216:219]
    buffer_load_dwordx4 v[44:47], v3, s[8:11], s55 offen offset:3072 sc1
    v_mfma_f32_16x16x32_bf16 v[212:215], v[228:231], v[152:155], v[212:215]
    v_mfma_f32_16x16x32_bf16 v[220:223], v[228:231], v[156:159], v[220:223]
    ds_bpermute_b32 v184, v7, v188 offset:128
    ds_bpermute_b32 v185, v7, v188 offset:132
    ds_bpermute_b32 v186, v7, v188 offset:160
    ds_bpermute_b32 v187, v7, v188 offset:164
    s_waitcnt lgkmcnt(6)
    v_mfma_f32_16x16x32_bf16 v[208:211], v[232:235], v[160:163], v[208:211]
    v_mfma_f32_16x16x32_bf16 v[216:219], v[232:235], v[164:167], v[216:219]
    buffer_load_dwordx4 v[48:51], v9, s[8:11], s55 offen sc1
    s_add_u32 s55, s55, 15360
    v_mfma_f32_16x16x32_bf16 v[212:215], v[236:239], v[160:163], v[212:215]
    v_mfma_f32_16x16x32_bf16 v[220:223], v[236:239], v[164:167], v[220:223]
    s_waitcnt lgkmcnt(0)
    v_mfma_f32_16x16x32_bf16 v[208:211], v[240:243], v[168:171], v[208:211]
    v_lshlrev_b32_e64 v176, 16, v184
    v_and_b32 v177, 0xffff0000, v184
    v_mfma_f32_16x16x32_bf16 v[216:219], v[240:243], v[172:175], v[216:219]
    buffer_load_dwordx4 v[52:55], v5, s[8:11], s36 offen sc1
    s_add_u32 s36, s36, 131072
    v_lshlrev_b32_e64 v178, 16, v185
    v_and_b32 v179, 0xffff0000, v185
    v_mfma_f32_16x16x32_bf16 v[212:215], v[244:247], v[168:171], v[212:215]
    v_lshlrev_b32_e64 v180, 16, v186
    v_and_b32 v181, 0xffff0000, v186
    v_mfma_f32_16x16x32_bf16 v[220:223], v[244:247], v[172:175], v[220:223]
    v_lshlrev_b32_e64 v182, 16, v187
    v_and_b32 v183, 0xffff0000, v187
    v_pk_fma_f32 v[208:209], v[208:209], v[14:15], v[176:177] op_sel:[0,0,0] op_sel_hi:[1,0,1]
    v_pk_fma_f32 v[210:211], v[210:211], v[14:15], v[178:179] op_sel:[0,0,0] op_sel_hi:[1,0,1]
    s_nop 0
    s_nop 0
    v_pk_fma_f32 v[212:213], v[212:213], v[14:15], v[180:181] op_sel:[0,0,0] op_sel_hi:[1,0,1]
    v_pk_fma_f32 v[214:215], v[214:215], v[14:15], v[182:183] op_sel:[0,0,0] op_sel_hi:[1,0,1]
    v_pk_mul_f32 v[232:233], v[208:209], v[208:209]
    v_pk_mul_f32 v[234:235], v[210:211], v[210:211]
    v_pk_mul_f32 v[236:237], v[212:213], v[212:213]
    v_pk_mul_f32 v[238:239], v[214:215], v[214:215]
    v_pk_fma_f32 v[232:233], v[232:233], s[22:23], v[12:13] op_sel_hi:[1,0,0]
    v_pk_fma_f32 v[234:235], v[234:235], s[22:23], v[12:13] op_sel_hi:[1,0,0]
    v_pk_fma_f32 v[236:237], v[236:237], s[22:23], v[12:13] op_sel_hi:[1,0,0]
    v_pk_fma_f32 v[238:239], v[238:239], s[22:23], v[12:13] op_sel_hi:[1,0,0]
    v_pk_mul_f32 v[232:233], v[232:233], v[208:209]
    v_pk_mul_f32 v[234:235], v[234:235], v[210:211]
    v_pk_mul_f32 v[236:237], v[236:237], v[212:213]
    v_pk_mul_f32 v[238:239], v[238:239], v[214:215]
    v_exp_f32 v232, v232
    v_exp_f32 v233, v233
    v_exp_f32 v234, v234
    v_exp_f32 v235, v235
    v_exp_f32 v236, v236
    v_exp_f32 v237, v237
    v_exp_f32 v238, v238
    v_exp_f32 v239, v239
    v_pk_add_f32 v[232:233], v[232:233], 1.0 op_sel_hi:[1,0]
    v_pk_add_f32 v[234:235], v[234:235], 1.0 op_sel_hi:[1,0]
    v_pk_add_f32 v[236:237], v[236:237], 1.0 op_sel_hi:[1,0]
    v_pk_add_f32 v[238:239], v[238:239], 1.0 op_sel_hi:[1,0]
    v_rcp_f32 v232, v232
    v_rcp_f32 v233, v233
    v_rcp_f32 v234, v234
    v_rcp_f32 v235, v235
    v_rcp_f32 v236, v236
    v_rcp_f32 v237, v237
    v_rcp_f32 v238, v238
    v_rcp_f32 v239, v239
    v_pk_mul_f32 v[232:233], v[232:233], v[208:209]
    v_pk_mul_f32 v[234:235], v[234:235], v[210:211]
    v_pk_mul_f32 v[236:237], v[236:237], v[212:213]
    v_pk_mul_f32 v[238:239], v[238:239], v[214:215]
    v_cvt_pk_bf16_f32 v208, v232, v233
    v_cvt_pk_bf16_f32 v209, v234, v235
    v_cvt_pk_bf16_f32 v210, v236, v237
    v_cvt_pk_bf16_f32 v211, v238, v239
    buffer_store_dwordx4 v[208:211], v3, s[8:11], s20 offen offset:2048 sc1
    v_pk_fma_f32 v[216:217], v[216:217], v[14:15], v[176:177] op_sel:[0,1,0] op_sel_hi:[1,1,1]
    v_pk_fma_f32 v[218:219], v[218:219], v[14:15], v[178:179] op_sel:[0,1,0] op_sel_hi:[1,1,1]
    v_pk_fma_f32 v[220:221], v[220:221], v[14:15], v[180:181] op_sel:[0,1,0] op_sel_hi:[1,1,1]
    v_pk_fma_f32 v[222:223], v[222:223], v[14:15], v[182:183] op_sel:[0,1,0] op_sel_hi:[1,1,1]
    v_pk_mul_f32 v[240:241], v[216:217], v[216:217]
    v_pk_mul_f32 v[242:243], v[218:219], v[218:219]
    v_pk_mul_f32 v[244:245], v[220:221], v[220:221]
    v_pk_mul_f32 v[246:247], v[222:223], v[222:223]
    v_pk_fma_f32 v[240:241], v[240:241], s[22:23], v[12:13] op_sel_hi:[1,0,0]
    v_pk_fma_f32 v[242:243], v[242:243], s[22:23], v[12:13] op_sel_hi:[1,0,0]
    v_pk_fma_f32 v[244:245], v[244:245], s[22:23], v[12:13] op_sel_hi:[1,0,0]
    v_pk_fma_f32 v[246:247], v[246:247], s[22:23], v[12:13] op_sel_hi:[1,0,0]
    v_pk_mul_f32 v[240:241], v[240:241], v[216:217]
    v_pk_mul_f32 v[242:243], v[242:243], v[218:219]
    v_pk_mul_f32 v[244:245], v[244:245], v[220:221]
    v_pk_mul_f32 v[246:247], v[246:247], v[222:223]
    v_exp_f32 v240, v240
    v_exp_f32 v241, v241
    v_exp_f32 v242, v242
    v_exp_f32 v243, v243
    v_exp_f32 v244, v244
    v_exp_f32 v245, v245
    v_exp_f32 v246, v246
    v_exp_f32 v247, v247
    v_pk_add_f32 v[240:241], v[240:241], 1.0 op_sel_hi:[1,0]
    v_pk_add_f32 v[242:243], v[242:243], 1.0 op_sel_hi:[1,0]
    v_pk_add_f32 v[244:245], v[244:245], 1.0 op_sel_hi:[1,0]
    v_pk_add_f32 v[246:247], v[246:247], 1.0 op_sel_hi:[1,0]
    v_rcp_f32 v240, v240
    v_rcp_f32 v241, v241
    v_rcp_f32 v242, v242
    v_rcp_f32 v243, v243
    v_rcp_f32 v244, v244
    v_rcp_f32 v245, v245
    v_rcp_f32 v246, v246
    v_rcp_f32 v247, v247
    v_pk_mul_f32 v[240:241], v[240:241], v[216:217]
    v_pk_mul_f32 v[242:243], v[242:243], v[218:219]
    v_pk_mul_f32 v[244:245], v[244:245], v[220:221]
    v_pk_mul_f32 v[246:247], v[246:247], v[222:223]
    v_cvt_pk_bf16_f32 v216, v240, v241
    v_cvt_pk_bf16_f32 v217, v242, v243
    v_cvt_pk_bf16_f32 v218, v244, v245
    v_cvt_pk_bf16_f32 v219, v246, v247
    buffer_store_dwordx4 v[216:219], v3, s[8:11], s21 offen offset:2048 sc1
    v_mov_b32 v15, 0
    s_cmp_eq_u32 s53, 1
    s_cbranch_scc1 MLP_xpart
    buffer_load_dwordx4 a[200:203], v3, s[8:11], s60 offen offset:0 sc1
    v_mov_b32 v196, 0
    v_mov_b32 v197, 0
    v_mov_b32 v198, 0
    v_mov_b32 v199, 0
    v_mov_b32 v200, 0
    v_mov_b32_e64 v201, 0
    buffer_load_dwordx4 a[204:207], v3, s[8:11], s60 offen offset:1024 sc1
    v_mov_b32 v202, 0
    v_mov_b32 v203, 0
    v_mov_b32 v204, 0
    v_mov_b32 v205, 0
    v_mov_b32 v206, 0
    v_mov_b32 v207, 0
    buffer_load_dwordx4 a[208:211], v3, s[8:11], s60 offen offset:2048 sc1
    v_mov_b32 v208, 0
    v_mov_b32 v209, 0
    v_mov_b32 v210, 0
    v_mov_b32 v211, 0
    v_mov_b32 v212, 0
    v_mov_b32 v213, 0
    buffer_load_dwordx4 a[212:215], v3, s[8:11], s60 offen offset:3072 sc1
    v_mov_b32 v214, 0
    v_mov_b32 v215, 0
    v_mov_b32 v216, 0
    v_mov_b32 v217, 0
    v_mov_b32 v218, 0
    v_mov_b32 v219, 0
    buffer_load_dwordx4 a[216:219], v9, s[8:11], s60 offen sc1
    s_add_u32 s60, s60, 5120
    v_mov_b32 v220, 0
    v_mov_b32 v221, 0
    v_mov_b32 v222, 0
    v_mov_b32 v223, 0
    v_mov_b32 v224, 0
    v_mov_b32 v225, 0
    buffer_load_dword v14, v15, s[8:11], s56 offen offset:0 sc1
    buffer_load_dwordx4 a[220:223], v3, s[8:11], s60 offen offset:0 sc1
    v_mov_b32 v226, 0
    v_mov_b32 v227, 0
    v_mov_b32 v228, 0
    v_mov_b32 v229, 0
    v_mov_b32 v230, 0
    v_mov_b32 v231, 0
    buffer_load_dwordx4 a[224:227], v3, s[8:11], s60 offen offset:1024 sc1
    v_mov_b32 v232, 0
    v_mov_b32 v233, 0
    v_mov_b32 v234, 0
    v_mov_b32 v235, 0
    v_mov_b32 v236, 0
    v_mov_b32 v237, 0
    buffer_load_dwordx4 a[228:231], v3, s[8:11], s60 offen offset:2048 sc1
    v_mov_b32 v238, 0
    v_mov_b32 v239, 0
    v_mov_b32 v240, 0
    v_mov_b32 v241, 0
    v_mov_b32 v242, 0
    v_mov_b32 v243, 0
    buffer_load_dwordx4 a[232:235], v3, s[8:11], s60 offen offset:3072 sc1
    v_mov_b32 v244, 0
    v_mov_b32 v245, 0
    v_mov_b32 v246, 0
    v_mov_b32 v247, 0
    v_mov_b32 v248, 0
    v_mov_b32 v249, 0
    buffer_load_dwordx4 a[236:239], v9, s[8:11], s60 offen sc1
    s_add_u32 s60, s60, 5120
    v_mov_b32 v250, 0
    v_mov_b32 v251, 0
    v_mov_b32 v252, 0
    v_mov_b32 v253, 0
    v_mov_b32 v254, 0
    v_mov_b32 v255, 0
    s_waitcnt vmcnt(5)
    s_barrier
    s_mov_b64 exec, 1
    buffer_atomic_add v10, v11, s[8:11], s56 offen offset:2048 sc1
    s_mov_b64 exec, -1
    v_cmp_gt_u32 vcc, 16, v14
    s_nop 1
    s_cbranch_vccnz LS_spin
    s_nop 0
LS_ok:
    buffer_load_dwordx4 v[124:127], v3, s[8:11], s25 offen offset:0 sc1
    buffer_load_dwordx4 v[128:131], v3, s[8:11], s25 offen offset:1024 sc1
    buffer_load_dwordx4 v[132:135], v3, s[8:11], s25 offen offset:3072 sc1
    s_add_u32 s17, s25, 4096
    buffer_load_dwordx4 v[136:139], v3, s[8:11], s17 offen offset:0 sc1
    s_add_u32 s17, s25, 4096
    buffer_load_dwordx4 v[140:143], v3, s[8:11], s17 offen offset:2048 sc1
    s_add_u32 s17, s25, 4096
    buffer_load_dwordx4 v[144:147], v3, s[8:11], s17 offen offset:3072 sc1
    s_add_u32 s17, s25, 8192
    buffer_load_dwordx4 v[148:151], v3, s[8:11], s17 offen offset:1024 sc1
    s_add_u32 s17, s25, 8192
    buffer_load_dwordx4 v[152:155], v3, s[8:11], s17 offen offset:2048 sc1
    buffer_load_dwordx4 v[156:159], v3, s[8:11], s26 offen offset:0 sc1
    buffer_load_dwordx4 v[160:163], v3, s[8:11], s26 offen offset:1024 sc1
    buffer_load_dwordx4 v[164:167], v3, s[8:11], s26 offen offset:3072 sc1
    s_add_u32 s17, s26, 4096
    buffer_load_dwordx4 v[168:171], v3, s[8:11], s17 offen offset:0 sc1
    s_xor_b32 s16, s3, 0
    s_mul_i32 s17, s16, 15360
    s_add_u32 s17, s17, 102400
    v_add_u32 v10, s17, v3
    s_xor_b32 s16, s3, 1
    s_mul_i32 s17, s16, 15360
    s_add_u32 s17, s17, 102400
    v_add_u32 v11, s17, v3
    s_xor_b32 s16, s3, 2
    s_mul_i32 s17, s16, 15360
    s_add_u32 s17, s17, 102400
    v_add_u32 v12, s17, v3
    s_xor_b32 s16, s3, 3
    s_mul_i32 s17, s16, 15360
    s_add_u32 s17, s17, 102400
    v_add_u32 v13, s17, v3
    s_cmp_eq_u32 s47, 1
    s_cselect_b64 vcc, -1, 0
    v_cndmask_b32 v20, v20, v22, vcc
    v_cndmask_b32 v21, v21, v23, vcc
    v_lshlrev_b32_e64 v176, 16, v20
    v_and_b32 v177, 0xffff0000, v20
    v_lshlrev_b32_e64 v178, 16, v21
    v_and_b32 v179, 0xffff0000, v21
    v_cndmask_b32 v24, v24, v26, vcc
    v_cndmask_b32 v25, v25, v27, vcc
    v_lshlrev_b32_e64 v180, 16, v24
    v_and_b32 v181, 0xffff0000, v24
    v_lshlrev_b32_e64 v182, 16, v25
    v_and_b32 v183, 0xffff0000, v25
    v_cndmask_b32 v16, v16, v18, vcc
    v_cndmask_b32 v17, v17, v19, vcc
    v_lshlrev_b32_e64 v184, 16, v16
    v_and_b32 v185, 0xffff0000, v16
    v_lshlrev_b32_e64 v186, 16, v17
    v_and_b32 v187, 0xffff0000, v17
    v_cndmask_b32 v28, v28, v30, vcc
    v_cndmask_b32 v29, v29, v31, vcc
    v_lshlrev_b32_e64 v188, 16, v28
    v_and_b32 v189, 0xffff0000, v28
    v_lshlrev_b32_e64 v190, 16, v29
    v_and_b32 v191, 0xffff0000, v29
    v_cndmask_b32 v52, v52, v54, vcc
    v_cndmask_b32 v53, v53, v55, vcc
    v_lshlrev_b32_e64 v192, 16, v52
    v_and_b32 v193, 0xffff0000, v52
    v_lshlrev_b32_e64 v194, 16, v53
    v_and_b32 v195, 0xffff0000, v53
    v_pk_add_f32 v[176:177], v[176:177], v[32:33]
    v_pk_add_f32 v[178:179], v[178:179], v[34:35]
    v_pk_add_f32 v[180:181], v[180:181], v[36:37]
    v_pk_add_f32 v[182:183], v[182:183], v[38:39]
    v_pk_add_f32 v[184:185], v[184:185], v[40:41]
    v_pk_add_f32 v[186:187], v[186:187], v[42:43]
    v_pk_add_f32 v[188:189], v[188:189], v[44:45]
    v_pk_add_f32 v[190:191], v[190:191], v[46:47]
    v_pk_add_f32 v[192:193], v[192:193], v[48:49]
    v_pk_add_f32 v[194:195], v[194:195], v[50:51]
    v_lshlrev_b32 v9, 3, v1
    v_or_b32 v8, s4, v2
    v_cmp_eq_u32 vcc, 0, v8
    s_nop 1
    v_cndmask_b32 v8, -1, 0, vcc
    s_and_b32 s16, s3, 2
    s_mul_i32 s16, s16, 15360
    s_add_u32 s16, s16, 102400
    v_lshl_add_u32 v7, v0, 3, s16
    s_mul_i32 s17, s47, 1536
    v_add_u32 v6, s17, v7
    s_lshl_b32 s17, s47, 8
    s_add_u32 s17, s17, 1024
    v_add_u32 v7, s17, v7
MLP_p2:
    v_lshlrev_b32 v4, 3, v0
    v_sub_u32 v4, v10, v4
    s_waitcnt vmcnt(11)
    v_mfma_f32_16x16x32_bf16 v[196:199], a[0:3], v[124:127], v[196:199]
    s_add_u32 s17, s26, 4096
    buffer_load_dwordx4 v[172:175], v3, s[8:11], s17 offen offset:2048 sc1
    v_mfma_f32_16x16x32_bf16 v[200:203], a[4:7], v[124:127], v[200:203]
    v_mfma_f32_16x16x32_bf16 v[204:207], a[8:11], v[124:127], v[204:207]
    v_mfma_f32_16x16x32_bf16 v[208:211], a[12:15], v[124:127], v[208:211]
    v_mfma_f32_16x16x32_bf16 v[212:215], a[16:19], v[124:127], v[212:215]
    s_waitcnt vmcnt(11)
    v_mfma_f32_16x16x32_bf16 v[196:199], a[20:23], v[128:131], v[196:199]
    s_add_u32 s17, s26, 4096
    buffer_load_dwordx4 v[88:91], v3, s[8:11], s17 offen offset:3072 sc1
    v_mfma_f32_16x16x32_bf16 v[200:203], a[24:27], v[128:131], v[200:203]
    v_mfma_f32_16x16x32_bf16 v[204:207], a[28:31], v[128:131], v[204:207]
    v_mfma_f32_16x16x32_bf16 v[208:211], a[32:35], v[128:131], v[208:211]
    v_mfma_f32_16x16x32_bf16 v[212:215], a[36:39], v[128:131], v[212:215]
    s_waitcnt vmcnt(11)
    v_mfma_f32_16x16x32_bf16 v[196:199], a[60:63], v[132:135], v[196:199]
    s_add_u32 s17, s26, 8192
    buffer_load_dwordx4 v[92:95], v3, s[8:11], s17 offen offset:1024 sc1
    v_mfma_f32_16x16x32_bf16 v[200:203], a[64:67], v[132:135], v[200:203]
    v_mfma_f32_16x16x32_bf16 v[204:207], a[68:71], v[132:135], v[204:207]
    v_mfma_f32_16x16x32_bf16 v[208:211], a[72:75], v[132:135], v[208:211]
    v_mfma_f32_16x16x32_bf16 v[212:215], a[76:79], v[132:135], v[212:215]
    s_waitcnt vmcnt(11)
    v_mfma_f32_16x16x32_bf16 v[196:199], a[80:83], v[136:139], v[196:199]
    s_add_u32 s17, s26, 8192
    buffer_load_dwordx4 v[96:99], v3, s[8:11], s17 offen offset:2048 sc1
    v_mfma_f32_16x16x32_bf16 v[200:203], a[84:87], v[136:139], v[200:203]
    v_mfma_f32_16x16x32_bf16 v[204:207], a[88:91], v[136:139], v[204:207]
    v_mfma_f32_16x16x32_bf16 v[208:211], a[92:95], v[136:139], v[208:211]
    v_mfma_f32_16x16x32_bf16 v[212:215], a[96:99], v[136:139], v[212:215]
    s_waitcnt vmcnt(11)
    v_mfma_f32_16x16x32_bf16 v[196:199], a[120:123], v[140:143], v[196:199]
    buffer_load_dwordx4 v[100:103], v3, s[8:11], s27 offen offset:0 sc1
    v_mfma_f32_16x16x32_bf16 v[200:203], a[124:127], v[140:143], v[200:203]
    v_mfma_f32_16x16x32_bf16 v[204:207], a[128:131], v[140:143], v[204:207]
    v_mfma_f32_16x16x32_bf16 v[208:211], a[132:135], v[140:143], v[208:211]
    v_mfma_f32_16x16x32_bf16 v[212:215], a[136:139], v[140:143], v[212:215]
    s_waitcnt vmcnt(11)
    v_mfma_f32_16x16x32_bf16 v[196:199], a[140:143], v[144:147], v[196:199]
    buffer_load_dwordx4 v[104:107], v3, s[8:11], s27 offen offset:1024 sc1
    v_mfma_f32_16x16x32_bf16 v[200:203], a[144:147], v[144:147], v[200:203]
    v_mfma_f32_16x16x32_bf16 v[204:207], a[148:151], v[144:147], v[204:207]
    v_mfma_f32_16x16x32_bf16 v[208:211], a[152:155], v[144:147], v[208:211]
    v_mfma_f32_16x16x32_bf16 v[212:215], a[156:159], v[144:147], v[212:215]
    s_waitcnt vmcnt(11)
    v_mfma_f32_16x16x32_bf16 v[196:199], a[180:183], v[148:151], v[196:199]
    buffer_load_dwordx4 v[108:111], v3, s[8:11], s27 offen offset:3072 sc1
    v_mfma_f32_16x16x32_bf16 v[200:203], a[184:187], v[148:151], v[200:203]
    v_mfma_f32_16x16x32_bf16 v[204:207], a[188:191], v[148:151], v[204:207]
    v_mfma_f32_16x16x32_bf16 v[208:211], a[192:195], v[148:151], v[208:211]
    v_mfma_f32_16x16x32_bf16 v[212:215], a[196:199], v[148:151], v[212:215]
    s_waitcnt vmcnt(11)
    v_mfma_f32_16x16x32_bf16 v[196:199], a[200:203], v[152:155], v[196:199]
    s_add_u32 s17, s27, 4096
    buffer_load_dwordx4 v[112:115], v3, s[8:11], s17 offen offset:0 sc1
    v_mfma_f32_16x16x32_bf16 v[200:203], a[204:207], v[152:155], v[200:203]
    v_mfma_f32_16x16x32_bf16 v[204:207], a[208:211], v[152:155], v[204:207]
    v_mfma_f32_16x16x32_bf16 v[208:211], a[212:215], v[152:155], v[208:211]
    v_mfma_f32_16x16x32_bf16 v[212:215], a[216:219], v[152:155], v[212:215]
    s_waitcnt vmcnt(11)
    v_mfma_f32_16x16x32_bf16 v[216:219], a[0:3], v[156:159], v[216:219]
    s_add_u32 s17, s27, 4096
    buffer_load_dwordx4 v[116:119], v3, s[8:11], s17 offen offset:2048 sc1
    v_mfma_f32_16x16x32_bf16 v[220:223], a[4:7], v[156:159], v[220:223]
    v_mfma_f32_16x16x32_bf16 v[224:227], a[8:11], v[156:159], v[224:227]
    v_mfma_f32_16x16x32_bf16 v[228:231], a[12:15], v[156:159], v[228:231]
    v_mfma_f32_16x16x32_bf16 v[232:235], a[16:19], v[156:159], v[232:235]
    s_waitcnt vmcnt(11)
    v_mfma_f32_16x16x32_bf16 v[216:219], a[20:23], v[160:163], v[216:219]
    s_add_u32 s17, s27, 4096
    buffer_load_dwordx4 v[120:123], v3, s[8:11], s17 offen offset:3072 sc1
    v_mfma_f32_16x16x32_bf16 v[220:223], a[24:27], v[160:163], v[220:223]
    v_mfma_f32_16x16x32_bf16 v[224:227], a[28:31], v[160:163], v[224:227]
    v_mfma_f32_16x16x32_bf16 v[228:231], a[32:35], v[160:163], v[228:231]
    v_mfma_f32_16x16x32_bf16 v[232:235], a[36:39], v[160:163], v[232:235]
    s_waitcnt vmcnt(11)
    v_mfma_f32_16x16x32_bf16 v[216:219], a[60:63], v[164:167], v[216:219]
    s_add_u32 s17, s27, 8192
    buffer_load_dwordx4 v[16:19], v3, s[8:11], s17 offen offset:1024 sc1
    buffer_load_dword v14, v15, s[8:11], s56 offen offset:2048 sc1
    v_mfma_f32_16x16x32_bf16 v[220:223], a[64:67], v[164:167], v[220:223]
    v_mfma_f32_16x16x32_bf16 v[224:227], a[68:71], v[164:167], v[224:227]
    v_mfma_f32_16x16x32_bf16 v[228:231], a[72:75], v[164:167], v[228:231]
    v_mfma_f32_16x16x32_bf16 v[232:235], a[76:79], v[164:167], v[232:235]
    s_waitcnt vmcnt(12)
    v_mfma_f32_16x16x32_bf16 v[216:219], a[80:83], v[168:171], v[216:219]
    s_add_u32 s17, s27, 8192
    buffer_load_dwordx4 v[20:23], v3, s[8:11], s17 offen offset:2048 sc1
    v_mfma_f32_16x16x32_bf16 v[220:223], a[84:87], v[168:171], v[220:223]
    v_mfma_f32_16x16x32_bf16 v[224:227], a[88:91], v[168:171], v[224:227]
    v_mfma_f32_16x16x32_bf16 v[228:231], a[92:95], v[168:171], v[228:231]
    v_mfma_f32_16x16x32_bf16 v[232:235], a[96:99], v[168:171], v[232:235]
    s_waitcnt vmcnt(12)
    v_mfma_f32_16x16x32_bf16 v[216:219], a[120:123], v[172:175], v[216:219]
    buffer_load_dwordx4 v[24:27], v3, s[8:11], s24 offen offset:0 sc1
    v_mfma_f32_16x16x32_bf16 v[220:223], a[124:127], v[172:175], v[220:223]
    v_mfma_f32_16x16x32_bf16 v[224:227], a[128:131], v[172:175], v[224:227]
    v_mfma_f32_16x16x32_bf16 v[228:231], a[132:135], v[172:175], v[228:231]
    v_mfma_f32_16x16x32_bf16 v[232:235], a[136:139], v[172:175], v[232:235]
    s_waitcnt vmcnt(12)
    v_mfma_f32_16x16x32_bf16 v[216:219], a[140:143], v[88:91], v[216:219]
    buffer_load_dwordx4 v[28:31], v3, s[8:11], s24 offen offset:1024 sc1
    v_mfma_f32_16x16x32_bf16 v[220:223], a[144:147], v[88:91], v[220:223]
    v_mfma_f32_16x16x32_bf16 v[224:227], a[148:151], v[88:91], v[224:227]
    v_mfma_f32_16x16x32_bf16 v[228:231], a[152:155], v[88:91], v[228:231]
    v_mfma_f32_16x16x32_bf16 v[232:235], a[156:159], v[88:91], v[232:235]
    s_waitcnt vmcnt(12)
    v_mfma_f32_16x16x32_bf16 v[216:219], a[180:183], v[92:95], v[216:219]
    buffer_load_dwordx4 v[32:35], v3, s[8:11], s24 offen offset:3072 sc1
    v_mfma_f32_16x16x32_bf16 v[220:223], a[184:187], v[92:95], v[220:223]
    v_mfma_f32_16x16x32_bf16 v[224:227], a[188:191], v[92:95], v[224:227]
    v_mfma_f32_16x16x32_bf16 v[228:231], a[192:195], v[92:95], v[228:231]
    v_mfma_f32_16x16x32_bf16 v[232:235], a[196:199], v[92:95], v[232:235]
    s_waitcnt vmcnt(12)
    v_mfma_f32_16x16x32_bf16 v[216:219], a[200:203], v[96:99], v[216:219]
    s_add_u32 s17, s24, 4096
    buffer_load_dwordx4 v[36:39], v3, s[8:11], s17 offen offset:0 sc1
    v_mfma_f32_16x16x32_bf16 v[220:223], a[204:207], v[96:99], v[220:223]
    v_mfma_f32_16x16x32_bf16 v[224:227], a[208:211], v[96:99], v[224:227]
    v_mfma_f32_16x16x32_bf16 v[228:231], a[212:215], v[96:99], v[228:231]
    v_mfma_f32_16x16x32_bf16 v[232:235], a[216:219], v[96:99], v[232:235]
    s_waitcnt vmcnt(12)
    v_mfma_f32_16x16x32_bf16 v[236:239], a[0:3], v[100:103], v[236:239]
    s_add_u32 s17, s24, 4096
    buffer_load_dwordx4 v[40:43], v3, s[8:11], s17 offen offset:2048 sc1
    v_mfma_f32_16x16x32_bf16 v[240:243], a[4:7], v[100:103], v[240:243]
    v_mfma_f32_16x16x32_bf16 v[244:247], a[8:11], v[100:103], v[244:247]
    v_mfma_f32_16x16x32_bf16 v[248:251], a[12:15], v[100:103], v[248:251]
    v_mfma_f32_16x16x32_bf16 v[252:255], a[16:19], v[100:103], v[252:255]
    s_waitcnt vmcnt(12)
    v_mfma_f32_16x16x32_bf16 v[236:239], a[20:23], v[104:107], v[236:239]
    s_add_u32 s17, s24, 4096
    buffer_load_dwordx4 v[44:47], v3, s[8:11], s17 offen offset:3072 sc1
    v_mfma_f32_16x16x32_bf16 v[240:243], a[24:27], v[104:107], v[240:243]
    v_mfma_f32_16x16x32_bf16 v[244:247], a[28:31], v[104:107], v[244:247]
    v_mfma_f32_16x16x32_bf16 v[248:251], a[32:35], v[104:107], v[248:251]
    v_mfma_f32_16x16x32_bf16 v[252:255], a[36:39], v[104:107], v[252:255]
    s_waitcnt vmcnt(12)
    v_mfma_f32_16x16x32_bf16 v[236:239], a[60:63], v[108:111], v[236:239]
    s_add_u32 s17, s24, 8192
    buffer_load_dwordx4 v[48:51], v3, s[8:11], s17 offen offset:1024 sc1
    v_mfma_f32_16x16x32_bf16 v[240:243], a[64:67], v[108:111], v[240:243]
    v_mfma_f32_16x16x32_bf16 v[244:247], a[68:71], v[108:111], v[244:247]
    v_mfma_f32_16x16x32_bf16 v[248:251], a[72:75], v[108:111], v[248:251]
    v_mfma_f32_16x16x32_bf16 v[252:255], a[76:79], v[108:111], v[252:255]
    s_waitcnt vmcnt(12)
    v_mfma_f32_16x16x32_bf16 v[236:239], a[80:83], v[112:115], v[236:239]
    s_add_u32 s17, s24, 8192
    buffer_load_dwordx4 v[52:55], v3, s[8:11], s17 offen offset:2048 sc1
    v_mfma_f32_16x16x32_bf16 v[240:243], a[84:87], v[112:115], v[240:243]
    v_mfma_f32_16x16x32_bf16 v[244:247], a[88:91], v[112:115], v[244:247]
    v_mfma_f32_16x16x32_bf16 v[248:251], a[92:95], v[112:115], v[248:251]
    v_mfma_f32_16x16x32_bf16 v[252:255], a[96:99], v[112:115], v[252:255]
    s_waitcnt vmcnt(12)
    v_mfma_f32_16x16x32_bf16 v[236:239], a[120:123], v[116:119], v[236:239]
    s_waitcnt vmcnt(9)
    v_cmp_gt_u32 vcc, 16, v14
    s_nop 1
    s_cbranch_vccnz LB_spin
LB_ok:
    buffer_load_dwordx4 v[56:59], v3, s[8:11], s25 offen offset:2048 sc1
    v_mfma_f32_16x16x32_bf16 v[240:243], a[124:127], v[116:119], v[240:243]
    v_mfma_f32_16x16x32_bf16 v[244:247], a[128:131], v[116:119], v[244:247]
    v_mfma_f32_16x16x32_bf16 v[248:251], a[132:135], v[116:119], v[248:251]
    v_mfma_f32_16x16x32_bf16 v[252:255], a[136:139], v[116:119], v[252:255]
    s_waitcnt vmcnt(12)
    v_mfma_f32_16x16x32_bf16 v[236:239], a[140:143], v[120:123], v[236:239]
    s_add_u32 s17, s25, 4096
    buffer_load_dwordx4 v[60:63], v3, s[8:11], s17 offen offset:1024 sc1
    v_mfma_f32_16x16x32_bf16 v[240:243], a[144:147], v[120:123], v[240:243]
    v_mfma_f32_16x16x32_bf16 v[244:247], a[148:151], v[120:123], v[244:247]
    v_mfma_f32_16x16x32_bf16 v[248:251], a[152:155], v[120:123], v[248:251]
    v_mfma_f32_16x16x32_bf16 v[252:255], a[156:159], v[120:123], v[252:255]
    s_waitcnt vmcnt(12)
    v_mfma_f32_16x16x32_bf16 v[236:239], a[180:183], v[16:19], v[236:239]
    s_add_u32 s17, s25, 8192
    buffer_load_dwordx4 v[64:67], v3, s[8:11], s17 offen offset:0 sc1
    v_mfma_f32_16x16x32_bf16 v[240:243], a[184:187], v[16:19], v[240:243]
    v_mfma_f32_16x16x32_bf16 v[244:247], a[188:191], v[16:19], v[244:247]
    v_mfma_f32_16x16x32_bf16 v[248:251], a[192:195], v[16:19], v[248:251]
    v_mfma_f32_16x16x32_bf16 v[252:255], a[196:199], v[16:19], v[252:255]
    s_waitcnt vmcnt(11)
    v_mfma_f32_16x16x32_bf16 v[236:239], a[200:203], v[20:23], v[236:239]
    s_add_u32 s17, s25, 8192
    buffer_load_dwordx4 v[68:71], v3, s[8:11], s17 offen offset:3072 sc1
    v_mfma_f32_16x16x32_bf16 v[240:243], a[204:207], v[20:23], v[240:243]
    v_mfma_f32_16x16x32_bf16 v[244:247], a[208:211], v[20:23], v[244:247]
    v_mfma_f32_16x16x32_bf16 v[248:251], a[212:215], v[20:23], v[248:251]
    v_mfma_f32_16x16x32_bf16 v[252:255], a[216:219], v[20:23], v[252:255]
    s_waitcnt vmcnt(11)
    v_mfma_f32_16x16x32_bf16 v[176:179], a[0:3], v[24:27], v[176:179]
    buffer_load_dwordx4 v[72:75], v3, s[8:11], s26 offen offset:2048 sc1
    v_mfma_f32_16x16x32_bf16 v[180:183], a[4:7], v[24:27], v[180:183]
    v_mfma_f32_16x16x32_bf16 v[184:187], a[8:11], v[24:27], v[184:187]
    v_mfma_f32_16x16x32_bf16 v[188:191], a[12:15], v[24:27], v[188:191]
    v_mfma_f32_16x16x32_bf16 v[192:195], a[16:19], v[24:27], v[192:195]
    s_waitcnt vmcnt(11)
    v_mfma_f32_16x16x32_bf16 v[176:179], a[20:23], v[28:31], v[176:179]
    s_add_u32 s17, s26, 4096
    buffer_load_dwordx4 v[76:79], v3, s[8:11], s17 offen offset:1024 sc1
    v_mfma_f32_16x16x32_bf16 v[180:183], a[24:27], v[28:31], v[180:183]
    v_mfma_f32_16x16x32_bf16 v[184:187], a[28:31], v[28:31], v[184:187]
    v_mfma_f32_16x16x32_bf16 v[188:191], a[32:35], v[28:31], v[188:191]
    v_mfma_f32_16x16x32_bf16 v[192:195], a[36:39], v[28:31], v[192:195]
    s_waitcnt vmcnt(11)
    v_mfma_f32_16x16x32_bf16 v[176:179], a[60:63], v[32:35], v[176:179]
    s_add_u32 s17, s26, 8192
    buffer_load_dwordx4 v[80:83], v3, s[8:11], s17 offen offset:0 sc1
    v_mfma_f32_16x16x32_bf16 v[180:183], a[64:67], v[32:35], v[180:183]
    v_mfma_f32_16x16x32_bf16 v[184:187], a[68:71], v[32:35], v[184:187]
    v_mfma_f32_16x16x32_bf16 v[188:191], a[72:75], v[32:35], v[188:191]
    v_mfma_f32_16x16x32_bf16 v[192:195], a[76:79], v[32:35], v[192:195]
    s_waitcnt vmcnt(11)
    v_mfma_f32_16x16x32_bf16 v[176:179], a[80:83], v[36:39], v[176:179]
    s_add_u32 s17, s26, 8192
    buffer_load_dwordx4 v[84:87], v3, s[8:11], s17 offen offset:3072 sc1
    v_mfma_f32_16x16x32_bf16 v[180:183], a[84:87], v[36:39], v[180:183]
    v_mfma_f32_16x16x32_bf16 v[184:187], a[88:91], v[36:39], v[184:187]
    v_mfma_f32_16x16x32_bf16 v[188:191], a[92:95], v[36:39], v[188:191]
    v_mfma_f32_16x16x32_bf16 v[192:195], a[96:99], v[36:39], v[192:195]
    s_waitcnt vmcnt(7)
    v_mfma_f32_16x16x32_bf16 v[196:199], a[40:43], v[56:59], v[196:199]
    buffer_load_dwordx4 v[124:127], v3, s[8:11], s27 offen offset:2048 sc1
    v_mfma_f32_16x16x32_bf16 v[200:203], a[44:47], v[56:59], v[200:203]
    v_mfma_f32_16x16x32_bf16 v[204:207], a[48:51], v[56:59], v[204:207]
    v_mfma_f32_16x16x32_bf16 v[208:211], a[52:55], v[56:59], v[208:211]
    v_mfma_f32_16x16x32_bf16 v[212:215], a[56:59], v[56:59], v[212:215]
    s_waitcnt vmcnt(7)
    v_mfma_f32_16x16x32_bf16 v[196:199], a[100:103], v[60:63], v[196:199]
    s_add_u32 s17, s27, 4096
    buffer_load_dwordx4 v[128:131], v3, s[8:11], s17 offen offset:1024 sc1
    v_mfma_f32_16x16x32_bf16 v[200:203], a[104:107], v[60:63], v[200:203]
    v_mfma_f32_16x16x32_bf16 v[204:207], a[108:111], v[60:63], v[204:207]
    v_mfma_f32_16x16x32_bf16 v[208:211], a[112:115], v[60:63], v[208:211]
    v_mfma_f32_16x16x32_bf16 v[212:215], a[116:119], v[60:63], v[212:215]
    s_waitcnt vmcnt(7)
    v_mfma_f32_16x16x32_bf16 v[196:199], a[160:163], v[64:67], v[196:199]
    s_add_u32 s17, s27, 8192
    buffer_load_dwordx4 v[132:135], v3, s[8:11], s17 offen offset:0 sc1
    v_mfma_f32_16x16x32_bf16 v[200:203], a[164:167], v[64:67], v[200:203]
    v_mfma_f32_16x16x32_bf16 v[204:207], a[168:171], v[64:67], v[204:207]
    v_mfma_f32_16x16x32_bf16 v[208:211], a[172:175], v[64:67], v[208:211]
    v_mfma_f32_16x16x32_bf16 v[212:215], a[176:179], v[64:67], v[212:215]
    s_waitcnt vmcnt(7)
    v_mfma_f32_16x16x32_bf16 v[196:199], a[220:223], v[68:71], v[196:199]
    s_add_u32 s17, s27, 8192
    buffer_load_dwordx4 v[136:139], v3, s[8:11], s17 offen offset:3072 sc1
    v_mfma_f32_16x16x32_bf16 v[200:203], a[224:227], v[68:71], v[200:203]
    v_mfma_f32_16x16x32_bf16 v[204:207], a[228:231], v[68:71], v[204:207]
    v_mfma_f32_16x16x32_bf16 v[208:211], a[232:235], v[68:71], v[208:211]
    v_mfma_f32_16x16x32_bf16 v[212:215], a[236:239], v[68:71], v[212:215]
    s_waitcnt vmcnt(7)
    v_mfma_f32_16x16x32_bf16 v[216:219], a[40:43], v[72:75], v[216:219]
    buffer_load_dwordx4 v[140:143], v3, s[8:11], s24 offen offset:2048 sc1
    v_mfma_f32_16x16x32_bf16 v[220:223], a[44:47], v[72:75], v[220:223]
    ds_write_b128 v11, v[196:199] offset:0
    v_mfma_f32_16x16x32_bf16 v[224:227], a[48:51], v[72:75], v[224:227]
    v_mfma_f32_16x16x32_bf16 v[228:231], a[52:55], v[72:75], v[228:231]
    v_mfma_f32_16x16x32_bf16 v[232:235], a[56:59], v[72:75], v[232:235]
    s_waitcnt vmcnt(7)
    v_mfma_f32_16x16x32_bf16 v[216:219], a[100:103], v[76:79], v[216:219]
    s_add_u32 s17, s24, 4096
    buffer_load_dwordx4 v[144:147], v3, s[8:11], s17 offen offset:1024 sc1
    ds_write_b128 v11, v[200:203] offset:1024
    v_mfma_f32_16x16x32_bf16 v[220:223], a[104:107], v[76:79], v[220:223]
    v_mfma_f32_16x16x32_bf16 v[224:227], a[108:111], v[76:79], v[224:227]
    v_mfma_f32_16x16x32_bf16 v[228:231], a[112:115], v[76:79], v[228:231]
    v_mfma_f32_16x16x32_bf16 v[232:235], a[116:119], v[76:79], v[232:235]
    ds_write_b128 v11, v[204:207] offset:2048
    s_waitcnt vmcnt(7)
    v_mfma_f32_16x16x32_bf16 v[216:219], a[160:163], v[80:83], v[216:219]
    s_add_u32 s17, s24, 8192
    buffer_load_dwordx4 v[148:151], v3, s[8:11], s17 offen offset:0 sc1
    v_mfma_f32_16x16x32_bf16 v[220:223], a[164:167], v[80:83], v[220:223]
    v_mfma_f32_16x16x32_bf16 v[224:227], a[168:171], v[80:83], v[224:227]
    v_mfma_f32_16x16x32_bf16 v[228:231], a[172:175], v[80:83], v[228:231]
    ds_write_b128 v11, v[208:211] offset:3072
    v_mfma_f32_16x16x32_bf16 v[232:235], a[176:179], v[80:83], v[232:235]
    s_waitcnt vmcnt(7)
    v_mfma_f32_16x16x32_bf16 v[216:219], a[220:223], v[84:87], v[216:219]
    s_add_u32 s17, s24, 8192
    buffer_load_dwordx4 v[152:155], v3, s[8:11], s17 offen offset:3072 sc1
    v_mfma_f32_16x16x32_bf16 v[220:223], a[224:227], v[84:87], v[220:223]
    v_mfma_f32_16x16x32_bf16 v[224:227], a[228:231], v[84:87], v[224:227]
    ds_write_b128 v11, v[212:215] offset:4096
    v_mfma_f32_16x16x32_bf16 v[228:231], a[232:235], v[84:87], v[228:231]
    v_mfma_f32_16x16x32_bf16 v[232:235], a[236:239], v[84:87], v[232:235]
    s_waitcnt vmcnt(7)
    v_mfma_f32_16x16x32_bf16 v[236:239], a[40:43], v[124:127], v[236:239]
    v_mfma_f32_16x16x32_bf16 v[240:243], a[44:47], v[124:127], v[240:243]
    ds_write_b128 v12, v[216:219] offset:5120
    v_mfma_f32_16x16x32_bf16 v[244:247], a[48:51], v[124:127], v[244:247]
    v_mfma_f32_16x16x32_bf16 v[248:251], a[52:55], v[124:127], v[248:251]
    v_mfma_f32_16x16x32_bf16 v[252:255], a[56:59], v[124:127], v[252:255]
    s_waitcnt vmcnt(6)
    v_mfma_f32_16x16x32_bf16 v[236:239], a[100:103], v[128:131], v[236:239]
    ds_write_b128 v12, v[220:223] offset:6144
    v_mfma_f32_16x16x32_bf16 v[240:243], a[104:107], v[128:131], v[240:243]
    v_mfma_f32_16x16x32_bf16 v[244:247], a[108:111], v[128:131], v[244:247]
    v_mfma_f32_16x16x32_bf16 v[248:251], a[112:115], v[128:131], v[248:251]
    v_mfma_f32_16x16x32_bf16 v[252:255], a[116:119], v[128:131], v[252:255]
    ds_write_b128 v12, v[224:227] offset:7168
    s_waitcnt vmcnt(5)
    v_mfma_f32_16x16x32_bf16 v[236:239], a[160:163], v[132:135], v[236:239]
    v_mfma_f32_16x16x32_bf16 v[240:243], a[164:167], v[132:135], v[240:243]
    v_mfma_f32_16x16x32_bf16 v[244:247], a[168:171], v[132:135], v[244:247]
    v_mfma_f32_16x16x32_bf16 v[248:251], a[172:175], v[132:135], v[248:251]
    ds_write_b128 v12, v[228:231] offset:8192
    v_mfma_f32_16x16x32_bf16 v[252:255], a[176:179], v[132:135], v[252:255]
    s_waitcnt vmcnt(4)
    v_mfma_f32_16x16x32_bf16 v[236:239], a[220:223], v[136:139], v[236:239]
    v_mfma_f32_16x16x32_bf16 v[240:243], a[224:227], v[136:139], v[240:243]
    v_mfma_f32_16x16x32_bf16 v[244:247], a[228:231], v[136:139], v[244:247]
    ds_write_b128 v12, v[232:235] offset:9216
    v_mfma_f32_16x16x32_bf16 v[248:251], a[232:235], v[136:139], v[248:251]
    v_mfma_f32_16x16x32_bf16 v[252:255], a[236:239], v[136:139], v[252:255]
    s_waitcnt vmcnt(19)
    v_mfma_f32_16x16x32_bf16 v[176:179], a[120:123], v[40:43], v[176:179]
    s_waitcnt lgkmcnt(0)
    s_barrier
    v_mfma_f32_16x16x32_bf16 v[180:183], a[124:127], v[40:43], v[180:183]
    ds_write_b128 v13, v[236:239] offset:10240
    v_mfma_f32_16x16x32_bf16 v[184:187], a[128:131], v[40:43], v[184:187]
    ds_read_b128 v[196:199], v10 offset:0
    v_mfma_f32_16x16x32_bf16 v[188:191], a[132:135], v[40:43], v[188:191]
    ds_read_b128 v[200:203], v10 offset:1024
    v_mfma_f32_16x16x32_bf16 v[192:195], a[136:139], v[40:43], v[192:195]
    ds_write_b128 v13, v[240:243] offset:11264
    s_waitcnt vmcnt(18)
    v_mfma_f32_16x16x32_bf16 v[176:179], a[140:143], v[44:47], v[176:179]
    ds_read_b128 v[204:207], v10 offset:2048
    v_mfma_f32_16x16x32_bf16 v[180:183], a[144:147], v[44:47], v[180:183]
    ds_read_b128 v[208:211], v10 offset:3072
    v_mfma_f32_16x16x32_bf16 v[184:187], a[148:151], v[44:47], v[184:187]
    ds_write_b128 v13, v[244:247] offset:12288
    v_mfma_f32_16x16x32_bf16 v[188:191], a[152:155], v[44:47], v[188:191]
    ds_read_b128 v[212:215], v10 offset:4096
    v_mfma_f32_16x16x32_bf16 v[192:195], a[156:159], v[44:47], v[192:195]
    ds_read_b128 v[216:219], v10 offset:5120
    s_waitcnt vmcnt(17)
    v_mfma_f32_16x16x32_bf16 v[176:179], a[180:183], v[48:51], v[176:179]
    ds_write_b128 v13, v[248:251] offset:13312
    v_mfma_f32_16x16x32_bf16 v[180:183], a[184:187], v[48:51], v[180:183]
    ds_read_b128 v[220:223], v10 offset:6144
    v_mfma_f32_16x16x32_bf16 v[184:187], a[188:191], v[48:51], v[184:187]
    ds_read_b128 v[224:227], v10 offset:7168
    v_mfma_f32_16x16x32_bf16 v[188:191], a[192:195], v[48:51], v[188:191]
    ds_write_b128 v13, v[252:255] offset:14336
    v_mfma_f32_16x16x32_bf16 v[192:195], a[196:199], v[48:51], v[192:195]
    ds_read_b128 v[228:231], v10 offset:8192
    s_waitcnt vmcnt(16)
    v_mfma_f32_16x16x32_bf16 v[176:179], a[200:203], v[52:55], v[176:179]
    ds_read_b128 v[232:235], v10 offset:9216
    v_mfma_f32_16x16x32_bf16 v[180:183], a[204:207], v[52:55], v[180:183]
    v_mfma_f32_16x16x32_bf16 v[184:187], a[208:211], v[52:55], v[184:187]
    s_waitcnt lgkmcnt(0)
    s_barrier
    v_mfma_f32_16x16x32_bf16 v[188:191], a[212:215], v[52:55], v[188:191]
    ds_read_b128 v[236:239], v10 offset:10240
    v_add_f32_e64 v196, v196, v216
    v_mfma_f32_16x16x32_bf16 v[192:195], a[216:219], v[52:55], v[192:195]
    ds_read_b128 v[240:243], v10 offset:11264
    v_add_f32 v197, v197, v217
    s_waitcnt vmcnt(3)
    v_mfma_f32_16x16x32_bf16 v[176:179], a[40:43], v[140:143], v[176:179]
    ds_read_b128 v[244:247], v10 offset:12288
    v_add_f32_e64 v198, v198, v218
    v_mfma_f32_16x16x32_bf16 v[180:183], a[44:47], v[140:143], v[180:183]
    ds_read_b128 v[248:251], v10 offset:13312
    v_add_f32_e64 v199, v199, v219
    v_mfma_f32_16x16x32_bf16 v[184:187], a[48:51], v[140:143], v[184:187]
    ds_read_b128 v[252:255], v10 offset:14336
    v_add_f32_e64 v200, v200, v220
    v_mfma_f32_16x16x32_bf16 v[188:191], a[52:55], v[140:143], v[188:191]
    v_add_f32 v201, v201, v221
    v_add_f32 v202, v202, v222
    v_mfma_f32_16x16x32_bf16 v[192:195], a[56:59], v[140:143], v[192:195]
    v_add_f32 v203, v203, v223
    v_add_f32 v204, v204, v224
    s_waitcnt vmcnt(2)
    v_mfma_f32_16x16x32_bf16 v[176:179], a[100:103], v[144:147], v[176:179]
    v_add_f32 v205, v205, v225
    v_add_f32_e64 v206, v206, v226
    v_mfma_f32_16x16x32_bf16 v[180:183], a[104:107], v[144:147], v[180:183]
    v_add_f32 v207, v207, v227
    v_add_f32 v208, v208, v228
    v_mfma_f32_16x16x32_bf16 v[184:187], a[108:111], v[144:147], v[184:187]
    v_add_f32 v209, v209, v229
    v_add_f32 v210, v210, v230
    v_mfma_f32_16x16x32_bf16 v[188:191], a[112:115], v[144:147], v[188:191]
    v_add_f32 v211, v211, v231
    v_add_f32 v212, v212, v232
    v_mfma_f32_16x16x32_bf16 v[192:195], a[116:119], v[144:147], v[192:195]
    v_add_f32 v213, v213, v233
    v_add_f32 v214, v214, v234
    s_waitcnt vmcnt(1)
    v_mfma_f32_16x16x32_bf16 v[176:179], a[160:163], v[148:151], v[176:179]
    v_add_f32 v215, v215, v235
    v_mfma_f32_16x16x32_bf16 v[180:183], a[164:167], v[148:151], v[180:183]
    s_waitcnt lgkmcnt(0)
    v_mfma_f32_16x16x32_bf16 v[184:187], a[168:171], v[148:151], v[184:187]
    v_add_f32 v196, v196, v236
    v_add_f32_e64 v197, v197, v237
    v_mfma_f32_16x16x32_bf16 v[188:191], a[172:175], v[148:151], v[188:191]
    v_add_f32 v198, v198, v238
    v_add_f32 v199, v199, v239
    v_mfma_f32_16x16x32_bf16 v[192:195], a[176:179], v[148:151], v[192:195]
    v_add_f32 v200, v200, v240
    v_add_f32 v201, v201, v241
    s_waitcnt vmcnt(0)
    v_mfma_f32_16x16x32_bf16 v[176:179], a[220:223], v[152:155], v[176:179]
    v_add_f32 v202, v202, v242
    v_add_f32_e64 v203, v203, v243
    v_mfma_f32_16x16x32_bf16 v[180:183], a[224:227], v[152:155], v[180:183]
    v_add_f32 v204, v204, v244
    v_add_f32 v205, v205, v245
    v_mfma_f32_16x16x32_bf16 v[184:187], a[228:231], v[152:155], v[184:187]
    v_add_f32 v206, v206, v246
    v_add_f32 v207, v207, v247
    v_mfma_f32_16x16x32_bf16 v[188:191], a[232:235], v[152:155], v[188:191]
    v_add_f32 v208, v208, v248
    v_add_f32 v209, v209, v249
    v_mfma_f32_16x16x32_bf16 v[192:195], a[236:239], v[152:155], v[192:195]
    v_add_f32 v210, v210, v250
    v_add_f32 v211, v211, v251
    v_add_f32 v212, v212, v252
    v_add_f32 v213, v213, v253
    v_add_f32 v214, v214, v254
    v_add_f32 v215, v215, v255
    v_pk_add_f32 v[176:177], v[176:177], v[196:197]
    v_pk_add_f32 v[178:179], v[178:179], v[198:199]
    v_cvt_pk_bf16_f32 v16, v176, v177
    v_cvt_pk_bf16_f32 v17, v178, v179
    ds_write_b64 v4, v[16:17] offset:0
    v_pk_add_f32 v[180:181], v[180:181], v[200:201]
    v_pk_add_f32 v[182:183], v[182:183], v[202:203]
    v_cvt_pk_bf16_f32 v18, v180, v181
    v_cvt_pk_bf16_f32 v19, v182, v183
    ds_write_b64 v4, v[18:19] offset:512
    v_pk_add_f32 v[184:185], v[184:185], v[204:205]
    v_pk_add_f32 v[186:187], v[186:187], v[206:207]
    v_cvt_pk_bf16_f32 v20, v184, v185
    v_cvt_pk_bf16_f32 v21, v186, v187
    ds_write_b64 v4, v[20:21] offset:1024
    v_pk_add_f32 v[188:189], v[188:189], v[208:209]
    v_pk_add_f32 v[190:191], v[190:191], v[210:211]
    v_cvt_pk_bf16_f32 v22, v188, v189
    v_cvt_pk_bf16_f32 v23, v190, v191
    ds_write_b64 v4, v[22:23] offset:1536
    v_pk_add_f32 v[192:193], v[192:193], v[212:213]
    v_pk_add_f32 v[194:195], v[194:195], v[214:215]
    v_cvt_pk_bf16_f32 v24, v192, v193
    v_cvt_pk_bf16_f32 v25, v194, v195
    ds_write_b64 v4, v[24:25] offset:2048
    s_cmp_eq_u32 s53, 1
    s_cbranch_scc1 MLP_fin
    v_and_b32_e64 v177, v8, v177
    v_pk_mul_f32 v[14:15], v[176:177], v[176:177]
    v_pk_fma_f32 v[14:15], v[178:179], v[178:179], v[14:15]
    v_pk_fma_f32 v[14:15], v[180:181], v[180:181], v[14:15]
    v_pk_fma_f32 v[14:15], v[182:183], v[182:183], v[14:15]
    v_pk_fma_f32 v[14:15], v[184:185], v[184:185], v[14:15]
    v_pk_fma_f32 v[14:15], v[186:187], v[186:187], v[14:15]
    v_pk_fma_f32 v[14:15], v[188:189], v[188:189], v[14:15]
    v_pk_fma_f32 v[14:15], v[190:191], v[190:191], v[14:15]
    v_pk_fma_f32 v[14:15], v[192:193], v[192:193], v[14:15]
    v_pk_fma_f32 v[14:15], v[194:195], v[194:195], v[14:15]
    s_waitcnt lgkmcnt(0)
    s_barrier
    ds_read2st64_b64 v[28:31], v6 offset0:0 offset1:30
    ds_read2st64_b64 v[32:35], v6 offset0:1 offset1:31
    ds_read2st64_b64 v[36:39], v7 offset0:0 offset1:30
    v_add_f32 v14, v14, v15
    v_mov_b32 v15, v14
    s_nop 1
    v_permlane32_swap_b32 v14, v15
    v_add_f32 v14, v14, v15
    v_mov_b32 v15, v14
    s_nop 1
    v_permlane16_swap_b32 v14, v15
    v_add_f32 v14, v14, v15
    v_cvt_f64_f32 v[14:15], v14
    s_waitcnt lgkmcnt(2)
    buffer_store_dwordx4 v[28:31], v5, s[8:11], s44 offen sc1
    s_waitcnt lgkmcnt(1)
    buffer_store_dwordx4 v[32:35], v5, s[8:11], s43 offen sc1
    s_waitcnt lgkmcnt(0)
    s_mov_b32 exec_hi, 0
    buffer_store_dwordx4 v[36:39], v5, s[8:11], s42 offen sc1
    s_mov_b64 exec, 0xffff
    buffer_atomic_add_f64 v[14:15], v9, s[8:11], s45 offen
    s_mov_b64 exec, -1
    s_nop 0
    s_mov_b32 s48, 5242880
    s_mov_b32 s49, 7864320
    s_mov_b32 s50, 32456704
    s_mov_b32 s57, 16777216
    s_mov_b32 s58, 27000832
    s_mov_b32 s51, 348160
    s_mov_b32 s52, 32538624
    s_mov_b32 s61, 32477184
    s_mov_b32 s53, 1
    s_mul_i32 s59, s7, 122880
    s_mul_i32 s17, s3, 5120
    s_add_u32 s17, s17, 102400
    s_mov_b32 m0, s17
    s_add_u32 s59, s59, s17
    s_add_u32 s59, s59, 23068672
    s_branch KL_layer
MLP_fin:
    v_accvgpr_read_b32 v5, a250
    s_waitcnt lgkmcnt(0)
    ds_read2_b64 v[28:31], v6 offset0:0 offset1:16
    ds_read2_b64 v[32:35], v7 offset0:0 offset1:16
    ds_read2_b64 v[36:39], v2 offset0:0 offset1:16
    s_waitcnt lgkmcnt(2)
    buffer_store_dwordx4 v[28:31], v8, s[32:35], s44 offen
    s_waitcnt lgkmcnt(1)
    buffer_store_dwordx4 v[32:35], v1, s[32:35], s44 offen
    s_waitcnt lgkmcnt(0)
    s_mov_b32 exec_hi, 0
    buffer_store_dwordx4 v[36:39], v5, s[32:35], s44 offen
    s_endpgm
MLP_xpart:
    s_lshl_b32 s44, s46, 5
    s_add_u32 s44, s44, s47
    s_mul_i32 s44, s44, 1280
    s_add_u32 s44, s44, s40
    s_mul_i32 s17, s3, 10240
    s_add_u32 s17, s17, 122880
    v_add_u32 v6, s17, v3
    v_accvgpr_read_b32 v14, a249
    buffer_load_dwordx4 v[56:59], v5, s[8:11], s37 offen sc1
    s_add_u32 s37, s37, 131072
    ds_bpermute_b32 v124, v7, v14 offset:0
    ds_bpermute_b32 v125, v7, v14 offset:4
    ds_bpermute_b32 v126, v7, v14 offset:32
    ds_bpermute_b32 v127, v7, v14 offset:36
    ds_bpermute_b32 v128, v7, v14 offset:64
    ds_bpermute_b32 v129, v7, v14 offset:68
    ds_bpermute_b32 v130, v7, v14 offset:96
    ds_bpermute_b32 v131, v7, v14 offset:100
    ds_bpermute_b32 v132, v7, v14 offset:128
    ds_bpermute_b32 v133, v7, v14 offset:132
    buffer_load_dwordx4 v[60:63], v5, s[8:11], s38 offen sc1
    s_add_u32 s38, s38, 131072
    s_waitcnt vmcnt(5)
    s_cmp_eq_u32 s47, 0
    s_cbranch_scc1 MLP_sw0
    v_swap_b32 v16, v22
    v_swap_b32 v17, v23
    v_swap_b32 v24, v30
    v_swap_b32 v25, v31
    s_branch MLP_sx0
MLP_sw0:
    v_swap_b32 v18, v20
    v_swap_b32 v19, v21
    v_swap_b32 v26, v28
    v_swap_b32 v27, v29
MLP_sx0:
    s_nop 1
    s_waitcnt lgkmcnt(0)
    v_mfma_f32_16x16x32_bf16 v[196:199], v[32:35], v[20:23], 0
    buffer_load_dwordx4 v[64:67], v5, s[8:11], s39 offen sc1
    s_add_u32 s39, s39, 131072
    v_mfma_f32_16x16x32_bf16 v[200:203], v[36:39], v[20:23], 0
    v_lshlrev_b32_e64 v176, 16, v124
    v_and_b32 v177, 0xffff0000, v124
    v_mfma_f32_16x16x32_bf16 v[204:207], v[40:43], v[20:23], 0
    v_lshlrev_b32_e64 v178, 16, v125
    v_and_b32 v179, 0xffff0000, v125
    v_mfma_f32_16x16x32_bf16 v[208:211], v[44:47], v[20:23], 0
    v_lshlrev_b32_e64 v180, 16, v126
    v_and_b32 v181, 0xffff0000, v126
    v_mfma_f32_16x16x32_bf16 v[212:215], v[48:51], v[20:23], 0
    buffer_load_dwordx4 v[88:91], v5, s[8:11], s36 offen sc1
    s_add_u32 s36, s36, 131072
    v_mfma_f32_16x16x32_bf16 v[216:219], v[32:35], v[24:27], 0
    v_lshlrev_b32_e64 v182, 16, v127
    v_and_b32 v183, 0xffff0000, v127
    v_mfma_f32_16x16x32_bf16 v[220:223], v[36:39], v[24:27], 0
    v_lshlrev_b32_e64 v184, 16, v128
    v_and_b32 v185, 0xffff0000, v128
    v_mfma_f32_16x16x32_bf16 v[224:227], v[40:43], v[24:27], 0
    v_lshlrev_b32_e64 v186, 16, v129
    v_and_b32 v187, 0xffff0000, v129
    v_mfma_f32_16x16x32_bf16 v[228:231], v[44:47], v[24:27], 0
    buffer_load_dwordx4 v[92:95], v5, s[8:11], s37 offen sc1
    s_add_u32 s37, s37, 131072
    v_mfma_f32_16x16x32_bf16 v[232:235], v[48:51], v[24:27], 0
    v_lshlrev_b32_e64 v188, 16, v130
    v_and_b32 v189, 0xffff0000, v130
    v_mfma_f32_16x16x32_bf16 v[236:239], v[32:35], v[28:31], 0
    v_lshlrev_b32_e64 v190, 16, v131
    v_and_b32 v191, 0xffff0000, v131
    v_mfma_f32_16x16x32_bf16 v[240:243], v[36:39], v[28:31], 0
    v_lshlrev_b32_e64 v192, 16, v132
    v_and_b32 v193, 0xffff0000, v132
    v_mfma_f32_16x16x32_bf16 v[244:247], v[40:43], v[28:31], 0
    buffer_load_dwordx4 v[96:99], v5, s[8:11], s38 offen sc1
    s_add_u32 s38, s38, 131072
    v_mfma_f32_16x16x32_bf16 v[248:251], v[44:47], v[28:31], 0
    v_lshlrev_b32_e64 v194, 16, v133
    v_and_b32 v195, 0xffff0000, v133
    v_mfma_f32_16x16x32_bf16 v[252:255], v[48:51], v[28:31], 0
    v_mfma_f32_16x16x32_bf16 v[176:179], v[32:35], v[16:19], v[176:179]
    v_mfma_f32_16x16x32_bf16 v[180:183], v[36:39], v[16:19], v[180:183]
    buffer_load_dwordx4 v[100:103], v5, s[8:11], s39 offen sc1
    s_add_u32 s39, s39, 131072
    v_mfma_f32_16x16x32_bf16 v[184:187], v[40:43], v[16:19], v[184:187]
    v_mfma_f32_16x16x32_bf16 v[188:191], v[44:47], v[16:19], v[188:191]
    v_mfma_f32_16x16x32_bf16 v[192:195], v[48:51], v[16:19], v[192:195]
    ds_read_b128 v[68:71], v6 offset:0
    ds_read_b128 v[72:75], v6 offset:1024
    ds_read_b128 v[76:79], v6 offset:2048
    ds_read_b128 v[80:83], v6 offset:3072
    ds_read_b128 v[84:87], v6 offset:4096
    ds_read_b128 v[104:107], v6 offset:5120
    ds_read_b128 v[108:111], v6 offset:6144
    ds_read_b128 v[112:115], v6 offset:7168
    ds_read_b128 v[116:119], v6 offset:8192
    ds_read_b128 v[120:123], v6 offset:9216
    buffer_load_dword v14, v15, s[8:11], s56 offen offset:0 sc1
    buffer_load_dwordx4 v[16:19], v5, s[8:11], s36 offen sc1
    s_add_u32 s36, s36, 131072
    s_mul_i32 s17, s3, 15360
    s_add_u32 s17, s17, 102400
    v_add_u32_e64 v125, 0, v0
    v_mul_u32_u24 v126, 205, v125
    v_lshrrev_b32 v126, 11, v126
    v_mul_u32_u24 v127, 10, v126
    v_sub_u32_e64 v125, v125, v127
    v_lshl_add_u32 v6, v125, 8, s17
    buffer_load_dwordx4 v[20:23], v5, s[8:11], s37 offen sc1
    s_add_u32 s37, s37, 131072
    v_lshl_add_u32 v6, v126, 3, v6
    v_mul_u32_u24 v8, 2560, v126
    v_lshl_add_u32 v8, v125, 4, v8
    v_add_u32_e64 v125, 64, v0
    v_mul_u32_u24 v126, 205, v125
    v_lshrrev_b32 v126, 11, v126
    v_mul_u32_u24 v127, 10, v126
    v_sub_u32_e64 v125, v125, v127
    buffer_load_dwordx4 v[24:27], v5, s[8:11], s38 offen sc1
    s_add_u32 s38, s38, 131072
    v_lshl_add_u32 v7, v125, 8, s17
    v_lshl_add_u32 v7, v126, 3, v7
    v_mul_u32_u24 v1, 2560, v126
    v_lshl_add_u32 v1, v125, 4, v1
    v_add_u32 v125, 128, v0
    v_mul_u32_u24 v126, 205, v125
    v_lshrrev_b32 v126, 11, v126
    v_mul_u32_u24 v127, 10, v126
    buffer_load_dwordx4 v[28:31], v5, s[8:11], s39 offen sc1
    s_add_u32 s39, s39, 131072
    v_sub_u32_e64 v125, v125, v127
    v_lshl_add_u32 v2, v125, 8, s17
    v_lshl_add_u32 v2, v126, 3, v2
    v_mul_u32_u24 v128, 2560, v126
    v_lshl_add_u32 v128, v125, 4, v128
    v_accvgpr_write_b32 a250, v128
    s_waitcnt vmcnt(9)
    s_cmp_eq_u32 s47, 0
    s_cbranch_scc1 MLP_sw1
    v_swap_b32 v52, v58
    v_swap_b32 v53, v59
    v_swap_b32 v60, v66
    v_swap_b32 v61, v67
    s_branch MLP_sx1
MLP_sw1:
    v_swap_b32 v54, v56
    v_swap_b32 v55, v57
    v_swap_b32 v62, v64
    v_swap_b32 v63, v65
MLP_sx1:
    s_nop 1
    s_waitcnt lgkmcnt(0)
    v_mfma_f32_16x16x32_bf16 v[196:199], v[68:71], v[56:59], v[196:199]
    buffer_load_dwordx4 v[32:35], v3, s[8:11], s55 offen offset:0 sc1
    v_mfma_f32_16x16x32_bf16 v[200:203], v[72:75], v[56:59], v[200:203]
    v_mfma_f32_16x16x32_bf16 v[204:207], v[76:79], v[56:59], v[204:207]
    v_mfma_f32_16x16x32_bf16 v[208:211], v[80:83], v[56:59], v[208:211]
    v_mfma_f32_16x16x32_bf16 v[212:215], v[84:87], v[56:59], v[212:215]
    buffer_load_dwordx4 v[36:39], v3, s[8:11], s55 offen offset:1024 sc1
    v_mfma_f32_16x16x32_bf16 v[216:219], v[68:71], v[60:63], v[216:219]
    v_mfma_f32_16x16x32_bf16 v[220:223], v[72:75], v[60:63], v[220:223]
    v_mfma_f32_16x16x32_bf16 v[224:227], v[76:79], v[60:63], v[224:227]
    v_mfma_f32_16x16x32_bf16 v[228:231], v[80:83], v[60:63], v[228:231]
    buffer_load_dwordx4 v[40:43], v3, s[8:11], s55 offen offset:2048 sc1
    v_mfma_f32_16x16x32_bf16 v[232:235], v[84:87], v[60:63], v[232:235]
    v_mfma_f32_16x16x32_bf16 v[236:239], v[68:71], v[64:67], v[236:239]
    v_mfma_f32_16x16x32_bf16 v[240:243], v[72:75], v[64:67], v[240:243]
    v_mfma_f32_16x16x32_bf16 v[244:247], v[76:79], v[64:67], v[244:247]
    buffer_load_dwordx4 v[44:47], v3, s[8:11], s55 offen offset:3072 sc1
    v_mfma_f32_16x16x32_bf16 v[248:251], v[80:83], v[64:67], v[248:251]
    v_mfma_f32_16x16x32_bf16 v[252:255], v[84:87], v[64:67], v[252:255]
    v_mfma_f32_16x16x32_bf16 v[176:179], v[68:71], v[52:55], v[176:179]
    v_mfma_f32_16x16x32_bf16 v[180:183], v[72:75], v[52:55], v[180:183]
    buffer_load_dwordx4 v[48:51], v9, s[8:11], s55 offen sc1
    s_add_u32 s55, s55, 5120
    v_mfma_f32_16x16x32_bf16 v[184:187], v[76:79], v[52:55], v[184:187]
    v_mfma_f32_16x16x32_bf16 v[188:191], v[80:83], v[52:55], v[188:191]
    v_mfma_f32_16x16x32_bf16 v[192:195], v[84:87], v[52:55], v[192:195]
    s_waitcnt vmcnt(9)
    s_barrier
    s_mov_b64 exec, 1
    buffer_atomic_add v10, v11, s[8:11], s56 offen offset:2048 sc1
    s_mov_b64 exec, -1
    buffer_load_dwordx4 v[52:55], v5, s[8:11], s36 offen sc1
    s_add_u32 s36, s36, 131072
    s_cmp_eq_u32 s47, 0
    s_cbranch_scc1 MLP_sw2
    v_swap_b32 v88, v94
    v_swap_b32 v89, v95
    v_swap_b32 v96, v102
    v_swap_b32 v97, v103
    s_branch MLP_sx2
MLP_sw2:
    v_swap_b32 v90, v92
    v_swap_b32 v91, v93
    v_swap_b32 v98, v100
    v_swap_b32 v99, v101
MLP_sx2:
    s_nop 1
    v_mfma_f32_16x16x32_bf16 v[196:199], v[104:107], v[92:95], v[196:199]
    buffer_load_dwordx4 v[56:59], v5, s[8:11], s37 offen sc1
    s_add_u32 s37, s37, 131072
    v_mfma_f32_16x16x32_bf16 v[200:203], v[108:111], v[92:95], v[200:203]
    s_xor_b32 s16, s3, 0
    s_mul_i32 s16, s16, 15360
    v_mfma_f32_16x16x32_bf16 v[204:207], v[112:115], v[92:95], v[204:207]
    s_add_u32 s16, s16, 102400
    v_add_u32 v10, s16, v3
    v_mfma_f32_16x16x32_bf16 v[208:211], v[116:119], v[92:95], v[208:211]
    s_xor_b32 s16, s3, 1
    s_mul_i32 s16, s16, 15360
    v_mfma_f32_16x16x32_bf16 v[212:215], v[120:123], v[92:95], v[212:215]
    buffer_load_dwordx4 v[60:63], v5, s[8:11], s38 offen sc1
    s_add_u32 s38, s38, 131072
    v_mfma_f32_16x16x32_bf16 v[216:219], v[104:107], v[96:99], v[216:219]
    s_add_u32 s16, s16, 102400
    v_add_u32 v11, s16, v3
    v_mfma_f32_16x16x32_bf16 v[220:223], v[108:111], v[96:99], v[220:223]
    s_xor_b32 s16, s3, 2
    s_mul_i32 s16, s16, 15360
    v_mfma_f32_16x16x32_bf16 v[224:227], v[112:115], v[96:99], v[224:227]
    s_add_u32 s16, s16, 102400
    v_add_u32 v12, s16, v3
    v_mfma_f32_16x16x32_bf16 v[228:231], v[116:119], v[96:99], v[228:231]
    buffer_load_dwordx4 v[64:67], v5, s[8:11], s39 offen sc1
    s_add_u32 s39, s39, 131072
    v_mfma_f32_16x16x32_bf16 v[232:235], v[120:123], v[96:99], v[232:235]
    s_xor_b32 s16, s3, 3
    s_mul_i32 s16, s16, 15360
    v_mfma_f32_16x16x32_bf16 v[236:239], v[104:107], v[100:103], v[236:239]
    s_add_u32 s16, s16, 102400
    v_add_u32 v13, s16, v3
    v_mfma_f32_16x16x32_bf16 v[240:243], v[108:111], v[100:103], v[240:243]
    v_mfma_f32_16x16x32_bf16 v[244:247], v[112:115], v[100:103], v[244:247]
    buffer_load_dwordx4 v[68:71], v3, s[8:11], s55 offen offset:0 sc1
    v_mfma_f32_16x16x32_bf16 v[248:251], v[116:119], v[100:103], v[248:251]
    v_mfma_f32_16x16x32_bf16 v[252:255], v[120:123], v[100:103], v[252:255]
    v_mfma_f32_16x16x32_bf16 v[176:179], v[104:107], v[88:91], v[176:179]
    v_mfma_f32_16x16x32_bf16 v[180:183], v[108:111], v[88:91], v[180:183]
    buffer_load_dwordx4 v[72:75], v3, s[8:11], s55 offen offset:1024 sc1
    v_mfma_f32_16x16x32_bf16 v[184:187], v[112:115], v[88:91], v[184:187]
    v_mfma_f32_16x16x32_bf16 v[188:191], v[116:119], v[88:91], v[188:191]
    v_mfma_f32_16x16x32_bf16 v[192:195], v[120:123], v[88:91], v[192:195]
    buffer_load_dwordx4 v[76:79], v3, s[8:11], s55 offen offset:2048 sc1
    buffer_load_dwordx4 v[80:83], v3, s[8:11], s55 offen offset:3072 sc1
    buffer_load_dwordx4 v[84:87], v9, s[8:11], s55 offen sc1
    s_add_u32 s55, s55, 5120
    v_cmp_gt_u32 vcc, 16, v14
    s_nop 1
    s_cbranch_vccnz LX_spin
LX_ok:
    buffer_load_dwordx4 v[124:127], v3, s[8:11], s25 offen offset:0 sc1
    s_waitcnt vmcnt(11)
    s_cmp_eq_u32 s47, 0
    s_cbranch_scc1 MLP_sw3
    v_swap_b32 v16, v22
    v_swap_b32 v17, v23
    v_swap_b32 v24, v30
    v_swap_b32 v25, v31
    s_branch MLP_sx3
MLP_sw3:
    v_swap_b32 v18, v20
    v_swap_b32 v19, v21
    v_swap_b32 v26, v28
    v_swap_b32 v27, v29
MLP_sx3:
    s_nop 1
    v_mfma_f32_16x16x32_bf16 v[196:199], v[32:35], v[20:23], v[196:199]
    buffer_load_dwordx4 v[128:131], v3, s[8:11], s25 offen offset:1024 sc1
    v_mfma_f32_16x16x32_bf16 v[200:203], v[36:39], v[20:23], v[200:203]
    v_mfma_f32_16x16x32_bf16 v[204:207], v[40:43], v[20:23], v[204:207]
    v_mfma_f32_16x16x32_bf16 v[208:211], v[44:47], v[20:23], v[208:211]
    v_mfma_f32_16x16x32_bf16 v[212:215], v[48:51], v[20:23], v[212:215]
    buffer_load_dwordx4 v[132:135], v3, s[8:11], s25 offen offset:3072 sc1
    v_mfma_f32_16x16x32_bf16 v[216:219], v[32:35], v[24:27], v[216:219]
    v_mfma_f32_16x16x32_bf16 v[220:223], v[36:39], v[24:27], v[220:223]
    v_mfma_f32_16x16x32_bf16 v[224:227], v[40:43], v[24:27], v[224:227]
    v_mfma_f32_16x16x32_bf16 v[228:231], v[44:47], v[24:27], v[228:231]
    s_add_u32 s17, s25, 4096
    buffer_load_dwordx4 v[136:139], v3, s[8:11], s17 offen offset:0 sc1
    v_mfma_f32_16x16x32_bf16 v[232:235], v[48:51], v[24:27], v[232:235]
    v_mfma_f32_16x16x32_bf16 v[236:239], v[32:35], v[28:31], v[236:239]
    v_mfma_f32_16x16x32_bf16 v[240:243], v[36:39], v[28:31], v[240:243]
    v_mfma_f32_16x16x32_bf16 v[244:247], v[40:43], v[28:31], v[244:247]
    s_add_u32 s17, s25, 4096
    buffer_load_dwordx4 v[140:143], v3, s[8:11], s17 offen offset:2048 sc1
    v_mfma_f32_16x16x32_bf16 v[248:251], v[44:47], v[28:31], v[248:251]
    v_mfma_f32_16x16x32_bf16 v[252:255], v[48:51], v[28:31], v[252:255]
    v_mfma_f32_16x16x32_bf16 v[176:179], v[32:35], v[16:19], v[176:179]
    v_mfma_f32_16x16x32_bf16 v[180:183], v[36:39], v[16:19], v[180:183]
    s_add_u32 s17, s25, 4096
    buffer_load_dwordx4 v[144:147], v3, s[8:11], s17 offen offset:3072 sc1
    v_mfma_f32_16x16x32_bf16 v[184:187], v[40:43], v[16:19], v[184:187]
    v_mfma_f32_16x16x32_bf16 v[188:191], v[44:47], v[16:19], v[188:191]
    v_mfma_f32_16x16x32_bf16 v[192:195], v[48:51], v[16:19], v[192:195]
    s_add_u32 s17, s25, 8192
    buffer_load_dwordx4 v[148:151], v3, s[8:11], s17 offen offset:1024 sc1
    s_waitcnt vmcnt(7)
    s_cmp_eq_u32 s47, 0
    s_cbranch_scc1 MLP_sw4
    v_swap_b32 v52, v58
    v_swap_b32 v53, v59
    v_swap_b32 v60, v66
    v_swap_b32 v61, v67
    s_branch MLP_sx4
MLP_sw4:
    v_swap_b32 v54, v56
    v_swap_b32 v55, v57
    v_swap_b32 v62, v64
    v_swap_b32 v63, v65
MLP_sx4:
    s_nop 1
    v_mfma_f32_16x16x32_bf16 v[196:199], v[68:71], v[56:59], v[196:199]
    s_add_u32 s17, s25, 8192
    buffer_load_dwordx4 v[152:155], v3, s[8:11], s17 offen offset:2048 sc1
    v_mfma_f32_16x16x32_bf16 v[200:203], v[72:75], v[56:59], v[200:203]
    v_mfma_f32_16x16x32_bf16 v[204:207], v[76:79], v[56:59], v[204:207]
    v_mfma_f32_16x16x32_bf16 v[208:211], v[80:83], v[56:59], v[208:211]
    v_mfma_f32_16x16x32_bf16 v[212:215], v[84:87], v[56:59], v[212:215]
    buffer_load_dwordx4 v[156:159], v3, s[8:11], s26 offen offset:0 sc1
    v_mfma_f32_16x16x32_bf16 v[216:219], v[68:71], v[60:63], v[216:219]
    v_mfma_f32_16x16x32_bf16 v[220:223], v[72:75], v[60:63], v[220:223]
    v_mfma_f32_16x16x32_bf16 v[224:227], v[76:79], v[60:63], v[224:227]
    v_mfma_f32_16x16x32_bf16 v[228:231], v[80:83], v[60:63], v[228:231]
    buffer_load_dwordx4 v[160:163], v3, s[8:11], s26 offen offset:1024 sc1
    v_mfma_f32_16x16x32_bf16 v[232:235], v[84:87], v[60:63], v[232:235]
    v_mfma_f32_16x16x32_bf16 v[236:239], v[68:71], v[64:67], v[236:239]
    v_mfma_f32_16x16x32_bf16 v[240:243], v[72:75], v[64:67], v[240:243]
    v_mfma_f32_16x16x32_bf16 v[244:247], v[76:79], v[64:67], v[244:247]
    buffer_load_dwordx4 v[164:167], v3, s[8:11], s26 offen offset:3072 sc1
    v_mfma_f32_16x16x32_bf16 v[248:251], v[80:83], v[64:67], v[248:251]
    v_mfma_f32_16x16x32_bf16 v[252:255], v[84:87], v[64:67], v[252:255]
    v_mfma_f32_16x16x32_bf16 v[176:179], v[68:71], v[52:55], v[176:179]
    v_mfma_f32_16x16x32_bf16 v[180:183], v[72:75], v[52:55], v[180:183]
    s_add_u32 s17, s26, 4096
    buffer_load_dwordx4 v[168:171], v3, s[8:11], s17 offen offset:0 sc1
    v_mfma_f32_16x16x32_bf16 v[184:187], v[76:79], v[52:55], v[184:187]
    v_mfma_f32_16x16x32_bf16 v[188:191], v[80:83], v[52:55], v[188:191]
    v_mfma_f32_16x16x32_bf16 v[192:195], v[84:87], v[52:55], v[192:195]
    s_branch MLP_p2
KL_side:
    s_waitcnt vmcnt(0)
    s_barrier
    s_cmp_lg_u32 s3, 0
    s_cbranch_scc1 SA_skip
    s_sub_u32 s21, s52, 16384
    s_lshr_b32 s22, s2, 4
    s_lshl_b32 s22, s22, 7
    s_add_u32 s22, s22, s21
    v_mov_b32 v14, 1
    v_lshlrev_b32_e64 v15, 11, v0
    s_mov_b64 exec, 0xff
    buffer_atomic_add v14, v15, s[8:11], s22 offen sc1
    s_mov_b64 exec, -1
SA_skip:
    s_cmp_eq_u32 s53, 0
    s_cbranch_scc1 SA_nore
    s_nop 0
    buffer_load_dwordx4 v3, s[8:11], s59 offen offset:0 sc1 lds
    buffer_load_dwordx4 v3, s[8:11], s59 offen offset:1024 sc1 lds
    buffer_load_dwordx4 v3, s[8:11], s59 offen offset:2048 sc1 lds
    buffer_load_dwordx4 v3, s[8:11], s59 offen offset:3072 sc1 lds
    s_add_u32 m0, m0, 4096
    s_add_u32 s59, s59, 4096
    buffer_load_dwordx4 v3, s[8:11], s59 offen offset:0 sc1 lds
SA_nore:
    s_cmp_eq_u32 s53, 1
    s_cbranch_scc1 SD_l1
    s_mov_b32 s60, m0
    s_sub_u32 s14, s2, 160
    s_lshl_b32 s14, s14, 2
    s_add_u32 s14, s14, s3
    s_mov_b32 s20, 0x3acccccd
    s_mov_b32 s21, 0xc4200000
    s_mov_b32 s22, 0x3d64f92e
P0_floop:
    s_mul_i32 s15, s14, 5243
    s_lshr_b32 s15, s15, 19
    s_mul_i32 s16, s15, 100
    s_sub_u32 s16, s14, s16
    s_mul_i32 s17, s16, 13108
    s_lshr_b32 s17, s17, 16
    s_mul_i32 s18, s17, 5
    s_sub_u32 s18, s16, s18
    s_lshl_b32 s40, s18, 4
    s_mul_i32 s41, s15, 80
    s_add_u32 s40, s40, s41
    v_add_u32 v80, s40, v1
    s_lshl_b32 s41, s17, 4
    v_lshl_add_u32 v81, v2, 1, s41
    v_sub_u32 v87, 480, v81
    s_cmp_ge_u32 s17, 10
    s_cselect_b64 vcc, -1, 0
    s_cselect_b32 s23, -1.0, 1.0
    v_cndmask_b32 v87, v81, v87, vcc
    v_mul_u32_u24 v82, v80, v87
    v_cvt_f32_u32 v82, v82
    v_cvt_f32_u32_e64 v83, v80
    v_mul_f32 v92, 0x43200000, v83
    v_add_f32 v92, 0x42a00000, v92
    v_mul_f32_e64 v83, s23, v83
    v_mul_f32 v93, 0x40e00000, v83
    v_cmp_eq_u32 vcc, 160, v81
    s_nop 1
    v_cndmask_b32 v92, v82, v92, vcc
    v_cmp_eq_u32 vcc, 0, v81
    v_mul_f32 v84, s20, v92
    v_floor_f32_e64 v84, v84
    v_fma_f32 v84, v84, s21, v92
    v_mul_f32 v84, s20, v84
    v_cos_f32 v85, v84
    v_sin_f32 v86, v84
    v_add_f32 v82, v82, v83
    v_mul_f32 v85, s22, v85
    v_mul_f32 v86, s22, v86
    v_cvt_pk_bf16_f32 v88, v85, -v86
    v_mul_f32 v84, s20, v82
    v_floor_f32 v84, v84
    v_fma_f32 v84, v84, s21, v82
    v_mul_f32 v84, s20, v84
    v_cos_f32 v85, v84
    v_sin_f32 v86, v84
    v_add_f32 v82, v82, v93
    v_mul_f32 v85, s22, v85
    v_mul_f32 v86, s22, v86
    v_cvt_pk_bf16_f32 v89, v85, -v86
    v_mul_f32 v84, s20, v82
    v_floor_f32 v84, v84
    v_fma_f32 v84, v84, s21, v82
    v_mul_f32 v84, s20, v84
    v_cos_f32 v85, v84
    v_sin_f32 v86, v84
    v_add_f32 v82, v82, v83
    v_mul_f32 v85, s22, v85
    v_mul_f32 v86, s22, v86
    v_cvt_pk_bf16_f32 v90, v85, -v86
    v_mul_f32 v84, s20, v82
    v_floor_f32 v84, v84
    v_fma_f32 v84, v84, s21, v82
    v_mul_f32 v84, s20, v84
    v_cos_f32 v85, v84
    v_sin_f32 v86, v84
    v_add_f32 v82, v82, v83
    v_mul_f32 v85, s22, v85
    v_mul_f32 v86, s22, v86
    v_cvt_pk_bf16_f32 v91, v85, -v86
    v_mov_b32 v85, 0x3d21e89b
    v_cvt_pk_bf16_f32 v85, v85, v85
    v_and_b32 v86, 1, v80
    v_lshlrev_b32 v86, 15, v86
    v_xor_b32 v85, v85, v86
    v_cndmask_b32 v88, v88, v85, vcc
    s_mul_i32 s15, s15, 348160
    s_lshl_b32 s16, s16, 10
    s_add_u32 s15, s15, s16
    s_add_u32 s15, s15, 27246592
    buffer_store_dwordx4 v[88:91], v3, s[8:11], s15 offen sc1
    s_add_u32 s14, s14, 384
    s_cmp_lt_u32 s14, 800
    s_cbranch_scc1 P0_floop
    s_sub_u32 s14, s2, 160
    s_lshr_b32 s15, s14, 1
    s_and_b32 s14, s14, 1
    s_mov_b32 s46, 1966080
    s_mov_b32 s47, 0x00020000
    v_lshrrev_b32 v80, 3, v0
    v_and_b32 v81, 7, v0
    v_xor_b32 v81, v81, v80
    v_mul_u32_u24 v80, 1280, v80
    v_lshl_add_u32 v80, v81, 4, v80
    s_lshl_b32 s16, s15, 2
    s_add_u32 s16, s16, s3
    s_mul_i32 s16, s16, 10240
    s_mul_i32 s17, s14, 640
    s_add_u32 s16, s16, s17
    s_lshl_b32 s17, s3, 10
    s_add_u32 m0, s17, 122880
    s_nop 0
    buffer_load_dwordx4 v80, s[44:47], s16 offen lds
    s_add_u32 s16, s16, 128
    s_add_u32 m0, m0, 4096
    s_nop 0
    buffer_load_dwordx4 v80, s[44:47], s16 offen lds
    s_add_u32 s16, s16, 128
    s_add_u32 m0, m0, 4096
    s_nop 0
    buffer_load_dwordx4 v80, s[44:47], s16 offen lds
    s_add_u32 s16, s16, 128
    s_add_u32 m0, m0, 4096
    s_nop 0
    buffer_load_dwordx4 v80, s[44:47], s16 offen lds
    s_add_u32 s16, s16, 128
    s_add_u32 m0, m0, 4096
    s_nop 0
    s_nop 0
    buffer_load_dwordx4 v80, s[44:47], s16 offen lds
    s_add_u32 s16, s16, 128
    s_add_u32 m0, m0, 4096
    v_bfe_u32 v81, v0, 2, 2
    v_lshl_add_u32 v81, v2, 2, v81
    v_bfe_u32 v82, v0, 1, 1
    s_lshl_b32 s17, s3, 1
    v_add_u32 v82, s17, v82
    v_and_b32 v83, 7, v81
    v_xor_b32 v82, v82, v83
    v_lshlrev_b32_e64 v82, 4, v82
    v_lshl_add_u32 v81, v81, 7, v82
    v_and_b32_e64 v82, 1, v0
    v_lshl_add_u32 v81, v82, 3, v81
    v_add_u32 v81, 122880, v81
    s_mul_i32 s14, s14, 20
    s_add_u32 s14, s14, s3
    s_mul_i32 s15, s15, 5120
    s_add_u32 s15, s15, 27000832
    s_waitcnt vmcnt(0)
    s_barrier
    ds_read_b64_tr_b16 v[84:85], v81 offset:0
    ds_read_b64_tr_b16 v[86:87], v81 offset:2048
    ds_read_b64_tr_b16 v[88:89], v81 offset:4096
    ds_read_b64_tr_b16 v[90:91], v81 offset:6144
    ds_read_b64_tr_b16 v[92:93], v81 offset:8192
    ds_read_b64_tr_b16 v[94:95], v81 offset:10240
    ds_read_b64_tr_b16 v[96:97], v81 offset:12288
    ds_read_b64_tr_b16 v[98:99], v81 offset:14336
    ds_read_b64_tr_b16 v[100:101], v81 offset:16384
    ds_read_b64_tr_b16 v[102:103], v81 offset:18432
    s_mul_i32 s16, s14, 13108
    s_lshr_b32 s16, s16, 16
    s_mul_i32 s16, s16, 343040
    s_lshl_b32 s17, s14, 10
    s_add_u32 s16, s16, s17
    s_add_u32 s16, s16, s15
    s_add_u32 s14, s14, 4
    s_waitcnt lgkmcnt(8)
    buffer_store_dwordx4 v[84:87], v3, s[8:11], s16 offen sc1
    s_mul_i32 s16, s14, 13108
    s_lshr_b32 s16, s16, 16
    s_mul_i32 s16, s16, 343040
    s_lshl_b32 s17, s14, 10
    s_add_u32 s16, s16, s17
    s_add_u32 s16, s16, s15
    s_add_u32 s14, s14, 4
    s_waitcnt lgkmcnt(6)
    buffer_store_dwordx4 v[88:91], v3, s[8:11], s16 offen sc1
    s_mul_i32 s16, s14, 13108
    s_lshr_b32 s16, s16, 16
    s_mul_i32 s16, s16, 343040
    s_lshl_b32 s17, s14, 10
    s_add_u32 s16, s16, s17
    s_add_u32 s16, s16, s15
    s_add_u32 s14, s14, 4
    s_waitcnt lgkmcnt(4)
    buffer_store_dwordx4 v[92:95], v3, s[8:11], s16 offen sc1
    s_mul_i32 s16, s14, 13108
    s_lshr_b32 s16, s16, 16
    s_mul_i32 s16, s16, 343040
    s_lshl_b32 s17, s14, 10
    s_add_u32 s16, s16, s17
    s_add_u32 s16, s16, s15
    s_add_u32 s14, s14, 4
    s_waitcnt lgkmcnt(2)
    buffer_store_dwordx4 v[96:99], v3, s[8:11], s16 offen sc1
    s_mul_i32 s16, s14, 13108
    s_lshr_b32 s16, s16, 16
    s_mul_i32 s16, s16, 343040
    s_lshl_b32 s17, s14, 10
    s_add_u32 s16, s16, s17
    s_add_u32 s16, s16, s15
    s_add_u32 s14, s14, 4
    s_waitcnt lgkmcnt(0)
    buffer_store_dwordx4 v[100:103], v3, s[8:11], s16 offen sc1
    s_mov_b32 m0, s60
    s_waitcnt vmcnt(0)
    s_mov_b32 s23, 32489472
    s_cmp_lg_u32 s3, 0
    s_cbranch_scc1 S0_go
    s_and_b32 s22, s2, 7
    s_lshl_b32 s22, s22, 11
    s_add_u32 s22, s22, s23
    v_lshlrev_b32 v15, 7, v0
    s_mov_b64 exec, 65535
    s_mov_b32 s17, 0
S0_poll:
    s_sleep 8
    buffer_load_dword v14, v15, s[8:11], s22 offen sc1
    s_add_u32 s17, s17, 1
    s_waitcnt vmcnt(0)
    v_cmp_gt_u32 vcc, 16, v14
    s_cmp_gt_u32 s17, 200000
    s_cbranch_scc1 S0_brk
    s_cbranch_vccnz S0_poll
S0_brk:
    s_mov_b64 exec, -1
S0_go:
SD_l1:
    v_add_u32 v4, 61440, v3
    v_lshlrev_b32_e64 v5, 14, v2
    v_lshl_add_u32 v5, v1, 4, v5
    v_add_u32 v9, 4096, v3
    s_and_b32 s4, s2, 7
    s_lshr_b32 s5, s2, 3
    s_lshr_b32 s6, s4, 1
    s_lshl_b32 s6, s6, 2
    s_lshr_b32 s7, s5, 3
    s_add_u32 s6, s6, s7
    s_and_b32 s4, s4, 1
    s_lshl_b32 s7, s4, 3
    s_and_b32 s16, s5, 7
    s_add_u32 s7, s7, s16
    s_lshl_b32 s16, s6, 2
    s_add_u32 s16, s16, s3
    s_mul_i32 s20, s16, 98304
    s_lshl_b32 s16, s16, 8
    s_add_u32 s16, s16, s49
    s_mul_i32 s19, s7, 192
    s_mul_i32 s21, s7, 3072
    s_add_u32 s20, s20, s21
    s_add_u32 s20, s20, s57
    s_add_u32 s21, s20, 49152
    s_lshl_b32 s56, s6, 7
    s_add_u32 s56, s56, s61
    s_lshl_b32 s4, s4, 2
    s_and_b32 s17, s5, 3
    s_add_u32 s4, s4, s17
    s_lshl_b32 s6, s6, 1
    s_bfe_u32 s17, s5, 0x10002
    s_add_u32 s6, s6, s17
    s_mul_i32 s54, s4, s51
    s_add_u32 s54, s54, s58
    s_mul_i32 s55, s3, 25600
    s_add_u32 s55, s55, s54
    s_add_u32 s55, s55, 245760
    s_mul_i32 s17, s3, 61440
    s_add_u32 s54, s54, s17
    s_add_u32 s60, s54, 51200
    s_barrier
    s_cmp_eq_u32 s3, 0
    s_cbranch_scc1 KL_arr1
    s_cmp_eq_u32 s53, 1
    s_cbranch_scc1 KL_l1b
    buffer_load_dwordx4 v3, s[8:11], s59 offen offset:0 sc1 lds
    buffer_load_dwordx4 v3, s[8:11], s59 offen offset:1024 sc1 lds
    buffer_load_dwordx4 v3, s[8:11], s59 offen offset:2048 sc1 lds
    buffer_load_dwordx4 v3, s[8:11], s59 offen offset:3072 sc1 lds
    s_add_u32 m0, m0, 4096
    s_add_u32 s59, s59, 4096
    buffer_load_dwordx4 v3, s[8:11], s59 offen offset:0 sc1 lds
    buffer_load_dwordx4 v3, s[8:11], s59 offen offset:1024 sc1 lds
    buffer_load_dwordx4 v3, s[8:11], s59 offen offset:2048 sc1 lds
    buffer_load_dwordx4 v3, s[8:11], s59 offen offset:3072 sc1 lds
    s_add_u32 m0, m0, 4096
    s_add_u32 s59, s59, 4096
    buffer_load_dwordx4 v3, s[8:11], s59 offen offset:0 sc1 lds
    buffer_load_dwordx4 v3, s[8:11], s59 offen offset:1024 sc1 lds
    buffer_load_dwordx4 v3, s[8:11], s59 offen offset:2048 sc1 lds
    buffer_load_dwordx4 v3, s[8:11], s59 offen offset:3072 sc1 lds
    s_add_u32 m0, m0, 4096
    s_add_u32 s59, s59, 4096
    buffer_load_dwordx4 v3, s[8:11], s59 offen offset:0 sc1 lds
    buffer_load_dwordx4 v3, s[8:11], s59 offen offset:1024 sc1 lds
    buffer_load_dwordx4 v3, s[8:11], s59 offen offset:2048 sc1 lds
    buffer_load_dwordx4 v3, s[8:11], s59 offen offset:3072 sc1 lds
    s_add_u32 m0, m0, 4096
    s_add_u32 s59, s59, 4096
    s_branch KL_dma2
LS_spin:
    s_mov_b32 s16, 0
LS_sp:
    buffer_load_dword v14, v15, s[8:11], s56 offen offset:0 sc1
    s_add_u32 s16, s16, 1
    s_waitcnt vmcnt(0)
    v_cmp_gt_u32 vcc, 16, v14
    s_cmp_gt_u32 s16, 200000
    s_cbranch_scc1 LS_ok
    s_cbranch_vccnz LS_sp
    s_branch LS_ok
LB_spin:
    s_mov_b32 s16, 0
LB_sp:
    buffer_load_dword v14, v15, s[8:11], s56 offen offset:2048 sc1
    s_add_u32 s16, s16, 1
    s_waitcnt vmcnt(0)
    v_cmp_gt_u32 vcc, 16, v14
    s_cmp_gt_u32 s16, 200000
    s_cbranch_scc1 LB_ok
    s_cbranch_vccnz LB_sp
    s_branch LB_ok
LX_spin:
    s_mov_b32 s16, 0
LX_sp:
    buffer_load_dword v14, v15, s[8:11], s56 offen offset:0 sc1
    s_add_u32 s16, s16, 1
    s_waitcnt vmcnt(0)
    v_cmp_gt_u32 vcc, 16, v14
    s_cmp_gt_u32 s16, 200000
    s_cbranch_scc1 LX_ok
    s_cbranch_vccnz LX_sp
    s_branch LX_ok
K2_end:
    s_endpgm
code_end:
.section .rodata,"a"
.p2align 6
.amdhsa_kernel interleave_layers__spectral_gfnet__dense_activation_gelu__prompt_kernel
  .amdhsa_next_free_vgpr 512
  .amdhsa_next_free_sgpr 102
  .amdhsa_accum_offset 256
  .amdhsa_group_segment_fixed_size 0
  .amdhsa_kernarg_size 88
  .amdhsa_user_sgpr_count 2
  .amdhsa_user_sgpr_kernarg_segment_ptr 1
  .amdhsa_system_sgpr_workgroup_id_x 1
  .amdhsa_float_denorm_mode_32 3
.end_amdhsa_kernel
```
